```python
import torch

def _softmax(x, axis=-1):
    return torch.softmax(x, dim=axis)
def _gelu(x):
    return torch.nn.functional.gelu(x, approximate="tanh")
def _silu(x):
    return torch.nn.functional.silu(x)
def _sigmoid(x):
    return torch.sigmoid(x)
def _layernorm(x, axis=-1, eps=1e-5):
    m = x.mean(dim=axis, keepdim=True)
    v = x.var(dim=axis, keepdim=True, unbiased=False)
    return (x - m) / torch.sqrt(v + eps)
def _scatter_add(tgt, idx, src, axis=0):
    return tgt.clone().index_add_(axis, idx, src)
def _segment_sum(src, seg, n):
    out = torch.zeros((n,) + src.shape[1:], dtype=src.dtype)
    return out.index_add_(0, seg, src)
def _pad(x, pw):
    flat = tuple(v for pair in reversed(pw) for v in pair)
    return torch.nn.functional.pad(x, flat)

kernel_name = 'sequential_preLN__grouped_kv_mqa__dense_activation_squared_relu__prompt'

def setup_inputs():

    _w = (lambda a: (lambda t: t.to(torch.bfloat16) if t.is_floating_point() else t)(torch.as_tensor(a)))
    def _A_setup():
        B, S, D, H = 1, 2048, 512, 32
        Dh = D // H
        return {
            "x": _w((lambda *s: torch.randn(*s, dtype=torch.bfloat16) * 0.05)(B, S, D)),
            "wq": _w((lambda *s: torch.randn(*s, dtype=torch.bfloat16) * 0.05)(D, H * Dh)),
            "wk": _w((lambda *s: torch.randn(*s, dtype=torch.bfloat16) * 0.05)(D, Dh)),
            "wv": _w((lambda *s: torch.randn(*s, dtype=torch.bfloat16) * 0.05)(D, Dh)),
            "wo": _w((lambda *s: torch.randn(*s, dtype=torch.bfloat16) * 0.05)(H * Dh, D)),
        }
    _A_in = _A_setup()

    def _B_setup():
        B, S, D, F = 1, 2048, 512, 1376
        return {
            "x": _w((lambda *s: torch.randn(*s, dtype=torch.bfloat16) * 0.05)(B, S, D)),
            "w1": _w((lambda *s: torch.randn(*s, dtype=torch.bfloat16) * 0.05)(D, F)),
            "b1": _w((lambda *s: torch.randn(*s, dtype=torch.bfloat16) * 0.4)(F)),
            "w2": _w((lambda *s: torch.randn(*s, dtype=torch.bfloat16) * 0.05)(F, D)),
            "b2": _w((lambda *s: torch.randn(*s, dtype=torch.bfloat16) * 1.6)(D)),
        }
    _B_in = _B_setup()

    return {
        "A_x": _A_in["x"],
        "A_wq": _A_in["wq"],
        "A_wk": _A_in["wk"],
        "A_wv": _A_in["wv"],
        "A_wo": _A_in["wo"],
        "B_x": _B_in["x"],
        "B_w1": _B_in["w1"],
        "B_b1": _B_in["b1"],
        "B_w2": _B_in["w2"],
        "B_b2": _B_in["b2"],
    }

def reference(A_x, A_wq, A_wk, A_wv, A_wo, B_x, B_w1, B_b1, B_w2, B_b2):
    def _A_ref(x, wq, wk, wv, wo):
        B, S, D = x.shape
        H = 32
        Dh = D // H
        q = (lambda x, *d: x.permute(*d))((x @ wq).reshape(B, S, H, Dh), 0, 2, 1, 3)
        k = x @ wk
        v = x @ wv
        scores = torch.einsum("bhqd,bkd->bhqk", q, k) * (Dh ** -0.5)
        p = _softmax(scores, axis=-1)
        o = torch.einsum("bhqk,bkd->bhqd", p, v)
        return (lambda x, *d: x.permute(*d))(o, 0, 2, 1, 3).reshape(B, S, H * Dh) @ wo

    def _B_ref(x, w1, b1, w2, b2):
        h = torch.einsum("bsd,df->bsf", x, w1) + b1
        zero = torch.zeros_like(h)
        r = torch.where(h > zero, h, zero)
        h = r * r
        out = torch.einsum("bsf,fd->bsd", h, w2) + b2
        return out

    x = A_x
    h = x + _A_ref(_layernorm(x, axis=-1), A_wq, A_wk, A_wv, A_wo)
    h2 = h + _B_ref(_layernorm(h, axis=-1), B_w1, B_b1, B_w2, B_b2)
    return h2
```

```asm
; @launch kernel=qkv_kernel grid=(256,1,1) block=(512,1,1) lds=163840
; @launch kernel=attn_kernel grid=(256,1,1) block=(512,1,1) lds=147712
.amdgcn_target "amdgcn-amd-amdhsa--gfx950"
.text
.globl qkv_kernel
.p2align 8
.type qkv_kernel,@function
qkv_kernel:
    s_cmp_ge_u32 s2, 256
    s_cbranch_scc1 K1_END
    s_load_dwordx8 s[8:15], s[0:1], 0
    s_load_dwordx2 s[16:17], s[0:1], 96
    s_load_dwordx2 s[18:19], s[0:1], 32
    s_load_dwordx2 s[4:5], s[0:1], 64
    v_lshrrev_b32 v2, 6, v0
    v_and_b32 v0, 63, v0
    v_readfirstlane_b32 s20, v2
    s_and_b32 s46, s2, 7
    s_lshr_b32 s47, s2, 3
    s_lshl_b32 s21, s46, 2
    s_and_b32 s46, s47, 3
    s_add_u32 s21, s21, s46
    s_lshr_b32 s22, s47, 2
    s_cmp_ge_u32 s20, 4
    s_cbranch_scc1 K1_MM
    s_setprio 3
    v_lshrrev_b32 v4, 4, v0
    v_and_b32 v5, 15, v0
    s_lshl_b32 s46, s20, 14
    v_add_u32 v6, 0, v4
    v_xor_b32 v7, v5, v6
    v_lshlrev_b32 v7, 4, v7
    v_lshl_add_u32 v7, v6, 10, v7
    v_add_u32 v12, s46, v7
    v_add_u32 v6, 4, v4
    v_xor_b32 v7, v5, v6
    v_lshlrev_b32 v7, 4, v7
    v_lshl_add_u32 v7, v6, 10, v7
    v_add_u32 v13, s46, v7
    v_add_u32 v6, 8, v4
    v_xor_b32 v7, v5, v6
    v_lshlrev_b32 v7, 4, v7
    v_lshl_add_u32 v7, v6, 10, v7
    v_add_u32 v14, s46, v7
    v_add_u32 v6, 12, v4
    v_xor_b32 v7, v5, v6
    v_lshlrev_b32 v7, 4, v7
    v_lshl_add_u32 v7, v6, 10, v7
    v_add_u32 v15, s46, v7
    v_lshrrev_b32 v6, 2, v0
    v_and_b32 v7, 3, v0
    v_lshlrev_b32 v7, 4, v7
    v_lshl_add_u32 v9, v6, 10, v7
    s_lshl_b32 s46, s22, 7
    s_lshl_b32 s47, s20, 15
    s_add_u32 s46, s46, s47
    v_add_u32 v16, s46, v9
    v_add_u32 v17, 0x4000, v16
    v_lshrrev_b32 v6, 1, v0
    v_and_b32 v7, 0x13, v6
    v_and_b32 v8, 4, v6
    v_lshl_or_b32 v7, v8, 1, v7
    v_and_b32 v8, 8, v6
    v_lshrrev_b32 v8, 1, v8
    v_or_b32 v7, v7, v8
    v_lshlrev_b32 v7, 5, v7
    v_and_b32 v8, 1, v0
    v_lshl_add_u32 v7, v8, 4, v7
    s_lshl_b32 s46, s20, 10
    v_add_u32 v18, s46, v7
    s_lshl_b32 s48, s20, 12
    s_lshl_b32 s49, s20, 11
    s_add_u32 s49, s49, 65536
    s_add_u32 s50, s46, 131072
    s_lshl_b32 s46, s21, 16
    s_waitcnt lgkmcnt(0)
    s_add_u32 s24, s8, s46
    s_addc_u32 s25, s9, 0
    s_mov_b32 s26, 0x10000
    s_mov_b32 s27, 0x20000
    s_mov_b32 s28, s10
    s_mov_b32 s29, s11
    s_mov_b32 s30, 0x80000
    s_mov_b32 s31, 0x20000
    s_bitcmp1_b32 s22, 0
    s_cselect_b32 s32, s14, s12
    s_cselect_b32 s33, s15, s13
    s_mov_b32 s34, 0x4000
    s_mov_b32 s35, 0x20000
    s_add_u32 s57, s22, s21
    s_add_u32 s56, s57, 0
    s_and_b32 s56, s56, 3
    s_lshl_b32 s51, s56, 8
    s_add_u32 m0, s48, 0
    s_nop 0
    buffer_load_dwordx4 v12, s[24:27], s51 offen lds
    s_add_u32 m0, s48, 1024
    s_nop 0
    buffer_load_dwordx4 v13, s[24:27], s51 offen lds
    s_add_u32 m0, s48, 2048
    s_nop 0
    buffer_load_dwordx4 v14, s[24:27], s51 offen lds
    s_add_u32 m0, s48, 3072
    s_nop 0
    buffer_load_dwordx4 v15, s[24:27], s51 offen lds
    s_lshl_b32 s51, s56, 17
    s_add_u32 m0, s49, 0
    s_nop 0
    buffer_load_dwordx4 v16, s[28:31], s51 offen offset:0 lds
    s_add_u32 m0, s49, 32704
    s_nop 0
    buffer_load_dwordx4 v16, s[28:31], s51 offen offset:64 lds
    s_add_u32 m0, s49, 1024
    s_nop 0
    buffer_load_dwordx4 v17, s[28:31], s51 offen offset:0 lds
    s_add_u32 m0, s49, 33728
    s_nop 0
    buffer_load_dwordx4 v17, s[28:31], s51 offen offset:64 lds
    s_lshl_b32 s51, s56, 12
    s_add_u32 m0, s50, 0
    s_nop 0
    buffer_load_dwordx4 v18, s[32:35], s51 offen lds
    s_add_u32 s56, s57, 1
    s_and_b32 s56, s56, 3
    s_lshl_b32 s51, s56, 8
    s_add_u32 m0, s48, 16384
    s_nop 0
    buffer_load_dwordx4 v12, s[24:27], s51 offen lds
    s_add_u32 m0, s48, 17408
    s_nop 0
    buffer_load_dwordx4 v13, s[24:27], s51 offen lds
    s_add_u32 m0, s48, 18432
    s_nop 0
    buffer_load_dwordx4 v14, s[24:27], s51 offen lds
    s_add_u32 m0, s48, 19456
    s_nop 0
    buffer_load_dwordx4 v15, s[24:27], s51 offen lds
    s_lshl_b32 s51, s56, 17
    s_add_u32 m0, s49, 8192
    s_nop 0
    buffer_load_dwordx4 v16, s[28:31], s51 offen offset:0 lds
    s_add_u32 m0, s49, 40896
    s_nop 0
    buffer_load_dwordx4 v16, s[28:31], s51 offen offset:64 lds
    s_add_u32 m0, s49, 9216
    s_nop 0
    buffer_load_dwordx4 v17, s[28:31], s51 offen offset:0 lds
    s_add_u32 m0, s49, 41920
    s_nop 0
    buffer_load_dwordx4 v17, s[28:31], s51 offen offset:64 lds
    s_lshl_b32 s51, s56, 12
    s_add_u32 m0, s50, 4096
    s_nop 0
    buffer_load_dwordx4 v18, s[32:35], s51 offen lds
    s_setprio 0
    s_lshl_b32 s46, s20, 12
    v_lshlrev_b32 v6, 8, v5
    v_add_u32 v6, s46, v6
    v_lshlrev_b32 v7, 2, v4
    v_add_u32 v8, 0, v7
    v_xor_b32 v8, v8, v5
    v_lshl_add_u32 v19, v8, 4, v6
    v_add_u32 v8, 1, v7
    v_xor_b32 v8, v8, v5
    v_lshl_add_u32 v20, v8, 4, v6
    v_add_u32 v8, 2, v7
    v_xor_b32 v8, v8, v5
    v_lshl_add_u32 v21, v8, 4, v6
    v_add_u32 v8, 3, v7
    v_xor_b32 v8, v8, v5
    v_lshl_add_u32 v22, v8, 4, v6
    v_lshrrev_b32 v3, 5, v0
    v_bfe_u32 v7, v0, 2, 2
    v_bfe_u32 v8, v0, 4, 1
    v_and_b32 v2, 3, v0
    v_lshlrev_b32 v6, 9, v3
    v_lshl_add_u32 v6, v8, 7, v6
    v_lshl_add_u32 v6, v7, 5, v6
    v_lshl_add_u32 v6, v2, 3, v6
    v_add_u32 v24, s50, v6
    s_lshr_b32 s46, s22, 1
    s_lshl_b32 s46, s46, 12
    s_lshl_b32 s47, s20, 2
    v_add_u32 v8, s47, v4
    v_xor_b32 v8, v8, v5
    v_lshlrev_b32 v8, 4, v8
    v_lshl_add_u32 v8, v5, 8, v8
    v_add_u32 v23, s46, v8
    v_mov_b32 v36, 0x3f803f80
    v_mov_b32 v37, 0x3f803f80
    v_mov_b32 v38, 0x3f803f80
    v_mov_b32 v39, 0x3f803f80
    s_add_u32 s40, s16, 0x200000
    s_addc_u32 s41, s17, 0
    s_mov_b32 s42, 0x22000
    s_mov_b32 s43, 0x20000
    s_waitcnt vmcnt(9)
    s_barrier
    ds_read_b128 v[40:43], v19 offset:0
    ds_read_b128 v[44:47], v20 offset:0
    ds_read_b128 v[48:51], v21 offset:0
    ds_read_b128 v[52:55], v22 offset:0
    ds_read_b128 v[72:75], v23 offset:0
    ds_read_b64_tr_b16 v[76:77], v24 offset:0
    ds_read_b64_tr_b16 v[78:79], v24 offset:256
    s_add_u32 s56, s57, 2
    s_and_b32 s56, s56, 3
    s_lshl_b32 s51, s56, 8
    s_add_u32 m0, s48, 32768
    s_nop 0
    buffer_load_dwordx4 v12, s[24:27], s51 offen lds
    s_add_u32 m0, s48, 33792
    s_nop 0
    buffer_load_dwordx4 v13, s[24:27], s51 offen lds
    s_add_u32 m0, s48, 34816
    s_nop 0
    buffer_load_dwordx4 v14, s[24:27], s51 offen lds
    s_add_u32 m0, s48, 35840
    s_nop 0
    buffer_load_dwordx4 v15, s[24:27], s51 offen lds
    s_lshl_b32 s51, s56, 17
    s_add_u32 m0, s49, 16384
    s_nop 0
    buffer_load_dwordx4 v16, s[28:31], s51 offen offset:0 lds
    s_add_u32 m0, s49, 49088
    s_nop 0
    buffer_load_dwordx4 v16, s[28:31], s51 offen offset:64 lds
    s_add_u32 m0, s49, 17408
    s_nop 0
    buffer_load_dwordx4 v17, s[28:31], s51 offen offset:0 lds
    s_add_u32 m0, s49, 50112
    s_nop 0
    buffer_load_dwordx4 v17, s[28:31], s51 offen offset:64 lds
    s_lshl_b32 s51, s56, 12
    s_add_u32 m0, s50, 8192
    s_nop 0
    buffer_load_dwordx4 v18, s[32:35], s51 offen lds
    s_waitcnt lgkmcnt(6)
    v_mfma_f32_16x16x32_bf16 v[28:31], v[40:43], v[40:43], 0
    v_mfma_f32_16x16x32_bf16 v[32:35], v[40:43], v[36:39], 0
    s_waitcnt lgkmcnt(5)
    v_mfma_f32_16x16x32_bf16 v[28:31], v[44:47], v[44:47], v[28:31]
    v_mfma_f32_16x16x32_bf16 v[32:35], v[44:47], v[36:39], v[32:35]
    s_waitcnt lgkmcnt(4)
    v_mfma_f32_16x16x32_bf16 v[28:31], v[48:51], v[48:51], v[28:31]
    v_mfma_f32_16x16x32_bf16 v[32:35], v[48:51], v[36:39], v[32:35]
    s_waitcnt lgkmcnt(3)
    v_mfma_f32_16x16x32_bf16 v[28:31], v[52:55], v[52:55], v[28:31]
    v_mfma_f32_16x16x32_bf16 v[32:35], v[52:55], v[36:39], v[32:35]
    s_waitcnt lgkmcnt(0)
    s_bitcmp1_b32 s22, 0
    s_cbranch_scc1 K1_V0
    v_mfma_f32_16x16x32_bf16 v[80:83], v[76:79], v[72:75], 0
    v_mfma_f32_16x16x32_bf16 v[84:87], v[76:79], v[36:39], 0
    s_branch K1_J0
K1_V0:
    v_mfma_f32_16x16x32_bf16 v[80:83], v[72:75], v[76:79], 0
    v_mfma_f32_16x16x32_bf16 v[84:87], v[36:39], v[76:79], 0
K1_J0:
    s_waitcnt vmcnt(9)
    s_barrier
    ds_read_b128 v[40:43], v19 offset:16384
    ds_read_b128 v[44:47], v20 offset:16384
    ds_read_b128 v[48:51], v21 offset:16384
    ds_read_b128 v[52:55], v22 offset:16384
    ds_read_b128 v[72:75], v23 offset:16384
    ds_read_b64_tr_b16 v[76:77], v24 offset:4096
    ds_read_b64_tr_b16 v[78:79], v24 offset:4352
    s_add_u32 s56, s57, 3
    s_and_b32 s56, s56, 3
    s_lshl_b32 s51, s56, 8
    s_add_u32 m0, s48, 49152
    s_nop 0
    buffer_load_dwordx4 v12, s[24:27], s51 offen lds
    s_add_u32 m0, s48, 50176
    s_nop 0
    buffer_load_dwordx4 v13, s[24:27], s51 offen lds
    s_add_u32 m0, s48, 51200
    s_nop 0
    buffer_load_dwordx4 v14, s[24:27], s51 offen lds
    s_add_u32 m0, s48, 52224
    s_nop 0
    buffer_load_dwordx4 v15, s[24:27], s51 offen lds
    s_lshl_b32 s51, s56, 17
    s_add_u32 m0, s49, 24576
    s_nop 0
    buffer_load_dwordx4 v16, s[28:31], s51 offen offset:0 lds
    s_add_u32 m0, s49, 57280
    s_nop 0
    buffer_load_dwordx4 v16, s[28:31], s51 offen offset:64 lds
    s_add_u32 m0, s49, 25600
    s_nop 0
    buffer_load_dwordx4 v17, s[28:31], s51 offen offset:0 lds
    s_add_u32 m0, s49, 58304
    s_nop 0
    buffer_load_dwordx4 v17, s[28:31], s51 offen offset:64 lds
    s_lshl_b32 s51, s56, 12
    s_add_u32 m0, s50, 12288
    s_nop 0
    buffer_load_dwordx4 v18, s[32:35], s51 offen lds
    s_waitcnt lgkmcnt(6)
    v_mfma_f32_16x16x32_bf16 v[28:31], v[40:43], v[40:43], v[28:31]
    v_mfma_f32_16x16x32_bf16 v[32:35], v[40:43], v[36:39], v[32:35]
    s_waitcnt lgkmcnt(5)
    v_mfma_f32_16x16x32_bf16 v[28:31], v[44:47], v[44:47], v[28:31]
    v_mfma_f32_16x16x32_bf16 v[32:35], v[44:47], v[36:39], v[32:35]
    s_waitcnt lgkmcnt(4)
    v_mfma_f32_16x16x32_bf16 v[28:31], v[48:51], v[48:51], v[28:31]
    v_mfma_f32_16x16x32_bf16 v[32:35], v[48:51], v[36:39], v[32:35]
    s_waitcnt lgkmcnt(3)
    v_mfma_f32_16x16x32_bf16 v[28:31], v[52:55], v[52:55], v[28:31]
    v_mfma_f32_16x16x32_bf16 v[32:35], v[52:55], v[36:39], v[32:35]
    s_waitcnt lgkmcnt(0)
    s_bitcmp1_b32 s22, 0
    s_cbranch_scc1 K1_V1
    v_mfma_f32_16x16x32_bf16 v[80:83], v[76:79], v[72:75], v[80:83]
    v_mfma_f32_16x16x32_bf16 v[84:87], v[76:79], v[36:39], v[84:87]
    s_branch K1_J1
K1_V1:
    v_mfma_f32_16x16x32_bf16 v[80:83], v[72:75], v[76:79], v[80:83]
    v_mfma_f32_16x16x32_bf16 v[84:87], v[36:39], v[76:79], v[84:87]
K1_J1:
    s_waitcnt vmcnt(9)
    s_barrier
    ds_read_b128 v[40:43], v19 offset:32768
    ds_read_b128 v[44:47], v20 offset:32768
    ds_read_b128 v[48:51], v21 offset:32768
    ds_read_b128 v[52:55], v22 offset:32768
    ds_read_b128 v[72:75], v23 offset:32768
    ds_read_b64_tr_b16 v[76:77], v24 offset:8192
    ds_read_b64_tr_b16 v[78:79], v24 offset:8448
    s_waitcnt lgkmcnt(6)
    v_mfma_f32_16x16x32_bf16 v[28:31], v[40:43], v[40:43], v[28:31]
    v_mfma_f32_16x16x32_bf16 v[32:35], v[40:43], v[36:39], v[32:35]
    s_waitcnt lgkmcnt(5)
    v_mfma_f32_16x16x32_bf16 v[28:31], v[44:47], v[44:47], v[28:31]
    v_mfma_f32_16x16x32_bf16 v[32:35], v[44:47], v[36:39], v[32:35]
    s_waitcnt lgkmcnt(4)
    v_mfma_f32_16x16x32_bf16 v[28:31], v[48:51], v[48:51], v[28:31]
    v_mfma_f32_16x16x32_bf16 v[32:35], v[48:51], v[36:39], v[32:35]
    s_waitcnt lgkmcnt(3)
    v_mfma_f32_16x16x32_bf16 v[28:31], v[52:55], v[52:55], v[28:31]
    v_mfma_f32_16x16x32_bf16 v[32:35], v[52:55], v[36:39], v[32:35]
    s_waitcnt lgkmcnt(0)
    s_bitcmp1_b32 s22, 0
    s_cbranch_scc1 K1_V2
    v_mfma_f32_16x16x32_bf16 v[80:83], v[76:79], v[72:75], v[80:83]
    v_mfma_f32_16x16x32_bf16 v[84:87], v[76:79], v[36:39], v[84:87]
    s_branch K1_J2
K1_V2:
    v_mfma_f32_16x16x32_bf16 v[80:83], v[72:75], v[76:79], v[80:83]
    v_mfma_f32_16x16x32_bf16 v[84:87], v[36:39], v[76:79], v[84:87]
K1_J2:
    s_waitcnt vmcnt(0)
    s_barrier
    ds_read_b128 v[40:43], v19 offset:49152
    ds_read_b128 v[44:47], v20 offset:49152
    ds_read_b128 v[48:51], v21 offset:49152
    ds_read_b128 v[52:55], v22 offset:49152
    ds_read_b128 v[72:75], v23 offset:49152
    ds_read_b64_tr_b16 v[76:77], v24 offset:12288
    ds_read_b64_tr_b16 v[78:79], v24 offset:12544
    s_waitcnt lgkmcnt(6)
    v_mfma_f32_16x16x32_bf16 v[28:31], v[40:43], v[40:43], v[28:31]
    v_mfma_f32_16x16x32_bf16 v[32:35], v[40:43], v[36:39], v[32:35]
    s_waitcnt lgkmcnt(5)
    v_mfma_f32_16x16x32_bf16 v[28:31], v[44:47], v[44:47], v[28:31]
    v_mfma_f32_16x16x32_bf16 v[32:35], v[44:47], v[36:39], v[32:35]
    s_waitcnt lgkmcnt(4)
    v_mfma_f32_16x16x32_bf16 v[28:31], v[48:51], v[48:51], v[28:31]
    v_mfma_f32_16x16x32_bf16 v[32:35], v[48:51], v[36:39], v[32:35]
    s_waitcnt lgkmcnt(3)
    v_mfma_f32_16x16x32_bf16 v[28:31], v[52:55], v[52:55], v[28:31]
    v_mfma_f32_16x16x32_bf16 v[32:35], v[52:55], v[36:39], v[32:35]
    s_waitcnt lgkmcnt(0)
    s_bitcmp1_b32 s22, 0
    s_cbranch_scc1 K1_V3
    v_mfma_f32_16x16x32_bf16 v[80:83], v[76:79], v[72:75], v[80:83]
    v_mfma_f32_16x16x32_bf16 v[84:87], v[76:79], v[36:39], v[84:87]
    s_branch K1_J3
K1_V3:
    v_mfma_f32_16x16x32_bf16 v[80:83], v[72:75], v[76:79], v[80:83]
    v_mfma_f32_16x16x32_bf16 v[84:87], v[36:39], v[76:79], v[84:87]
K1_J3:
    v_and_b32 v2, 1, v0
    v_cmp_eq_u32 vcc, 1, v2
    v_and_b32 v2, 2, v0
    v_cmp_eq_u32 s[6:7], 2, v2
    s_mov_b32 s48, 0x3b000000
    s_mov_b32 s49, 0x3727c5ac
    v_cndmask_b32 v28, v28, v29, vcc
    v_cndmask_b32 v30, v30, v31, vcc
    v_cndmask_b32 v32, v32, v33, vcc
    v_cndmask_b32 v34, v34, v35, vcc
    v_cndmask_b32 v89, v28, v30, s[6:7]
    v_cndmask_b32 v88, v32, v34, s[6:7]
    v_mul_f32 v91, s48, v88
    v_mul_f32 v89, s48, v89
    v_fma_f32 v89, -v91, v91, v89
    v_max_f32 v89, 0, v89
    v_add_f32 v89, s49, v89
    v_rsq_f32 v90, v89
    s_lshl_b32 s46, s20, 8
    s_add_u32 s46, s46, 147456
    v_lshlrev_b32 v2, 4, v5
    v_mul_f32 v88, 0x3eb8aa3b, v90
    v_add_u32 v2, s46, v2
    v_mul_f32 v89, v88, v91
    s_mov_b32 exec_lo, 0x00f0000f
    s_mov_b32 exec_hi, 0xf0000f00
    ds_write_b128 v2, v[88:91]
    s_mov_b64 exec, -1
    v_lshlrev_b32 v6, 4, v0
    v_add_u32 v6, 149504, v6
    s_lshl_b32 s46, s20, 11
    v_add_u32 v7, s46, v6
    s_cmp_eq_u32 s20, 3
    s_cbranch_scc1 K1_NOKVP
    ds_write_b128 v7, v[80:83]
    ds_write_b128 v7, v[84:87] offset:1024
K1_NOKVP:
    s_waitcnt lgkmcnt(0)
    s_barrier
    s_cmp_lg_u32 s20, 3
    s_cbranch_scc1 K1_DONE
    ds_read_b128 v[40:43], v6 offset:0
    ds_read_b128 v[44:47], v6 offset:1024
    ds_read_b128 v[48:51], v6 offset:2048
    ds_read_b128 v[52:55], v6 offset:3072
    ds_read_b128 v[56:59], v6 offset:4096
    ds_read_b128 v[60:63], v6 offset:5120
    s_lshr_b32 s45, s22, 1
    s_lshl_b32 s46, s45, 8
    s_add_u32 s46, s46, 147456
    s_lshl_b32 s50, s21, 2
    s_add_u32 s50, s50, s45
    s_bitcmp1_b32 s22, 0
    s_cbranch_scc1 K1_VEP
    v_lshlrev_b32 v2, 4, v5
    v_add_u32 v2, s46, v2
    ds_read_b64 v[88:89], v2 offset:8
    v_and_b32 v3, 3, v5
    v_and_b32 v7, 4, v5
    v_lshl_or_b32 v3, v7, 1, v3
    v_and_b32 v7, 8, v5
    v_lshrrev_b32 v7, 1, v7
    v_or_b32 v3, v3, v7
    v_lshlrev_b32 v3, 4, v3
    v_and_b32 v7, 1, v4
    v_lshl_add_u32 v3, v7, 9, v3
    v_lshrrev_b32 v7, 1, v4
    v_lshl_add_u32 v3, v7, 3, v3
    s_lshr_b32 s47, s50, 1
    s_lshl_b32 s47, s47, 10
    s_and_b32 s46, s50, 1
    s_lshl_b32 s46, s46, 8
    s_add_u32 s47, s47, s46
    s_waitcnt lgkmcnt(0)
    v_pk_add_f32 v[40:41], v[40:41], v[48:49]
    v_pk_add_f32 v[56:57], v[56:57], v[80:81]
    v_pk_add_f32 v[42:43], v[42:43], v[50:51]
    v_pk_add_f32 v[58:59], v[58:59], v[82:83]
    v_pk_add_f32 v[44:45], v[44:45], v[52:53]
    v_pk_add_f32 v[60:61], v[60:61], v[84:85]
    v_pk_add_f32 v[46:47], v[46:47], v[54:55]
    v_pk_add_f32 v[62:63], v[62:63], v[86:87]
    v_pk_add_f32 v[80:81], v[40:41], v[56:57]
    v_pk_add_f32 v[82:83], v[42:43], v[58:59]
    v_pk_add_f32 v[84:85], v[44:45], v[60:61]
    v_pk_add_f32 v[86:87], v[46:47], v[62:63]
    v_fma_f32 v80, -v89, v84, v80
    v_fma_f32 v81, -v89, v85, v81
    v_fma_f32 v82, -v89, v86, v82
    v_fma_f32 v83, -v89, v87, v83
    v_mul_f32 v80, v80, v88
    v_mul_f32 v81, v81, v88
    v_mul_f32 v82, v82, v88
    v_mul_f32 v83, v83, v88
    v_cvt_pk_bf16_f32 v96, v80, v81
    v_cvt_pk_bf16_f32 v97, v82, v83
    v_mul_f32 v90, v80, v80
    v_fmac_f32 v90, v81, v81
    v_fmac_f32 v90, v82, v82
    v_fmac_f32 v90, v83, v83
    buffer_store_dwordx2 v[96:97], v3, s[40:43], s47 offen
    v_mov_b32 v91, v90
    s_nop 1
    v_permlane32_swap_b32 v90, v91
    v_add_f32 v90, v90, v91
    v_mov_b32 v91, v90
    s_nop 1
    v_permlane16_swap_b32 v90, v91
    v_add_f32 v90, v90, v91
    s_nop 1
    v_max_f32_dpp v90, v90, v90 row_ror:8 row_mask:0xf bank_mask:0xf
    s_nop 1
    v_max_f32_dpp v90, v90, v90 row_ror:4 row_mask:0xf bank_mask:0xf
    s_nop 1
    v_max_f32_dpp v90, v90, v90 row_ror:2 row_mask:0xf bank_mask:0xf
    s_nop 1
    v_max_f32_dpp v90, v90, v90 row_ror:1 row_mask:0xf bank_mask:0xf
    s_lshl_b32 s50, s50, 2
    s_add_u32 s50, s50, 0x21000
    v_mov_b32 v7, 0
    s_mov_b64 exec, 1
    buffer_store_dword v90, v7, s[40:43], s50 offen
    s_branch K1_DONE
K1_VEP:
    v_lshlrev_b32 v2, 6, v4
    v_add_u32 v2, s46, v2
    ds_read_b64 v[88:89], v2 offset:8
    ds_read_b64 v[90:91], v2 offset:24
    ds_read_b64 v[92:93], v2 offset:40
    ds_read_b64 v[94:95], v2 offset:56
    v_lshlrev_b32 v3, 4, v5
    v_and_b32 v7, 1, v4
    v_lshl_add_u32 v3, v7, 8, v3
    v_lshrrev_b32 v7, 1, v4
    v_lshl_add_u32 v3, v7, 3, v3
    s_mul_i32 s47, s50, 528
    s_add_u32 s47, s47, 0x10000
    s_waitcnt lgkmcnt(0)
    v_pk_add_f32 v[40:41], v[40:41], v[48:49]
    v_pk_add_f32 v[56:57], v[56:57], v[80:81]
    v_pk_add_f32 v[42:43], v[42:43], v[50:51]
    v_pk_add_f32 v[58:59], v[58:59], v[82:83]
    v_pk_add_f32 v[44:45], v[44:45], v[52:53]
    v_pk_add_f32 v[60:61], v[60:61], v[84:85]
    v_pk_add_f32 v[46:47], v[46:47], v[54:55]
    v_pk_add_f32 v[62:63], v[62:63], v[86:87]
    v_pk_add_f32 v[80:81], v[40:41], v[56:57]
    v_pk_add_f32 v[82:83], v[42:43], v[58:59]
    v_pk_add_f32 v[84:85], v[44:45], v[60:61]
    v_pk_add_f32 v[86:87], v[46:47], v[62:63]
    v_fma_f32 v80, -v89, v84, v80
    v_fma_f32 v81, -v91, v85, v81
    v_fma_f32 v82, -v93, v86, v82
    v_fma_f32 v83, -v95, v87, v83
    v_mul_f32 v80, v80, v88
    v_mul_f32 v81, v81, v90
    v_mul_f32 v82, v82, v92
    v_mul_f32 v83, v83, v94
    v_cvt_pk_bf16_f32 v96, v80, v81
    v_cvt_pk_bf16_f32 v97, v82, v83
    buffer_store_dwordx2 v[96:97], v3, s[40:43], s47 offen
    v_lshlrev_b32 v3, 2, v0
    s_mov_b64 exec, 15
    buffer_store_dword v36, v3, s[40:43], s47 offen offset:512
    s_branch K1_DONE
K1_MM:
    s_sub_u32 s20, s20, 4
    s_getpc_b64 s[6:7]
K1_PC:
    s_sub_u32 s6, s6, K1_PC-qkv_kernel
    s_subb_u32 s7, s7, 0
    s_lshl_b32 s46, s20, 13
    s_add_u32 s6, s6, s46
    s_addc_u32 s7, s7, 0
    v_lshlrev_b32 v6, 7, v0
    v_mov_b32 v7, s7
    v_add_co_u32 v6, vcc, s6, v6
    s_nop 1
    v_addc_co_u32 v7, vcc, 0, v7, vcc
    global_load_dword v102, v[6:7], off
    s_and_b32 s23, s20, 1
    s_bfe_u32 s44, s20, 0x10001
    v_and_b32 v2, 31, v0
    v_lshrrev_b32 v3, 5, v0
    s_lshl_b32 s46, s23, 13
    v_lshlrev_b32 v4, 8, v2
    v_add_u32 v4, s46, v4
    v_and_b32 v5, 15, v0
    v_xor_b32 v5, v5, v3
    s_lshl_b32 s47, s23, 1
    v_xor_b32 v5, s47, v5
    v_mov_b32 v24, 0x3f803f80
    v_mov_b32 v22, 0
    v_mov_b32 v23, 0
    v_xor_b32 v6, 0, v5
    v_lshl_add_u32 v12, v6, 4, v4
    v_xor_b32 v6, 2, v5
    v_lshl_add_u32 v13, v6, 4, v4
    v_xor_b32 v6, 4, v5
    v_lshl_add_u32 v14, v6, 4, v4
    v_xor_b32 v6, 6, v5
    v_lshl_add_u32 v15, v6, 4, v4
    v_xor_b32 v6, 8, v5
    v_lshl_add_u32 v16, v6, 4, v4
    v_xor_b32 v6, 10, v5
    v_lshl_add_u32 v17, v6, 4, v4
    v_xor_b32 v6, 12, v5
    v_lshl_add_u32 v18, v6, 4, v4
    v_xor_b32 v6, 14, v5
    v_lshl_add_u32 v19, v6, 4, v4
    v_lshlrev_b32 v6, 9, v3
    v_bfe_u32 v7, v0, 2, 2
    v_lshl_add_u32 v6, v7, 6, v6
    v_bfe_u32 v7, v0, 4, 1
    v_lshl_add_u32 v6, v7, 5, v6
    v_and_b32 v7, 3, v0
    v_lshl_add_u32 v6, v7, 3, v6
    s_lshl_b32 s46, s44, 15
    s_add_u32 s46, s46, 65536
    s_lshl_b32 s47, s23, 10
    s_add_u32 s46, s46, s47
    v_add_u32 v20, s46, v6
    v_xor_b32 v21, 0x400, v20
    s_lshl_b32 s46, s23, 9
    s_add_u32 s46, s46, 147456
    v_lshlrev_b32 v4, 4, v2
    v_add_u32 v4, s46, v4
    s_lshl_b32 s47, s44, 7
    s_add_u32 s47, s47, 148480
    v_lshlrev_b32 v7, 4, v3
    v_add_u32 v7, s47, v7
    s_lshl_b32 s46, s21, 16
    s_lshl_b32 s47, s23, 15
    s_add_u32 s46, s46, s47
    s_lshl_b32 s47, s22, 10
    s_add_u32 s46, s46, s47
    s_lshl_b32 s47, s44, 8
    s_add_u32 s46, s46, s47
    v_lshrrev_b32 v8, 3, v2
    v_lshlrev_b32 v8, 13, v8
    v_lshl_add_u32 v8, v3, 9, v8
    v_and_b32 v9, 7, v0
    v_lshl_add_u32 v8, v9, 4, v8
    s_waitcnt lgkmcnt(0)
    s_mov_b32 s36, s16
    s_mov_b32 s37, s17
    s_mov_b32 s38, 0x200000
    s_mov_b32 s39, 0x20000
    s_waitcnt lgkmcnt(0)
    s_add_u32 s40, s16, 0x230000
    s_addc_u32 s41, s17, 0
    s_mov_b32 s42, 0x2000
    s_mov_b32 s43, 0x20000
    v_lshlrev_b32 v3, 2, v0
    v_mov_b32 v9, 0
    s_lshl_b32 s47, s2, 8
    s_cmp_eq_u32 s20, 0
    s_cselect_b32 s47, s47, 0x10000
    buffer_store_dword v9, v3, s[40:43], s47 offen
    s_barrier
    ds_read_b128 v[28:31], v12 offset:0
    ds_read_b64_tr_b16 v[44:45], v20 offset:0
    ds_read_b64_tr_b16 v[46:47], v20 offset:256
    ds_read_b128 v[32:35], v13 offset:0
    ds_read_b64_tr_b16 v[48:49], v21 offset:0
    ds_read_b64_tr_b16 v[50:51], v21 offset:256
    ds_read_b128 v[36:39], v14 offset:0
    ds_read_b64_tr_b16 v[52:53], v20 offset:2048
    ds_read_b64_tr_b16 v[54:55], v20 offset:2304
    ds_read_b128 v[40:43], v15 offset:0
    ds_read_b64_tr_b16 v[56:57], v21 offset:2048
    ds_read_b64_tr_b16 v[58:59], v21 offset:2304
    s_waitcnt lgkmcnt(9)
    v_mfma_f32_32x32x16_bf16 v[60:75], v[44:47], v[28:31], 0
    v_dot2c_f32_bf16 v22, v44, v24
    v_dot2c_f32_bf16 v23, v45, v24
    v_dot2c_f32_bf16 v22, v46, v24
    v_dot2c_f32_bf16 v23, v47, v24
    ds_read_b128 v[28:31], v16 offset:0
    ds_read_b64_tr_b16 v[44:45], v20 offset:4096
    ds_read_b64_tr_b16 v[46:47], v20 offset:4352
    s_waitcnt lgkmcnt(9)
    v_mfma_f32_32x32x16_bf16 v[60:75], v[48:51], v[32:35], v[60:75]
    ds_read_b128 v[32:35], v17 offset:0
    ds_read_b64_tr_b16 v[48:49], v21 offset:4096
    ds_read_b64_tr_b16 v[50:51], v21 offset:4352
    s_waitcnt lgkmcnt(9)
    v_mfma_f32_32x32x16_bf16 v[60:75], v[52:55], v[36:39], v[60:75]
    v_dot2c_f32_bf16 v22, v52, v24
    v_dot2c_f32_bf16 v23, v53, v24
    v_dot2c_f32_bf16 v22, v54, v24
    v_dot2c_f32_bf16 v23, v55, v24
    ds_read_b128 v[36:39], v18 offset:0
    ds_read_b64_tr_b16 v[52:53], v20 offset:6144
    ds_read_b64_tr_b16 v[54:55], v20 offset:6400
    s_waitcnt lgkmcnt(9)
    v_mfma_f32_32x32x16_bf16 v[60:75], v[56:59], v[40:43], v[60:75]
    s_waitcnt vmcnt(0)
    v_lshrrev_b32 v104, 4, v0
    v_and_b32 v105, 15, v0
    s_lshl_b32 s59, s20, 11
    s_add_u32 s61, s59, 155648
    v_bfe_u32 v107, v0, 2, 2
    v_and_b32 v108, 3, v0
    v_lshlrev_b32 v106, 4, v0
    s_cmp_eq_u32 s20, 2
    s_cbranch_scc1 K1_WOJ
    s_mov_b32 s52, s4
    s_mov_b32 s53, s5
    s_mov_b32 s54, 0x158000
    s_mov_b32 s55, 0x20000
    s_mul_i32 s60, s2, 3
    s_min_u32 s58, s20, 2
    s_add_u32 s60, s60, s58
    s_lshr_b32 s58, s60, 3
    s_lshl_b32 s58, s58, 14
    s_and_b32 s59, s60, 7
    s_lshl_b32 s59, s59, 7
    s_add_u32 s58, s58, s59
    v_lshrrev_b32 v109, 3, v0
    v_lshlrev_b32 v109, 10, v109
    v_and_b32 v102, 7, v0
    v_lshl_add_u32 v109, v102, 4, v109
    s_mov_b32 m0, s61
    s_add_u32 s59, s58, 0x2000
    buffer_load_dwordx4 v109, s[52:55], s58 offen lds
    s_add_u32 m0, s61, 1024
    v_lshrrev_b32 v102, 5, v0
    buffer_load_dwordx4 v109, s[52:55], s59 offen lds
    v_lshlrev_b32 v102, 9, v102
    v_lshl_add_u32 v102, v107, 7, v102
    v_bfe_u32 v103, v0, 4, 1
    v_lshl_add_u32 v102, v103, 5, v102
    v_lshl_add_u32 v102, v108, 3, v102
    v_add_u32 v102, s61, v102
    s_and_b32 s58, s60, 7
    s_lshl_b32 s58, s58, 3
    s_bfe_u32 s59, s60, 0x30003
    s_add_u32 s58, s58, s59
    s_mul_i32 s58, s58, 11
    s_lshr_b32 s59, s60, 6
    s_add_u32 s58, s58, s59
    s_lshl_b32 s58, s58, 11
    s_cmp_lt_u32 s60, 704
    s_cselect_b32 s58, s58, 0x1000000
    s_add_u32 s52, s16, 0xd00000
    s_addc_u32 s53, s17, 0
    s_mov_b32 s54, 0x160000
    s_mov_b32 s55, 0x20000
    v_add_u32 v103, 1024, v102
    v_add_u32 v104, 64, v102
    v_add_u32 v105, 1088, v102
    s_branch K1_JOBST
K1_WOJ:
    s_mov_b32 s52, s18
    s_mov_b32 s53, s19
    s_mov_b32 s54, 0x80000
    s_mov_b32 s55, 0x20000
    s_lshr_b32 s58, s2, 4
    s_lshl_b32 s58, s58, 15
    s_and_b32 s59, s2, 15
    s_lshl_b32 s59, s59, 6
    s_add_u32 s58, s58, s59
    v_lshrrev_b32 v109, 2, v0
    v_lshlrev_b32 v109, 10, v109
    v_lshl_add_u32 v109, v108, 4, v109
    s_mov_b32 m0, s61
    s_add_u32 s59, s58, 0x4000
    buffer_load_dwordx4 v109, s[52:55], s58 offen lds
    s_add_u32 m0, s61, 1024
    v_lshlrev_b32 v102, 9, v104
    buffer_load_dwordx4 v109, s[52:55], s59 offen lds
    v_lshl_add_u32 v102, v107, 6, v102
    v_lshl_add_u32 v102, v108, 3, v102
    v_add_u32 v102, s61, v102
    s_lshr_b32 s58, s2, 5
    s_lshl_b32 s58, s58, 16
    s_bfe_u32 s59, s2, 0x30001
    s_lshl_b32 s59, s59, 13
    s_add_u32 s58, s58, s59
    s_bfe_u32 s59, s2, 0x10004
    s_lshl_b32 s59, s59, 12
    s_add_u32 s58, s58, s59
    s_and_b32 s59, s2, 1
    s_lshl_b32 s59, s59, 11
    s_add_u32 s58, s58, s59
    s_add_u32 s52, s16, 0x280000
    s_addc_u32 s53, s17, 0
    s_mov_b32 s54, 0x80000
    s_mov_b32 s55, 0x20000
    v_add_u32 v103, 256, v102
    v_add_u32 v104, 32, v102
    v_add_u32 v105, 288, v102
K1_JOBST:
    ds_read_b128 v[40:43], v19 offset:0
    ds_read_b64_tr_b16 v[56:57], v21 offset:6144
    ds_read_b64_tr_b16 v[58:59], v21 offset:6400
    s_waitcnt lgkmcnt(9)
    v_mfma_f32_32x32x16_bf16 v[60:75], v[44:47], v[28:31], v[60:75]
    v_dot2c_f32_bf16 v22, v44, v24
    v_dot2c_f32_bf16 v23, v45, v24
    v_dot2c_f32_bf16 v22, v46, v24
    v_dot2c_f32_bf16 v23, v47, v24
    s_waitcnt lgkmcnt(6)
    v_mfma_f32_32x32x16_bf16 v[60:75], v[48:51], v[32:35], v[60:75]
    s_waitcnt lgkmcnt(3)
    v_mfma_f32_32x32x16_bf16 v[60:75], v[52:55], v[36:39], v[60:75]
    v_dot2c_f32_bf16 v22, v52, v24
    v_dot2c_f32_bf16 v23, v53, v24
    v_dot2c_f32_bf16 v22, v54, v24
    v_dot2c_f32_bf16 v23, v55, v24
    s_waitcnt lgkmcnt(0)
    v_mfma_f32_32x32x16_bf16 v[60:75], v[56:59], v[40:43], v[60:75]
    s_barrier
    ds_read_b128 v[28:31], v12 offset:16384
    ds_read_b64_tr_b16 v[44:45], v20 offset:8192
    ds_read_b64_tr_b16 v[46:47], v20 offset:8448
    ds_read_b128 v[32:35], v13 offset:16384
    ds_read_b64_tr_b16 v[48:49], v21 offset:8192
    ds_read_b64_tr_b16 v[50:51], v21 offset:8448
    ds_read_b128 v[36:39], v14 offset:16384
    ds_read_b64_tr_b16 v[52:53], v20 offset:10240
    ds_read_b64_tr_b16 v[54:55], v20 offset:10496
    ds_read_b128 v[40:43], v15 offset:16384
    ds_read_b64_tr_b16 v[56:57], v21 offset:10240
    ds_read_b64_tr_b16 v[58:59], v21 offset:10496
    s_waitcnt lgkmcnt(9)
    v_mfma_f32_32x32x16_bf16 v[60:75], v[44:47], v[28:31], v[60:75]
    v_dot2c_f32_bf16 v22, v44, v24
    v_dot2c_f32_bf16 v23, v45, v24
    v_dot2c_f32_bf16 v22, v46, v24
    v_dot2c_f32_bf16 v23, v47, v24
    ds_read_b128 v[28:31], v16 offset:16384
    ds_read_b64_tr_b16 v[44:45], v20 offset:12288
    ds_read_b64_tr_b16 v[46:47], v20 offset:12544
    s_waitcnt lgkmcnt(9)
    v_mfma_f32_32x32x16_bf16 v[60:75], v[48:51], v[32:35], v[60:75]
    ds_read_b128 v[32:35], v17 offset:16384
    ds_read_b64_tr_b16 v[48:49], v21 offset:12288
    ds_read_b64_tr_b16 v[50:51], v21 offset:12544
    s_waitcnt lgkmcnt(9)
    v_mfma_f32_32x32x16_bf16 v[60:75], v[52:55], v[36:39], v[60:75]
    v_dot2c_f32_bf16 v22, v52, v24
    v_dot2c_f32_bf16 v23, v53, v24
    v_dot2c_f32_bf16 v22, v54, v24
    v_dot2c_f32_bf16 v23, v55, v24
    ds_read_b128 v[36:39], v18 offset:16384
    ds_read_b64_tr_b16 v[52:53], v20 offset:14336
    ds_read_b64_tr_b16 v[54:55], v20 offset:14592
    s_waitcnt lgkmcnt(9)
    v_mfma_f32_32x32x16_bf16 v[60:75], v[56:59], v[40:43], v[60:75]
    ds_read_b128 v[40:43], v19 offset:16384
    ds_read_b64_tr_b16 v[56:57], v21 offset:14336
    ds_read_b64_tr_b16 v[58:59], v21 offset:14592
    s_waitcnt lgkmcnt(9)
    v_mfma_f32_32x32x16_bf16 v[60:75], v[44:47], v[28:31], v[60:75]
    v_dot2c_f32_bf16 v22, v44, v24
    v_dot2c_f32_bf16 v23, v45, v24
    v_dot2c_f32_bf16 v22, v46, v24
    v_dot2c_f32_bf16 v23, v47, v24
    s_waitcnt lgkmcnt(6)
    v_mfma_f32_32x32x16_bf16 v[60:75], v[48:51], v[32:35], v[60:75]
    s_waitcnt lgkmcnt(3)
    v_mfma_f32_32x32x16_bf16 v[60:75], v[52:55], v[36:39], v[60:75]
    v_dot2c_f32_bf16 v22, v52, v24
    v_dot2c_f32_bf16 v23, v53, v24
    v_dot2c_f32_bf16 v22, v54, v24
    v_dot2c_f32_bf16 v23, v55, v24
    s_waitcnt lgkmcnt(0)
    v_mfma_f32_32x32x16_bf16 v[60:75], v[56:59], v[40:43], v[60:75]
    s_barrier
    ds_read_b128 v[28:31], v12 offset:32768
    ds_read_b64_tr_b16 v[44:45], v20 offset:16384
    ds_read_b64_tr_b16 v[46:47], v20 offset:16640
    ds_read_b128 v[32:35], v13 offset:32768
    ds_read_b64_tr_b16 v[48:49], v21 offset:16384
    ds_read_b64_tr_b16 v[50:51], v21 offset:16640
    ds_read_b128 v[36:39], v14 offset:32768
    ds_read_b64_tr_b16 v[52:53], v20 offset:18432
    ds_read_b64_tr_b16 v[54:55], v20 offset:18688
    ds_read_b128 v[40:43], v15 offset:32768
    ds_read_b64_tr_b16 v[56:57], v21 offset:18432
    ds_read_b64_tr_b16 v[58:59], v21 offset:18688
    s_waitcnt lgkmcnt(9)
    v_mfma_f32_32x32x16_bf16 v[60:75], v[44:47], v[28:31], v[60:75]
    v_dot2c_f32_bf16 v22, v44, v24
    v_dot2c_f32_bf16 v23, v45, v24
    v_dot2c_f32_bf16 v22, v46, v24
    v_dot2c_f32_bf16 v23, v47, v24
    ds_read_b128 v[28:31], v16 offset:32768
    ds_read_b64_tr_b16 v[44:45], v20 offset:20480
    ds_read_b64_tr_b16 v[46:47], v20 offset:20736
    s_waitcnt lgkmcnt(9)
    v_mfma_f32_32x32x16_bf16 v[60:75], v[48:51], v[32:35], v[60:75]
    ds_read_b128 v[32:35], v17 offset:32768
    ds_read_b64_tr_b16 v[48:49], v21 offset:20480
    ds_read_b64_tr_b16 v[50:51], v21 offset:20736
    s_waitcnt lgkmcnt(9)
    v_mfma_f32_32x32x16_bf16 v[60:75], v[52:55], v[36:39], v[60:75]
    v_dot2c_f32_bf16 v22, v52, v24
    v_dot2c_f32_bf16 v23, v53, v24
    v_dot2c_f32_bf16 v22, v54, v24
    v_dot2c_f32_bf16 v23, v55, v24
    ds_read_b128 v[36:39], v18 offset:32768
    ds_read_b64_tr_b16 v[52:53], v20 offset:22528
    ds_read_b64_tr_b16 v[54:55], v20 offset:22784
    s_waitcnt lgkmcnt(9)
    v_mfma_f32_32x32x16_bf16 v[60:75], v[56:59], v[40:43], v[60:75]
    ds_read_b128 v[40:43], v19 offset:32768
    ds_read_b64_tr_b16 v[56:57], v21 offset:22528
    ds_read_b64_tr_b16 v[58:59], v21 offset:22784
    s_waitcnt lgkmcnt(9)
    v_mfma_f32_32x32x16_bf16 v[60:75], v[44:47], v[28:31], v[60:75]
    v_dot2c_f32_bf16 v22, v44, v24
    v_dot2c_f32_bf16 v23, v45, v24
    v_dot2c_f32_bf16 v22, v46, v24
    v_dot2c_f32_bf16 v23, v47, v24
    s_waitcnt lgkmcnt(6)
    v_mfma_f32_32x32x16_bf16 v[60:75], v[48:51], v[32:35], v[60:75]
    s_waitcnt lgkmcnt(3)
    v_mfma_f32_32x32x16_bf16 v[60:75], v[52:55], v[36:39], v[60:75]
    v_dot2c_f32_bf16 v22, v52, v24
    v_dot2c_f32_bf16 v23, v53, v24
    v_dot2c_f32_bf16 v22, v54, v24
    v_dot2c_f32_bf16 v23, v55, v24
    s_waitcnt lgkmcnt(0)
    v_mfma_f32_32x32x16_bf16 v[60:75], v[56:59], v[40:43], v[60:75]
    s_waitcnt vmcnt(0)
    ds_read_b64_tr_b16 v[92:93], v102
    ds_read_b64_tr_b16 v[94:95], v103
    ds_read_b64_tr_b16 v[96:97], v104
    ds_read_b64_tr_b16 v[98:99], v105
    s_waitcnt lgkmcnt(0)
    buffer_store_dwordx4 v[92:95], v106, s[52:55], s58 offen
    buffer_store_dwordx4 v[96:99], v106, s[52:55], s58 offen offset:1024
    s_barrier
    ds_read_b128 v[28:31], v12 offset:49152
    ds_read_b64_tr_b16 v[44:45], v20 offset:24576
    ds_read_b64_tr_b16 v[46:47], v20 offset:24832
    ds_read_b128 v[32:35], v13 offset:49152
    ds_read_b64_tr_b16 v[48:49], v21 offset:24576
    ds_read_b64_tr_b16 v[50:51], v21 offset:24832
    ds_read_b128 v[36:39], v14 offset:49152
    ds_read_b64_tr_b16 v[52:53], v20 offset:26624
    ds_read_b64_tr_b16 v[54:55], v20 offset:26880
    ds_read_b128 v[40:43], v15 offset:49152
    ds_read_b64_tr_b16 v[56:57], v21 offset:26624
    ds_read_b64_tr_b16 v[58:59], v21 offset:26880
    s_waitcnt lgkmcnt(9)
    v_mfma_f32_32x32x16_bf16 v[60:75], v[44:47], v[28:31], v[60:75]
    v_dot2c_f32_bf16 v22, v44, v24
    v_dot2c_f32_bf16 v23, v45, v24
    v_dot2c_f32_bf16 v22, v46, v24
    v_dot2c_f32_bf16 v23, v47, v24
    ds_read_b128 v[28:31], v16 offset:49152
    ds_read_b64_tr_b16 v[44:45], v20 offset:28672
    ds_read_b64_tr_b16 v[46:47], v20 offset:28928
    s_waitcnt lgkmcnt(9)
    v_mfma_f32_32x32x16_bf16 v[60:75], v[48:51], v[32:35], v[60:75]
    ds_read_b128 v[32:35], v17 offset:49152
    ds_read_b64_tr_b16 v[48:49], v21 offset:28672
    ds_read_b64_tr_b16 v[50:51], v21 offset:28928
    s_waitcnt lgkmcnt(9)
    v_mfma_f32_32x32x16_bf16 v[60:75], v[52:55], v[36:39], v[60:75]
    v_dot2c_f32_bf16 v22, v52, v24
    v_dot2c_f32_bf16 v23, v53, v24
    v_dot2c_f32_bf16 v22, v54, v24
    v_dot2c_f32_bf16 v23, v55, v24
    ds_read_b128 v[36:39], v18 offset:49152
    ds_read_b64_tr_b16 v[52:53], v20 offset:30720
    ds_read_b64_tr_b16 v[54:55], v20 offset:30976
    s_waitcnt lgkmcnt(9)
    v_mfma_f32_32x32x16_bf16 v[60:75], v[56:59], v[40:43], v[60:75]
    ds_read_b128 v[40:43], v19 offset:49152
    ds_read_b64_tr_b16 v[56:57], v21 offset:30720
    ds_read_b64_tr_b16 v[58:59], v21 offset:30976
    s_waitcnt lgkmcnt(9)
    v_mfma_f32_32x32x16_bf16 v[60:75], v[44:47], v[28:31], v[60:75]
    v_dot2c_f32_bf16 v22, v44, v24
    v_dot2c_f32_bf16 v23, v45, v24
    v_dot2c_f32_bf16 v22, v46, v24
    v_dot2c_f32_bf16 v23, v47, v24
    s_waitcnt lgkmcnt(6)
    v_mfma_f32_32x32x16_bf16 v[60:75], v[48:51], v[32:35], v[60:75]
    s_waitcnt lgkmcnt(3)
    v_mfma_f32_32x32x16_bf16 v[60:75], v[52:55], v[36:39], v[60:75]
    v_dot2c_f32_bf16 v22, v52, v24
    v_dot2c_f32_bf16 v23, v53, v24
    v_dot2c_f32_bf16 v22, v54, v24
    v_dot2c_f32_bf16 v23, v55, v24
    s_waitcnt lgkmcnt(0)
    v_mfma_f32_32x32x16_bf16 v[60:75], v[56:59], v[40:43], v[60:75]
    s_nop 0
    v_add_f32 v22, v22, v23
    s_lshl_b32 s59, s23, 8
    v_mov_b32 v23, v22
    s_lshl_b32 s60, s44, 7
    s_add_u32 s59, s59, s60
    v_permlane32_swap_b32 v22, v23
    s_add_u32 s59, s59, 148480
    v_lshlrev_b32 v24, 2, v2
    v_add_f32 v22, v22, v23
    v_add_u32 v24, s59, v24
    ds_write_b32 v24, v22
    s_waitcnt lgkmcnt(0)
    s_barrier
    ds_read_b64 v[100:101], v4
    ds_read_b128 v[76:79], v7 offset:0
    ds_read_b128 v[28:31], v7 offset:256
    ds_read_b128 v[80:83], v7 offset:32
    ds_read_b128 v[32:35], v7 offset:288
    ds_read_b128 v[84:87], v7 offset:64
    ds_read_b128 v[36:39], v7 offset:320
    ds_read_b128 v[88:91], v7 offset:96
    ds_read_b128 v[40:43], v7 offset:352
    s_nop 0
    s_waitcnt lgkmcnt(8)
    v_pk_mul_f32 v[60:61], v[60:61], v[100:101] op_sel_hi:[1,0]
    v_pk_mul_f32 v[62:63], v[62:63], v[100:101] op_sel_hi:[1,0]
    v_pk_mul_f32 v[64:65], v[64:65], v[100:101] op_sel_hi:[1,0]
    v_pk_mul_f32 v[66:67], v[66:67], v[100:101] op_sel_hi:[1,0]
    v_pk_mul_f32 v[68:69], v[68:69], v[100:101] op_sel_hi:[1,0]
    v_pk_mul_f32 v[70:71], v[70:71], v[100:101] op_sel_hi:[1,0]
    v_pk_mul_f32 v[72:73], v[72:73], v[100:101] op_sel_hi:[1,0]
    v_pk_mul_f32 v[74:75], v[74:75], v[100:101] op_sel_hi:[1,0]
    s_waitcnt lgkmcnt(0)
    v_pk_add_f32 v[76:77], v[76:77], v[28:29]
    v_pk_add_f32 v[78:79], v[78:79], v[30:31]
    v_pk_add_f32 v[80:81], v[80:81], v[32:33]
    v_pk_add_f32 v[82:83], v[82:83], v[34:35]
    v_pk_add_f32 v[84:85], v[84:85], v[36:37]
    v_pk_add_f32 v[86:87], v[86:87], v[38:39]
    v_pk_add_f32 v[88:89], v[88:89], v[40:41]
    v_pk_add_f32 v[90:91], v[90:91], v[42:43]
    v_pk_fma_f32 v[60:61], v[76:77], v[100:101], v[60:61] op_sel:[0,1,0] op_sel_hi:[1,1,1] neg_lo:[1,0,0] neg_hi:[1,0,0]
    v_pk_fma_f32 v[62:63], v[78:79], v[100:101], v[62:63] op_sel:[0,1,0] op_sel_hi:[1,1,1] neg_lo:[1,0,0] neg_hi:[1,0,0]
    v_pk_fma_f32 v[64:65], v[80:81], v[100:101], v[64:65] op_sel:[0,1,0] op_sel_hi:[1,1,1] neg_lo:[1,0,0] neg_hi:[1,0,0]
    v_pk_fma_f32 v[66:67], v[82:83], v[100:101], v[66:67] op_sel:[0,1,0] op_sel_hi:[1,1,1] neg_lo:[1,0,0] neg_hi:[1,0,0]
    v_pk_fma_f32 v[68:69], v[84:85], v[100:101], v[68:69] op_sel:[0,1,0] op_sel_hi:[1,1,1] neg_lo:[1,0,0] neg_hi:[1,0,0]
    v_pk_fma_f32 v[70:71], v[86:87], v[100:101], v[70:71] op_sel:[0,1,0] op_sel_hi:[1,1,1] neg_lo:[1,0,0] neg_hi:[1,0,0]
    v_pk_fma_f32 v[72:73], v[88:89], v[100:101], v[72:73] op_sel:[0,1,0] op_sel_hi:[1,1,1] neg_lo:[1,0,0] neg_hi:[1,0,0]
    v_pk_fma_f32 v[74:75], v[90:91], v[100:101], v[74:75] op_sel:[0,1,0] op_sel_hi:[1,1,1] neg_lo:[1,0,0] neg_hi:[1,0,0]
    v_cvt_pk_bf16_f32 v92, v60, v61
    v_cvt_pk_bf16_f32 v93, v62, v63
    v_cvt_pk_bf16_f32 v94, v64, v65
    v_cvt_pk_bf16_f32 v95, v66, v67
    v_cvt_pk_bf16_f32 v96, v68, v69
    v_cvt_pk_bf16_f32 v97, v70, v71
    v_cvt_pk_bf16_f32 v98, v72, v73
    v_cvt_pk_bf16_f32 v99, v74, v75
    buffer_store_dwordx4 v[92:95], v8, s[36:39], s46 offen
    buffer_store_dwordx4 v[96:99], v8, s[36:39], s46 offen offset:128
    s_add_u32 s20, s20, 4
K1_DONE:
K1_END:
    s_endpgm
.globl attn_kernel
.p2align 8
.type attn_kernel,@function
attn_kernel:
    s_cmp_ge_u32 s2, 256
    s_cbranch_scc1 K2_END
    s_setprio 3
    s_load_dwordx2 s[16:17], s[0:1], 96
    s_load_dwordx2 s[8:9], s[0:1], 0
    s_load_dwordx4 s[12:15], s[0:1], 48
    s_load_dwordx2 s[18:19], s[0:1], 72
    s_load_dwordx2 s[10:11], s[0:1], 80
    v_lshrrev_b32 v1, 6, v0
    v_and_b32 v0, 63, v0
    v_readfirstlane_b32 s20, v1
    v_lshlrev_b32 v8, 4, v0
    s_and_b32 s22, s2, 7
    s_lshr_b32 s23, s2, 3
    s_lshl_b32 s21, s22, 5
    s_add_u32 s21, s21, s23
    s_lshl_b32 s45, s20, 13
    v_add_u32 v15, s45, v8
    v_lshrrev_b32 v4, 5, v0
    v_and_b32 v5, 31, v0
    v_lshlrev_b32 v3, 4, v5
    v_lshl_add_u32 v3, v4, 8, v3
    s_mul_i32 s22, s20, 8448
    s_add_u32 s22, s22, 0x10000
    v_and_b32 v2, 27, v0
    v_cmp_eq_u32 vcc, 16, v2
    v_mov_b32 v2, 0x40000000
    v_mov_b32 v6, 512
    v_cndmask_b32 v2, v2, v6, vcc
    v_cmp_gt_u32 vcc, 16, v5
    v_lshlrev_b32 v6, 3, v0
    s_nop 0
    v_cndmask_b32 v2, v2, v3, vcc
    v_add_u32 v16, s22, v2
    s_lshl_b32 s23, s21, 13
    s_lshl_b32 s44, s20, 10
    s_add_u32 s22, s23, s44
    s_mov_b32 s46, 0x21000
    s_movk_i32 s44, 0x1000
    s_movk_i32 s50, 3696
    s_movk_i32 s51, 7392
    s_lshr_b32 s47, s20, 2
    s_waitcnt lgkmcnt(0)
    s_mov_b32 s24, s16
    s_mov_b32 s25, s17
    s_mov_b32 s26, 0x200000
    s_mov_b32 s27, 0x20000
    s_add_u32 s28, s16, 0x200000
    s_addc_u32 s29, s17, 0
    s_mov_b32 s30, 0x22000
    s_mov_b32 s31, 0x20000
    buffer_load_dwordx4 v[28:31], v8, s[24:27], s23 offen
    buffer_load_dwordx4 v[40:43], v15, s[28:31], 0 offen offset:0
    buffer_load_dwordx4 v[44:47], v15, s[28:31], 0 offen offset:1024
    buffer_load_dwordx4 v[72:75], v16, s[28:31], 0 offen offset:0
    buffer_load_dwordx4 v[76:79], v16, s[28:31], 0 offen offset:528
    buffer_load_dwordx4 v[48:51], v15, s[28:31], 0 offen offset:2048
    buffer_load_dwordx4 v[232:235], v8, s[24:27], s22 offen
    buffer_load_dwordx2 v[32:33], v6, s[28:31], s46 offen
    buffer_load_dwordx4 v[80:83], v16, s[28:31], 0 offen offset:1056
    buffer_load_dwordx4 v[84:87], v16, s[28:31], 0 offen offset:1584
    buffer_load_dwordx4 v[52:55], v15, s[28:31], 0 offen offset:3072
    s_setprio 0
    s_add_u32 s32, s16, 0x280000
    s_addc_u32 s33, s17, 0
    s_mov_b32 s34, 0x80000
    s_mov_b32 s35, 0x20000
    v_mov_b32 v24, 0
    v_mov_b32 v25, 0
    v_mov_b32 v26, 0
    v_mov_b32 v27, 0
    v_mov_b32 v7, 0xdddddddd
    s_nop 0
    v_mfma_f32_32x32x16_bf16 v[168:183], v[24:27], v[24:27], 0
    v_mfma_f32_32x32x16_bf16 v[184:199], v[24:27], v[24:27], 0
    s_lshl_b32 s22, s20, 2
    s_add_u32 s23, s22, 124960
    v_mov_b32 v21, s23
    ds_write2_b32 v21, v24, v24 offset1:8
    s_add_u32 s22, s22, 122880
    v_lshlrev_b32 v10, 5, v5
    v_add_u32 v10, s22, v10
    s_lshl_b32 s22, s20, 11
    s_add_u32 s22, s22, 106496
    v_add_u32 v9, s22, v8
    s_and_b32 s23, s20, 3
    v_and_b32 v3, 7, v0
    v_lshlrev_b32 v19, 2, v3
    v_add_u32 v19, 124960, v19
    v_and_b32 v2, 3, v0
    v_lshlrev_b32 v20, 2, v2
    v_add_u32 v20, 124992, v20
    v_bfe_u32 v2, v0, 4, 1
    v_bfe_u32 v5, v0, 3, 1
    v_lshlrev_b32 v11, 4, v3
    v_lshl_add_u32 v13, v4, 7, v11
    v_lshl_add_u32 v11, v4, 10, v11
    v_lshl_add_u32 v11, v2, 9, v11
    v_lshl_add_u32 v11, v5, 3, v11
    s_lshl_b32 s22, s23, 7
    s_add_u32 s22, s22, 106496
    v_add_u32 v11, s22, v11
    s_lshl_b32 s22, s23, 8
    s_add_u32 s46, s22, 122880
    v_lshlrev_b32 v12, 5, v3
    v_add_u32 v12, s46, v12
    v_bfe_u32 v4, v0, 3, 2
    v_lshl_add_u32 v13, v4, 2, v13
    s_add_u32 s46, s22, 123904
    v_add_u32 v13, s46, v13
    v_lshrrev_b32 v4, 4, v0
    v_lshlrev_b32 v3, 4, v3
    v_lshl_add_u32 v14, v4, 7, v3
    v_add_u32 v14, 123904, v14
    s_mov_b32 s36, s8
    s_mov_b32 s37, s9
    s_mov_b32 s38, 0x200000
    s_mov_b32 s39, 0x20000
    s_add_u32 s52, s16, 0x500000
    s_addc_u32 s53, s17, 0
    s_mov_b32 s54, 0x200000
    s_mov_b32 s55, 0x20000
    s_mov_b32 s56, s12
    s_mov_b32 s57, s13
    s_mov_b32 s58, 0x158000
    s_mov_b32 s59, 0x20000
    s_add_u32 s40, s16, 0xd00000
    s_addc_u32 s41, s17, 0
    s_mov_b32 s42, 0x160000
    s_mov_b32 s43, 0x20000
    s_lshr_b32 s22, s2, 3
    s_mul_i32 s23, s22, 44032
    s_add_u32 s23, s23, s45
    v_lshlrev_b32 v6, 7, v0
    s_lshl_b32 s48, s22, 14
    s_and_b32 s22, s45, 0x2000
    s_add_u32 s48, s48, s22
    s_mov_b32 s49, s23
    s_lshr_b32 s22, s2, 3
    s_mul_i32 s60, s22, 45056
    s_add_u32 s60, s60, s45
    s_lshr_b32 s4, s21, 4
    s_and_b32 s5, s21, 15
    s_mul_i32 s6, s5, 3
    s_min_u32 s6, s6, 40
    v_add_u32 v17, 98304, v8
    v_lshrrev_b32 v4, 2, v0
    v_mul_u32_u24 v4, 2752, v4
    v_and_b32 v5, 3, v0
    v_lshl_add_u32 v4, v5, 4, v4
    s_lshl_b32 s22, s6, 6
    s_mul_i32 s23, s47, 704512
    s_add_u32 s22, s22, s23
    v_add_u32 v18, s22, v4
    s_lshl_b32 s61, s20, 2
    s_add_u32 s61, s61, s5
    s_mul_i32 s7, s20, 12288
    s_waitcnt vmcnt(9)
    v_mfma_f32_32x32x16_bf16 v[136:151], v[40:43], v[28:31], 0
    s_nop 7
    s_nop 3
    s_setprio 3
    buffer_load_dwordx4 v[88:91], v16, s[28:31], 0 offen offset:2112
    v_exp_f32 v136, v136
    v_exp_f32 v137, v137
    v_exp_f32 v138, v138
    v_exp_f32 v139, v139
    buffer_load_dwordx4 v[92:95], v16, s[28:31], 0 offen offset:2640
    v_exp_f32 v140, v140
    v_exp_f32 v141, v141
    s_waitcnt vmcnt(10)
    v_mfma_f32_32x32x16_bf16 v[152:167], v[44:47], v[28:31], 0
    v_exp_f32 v142, v142
    v_exp_f32 v143, v143
    buffer_load_dwordx4 v[56:59], v15, s[28:31], s44 offen offset:0
    v_exp_f32 v144, v144
    v_exp_f32 v145, v145
    v_exp_f32 v146, v146
    s_waitcnt vmcnt(9)
    v_smfmac_f32_32x32x32_bf16 v[168:183], v[72:75], v[136:143], v7
    v_exp_f32 v147, v147
    v_exp_f32 v148, v148
    v_exp_f32 v149, v149
    v_exp_f32 v150, v150
    v_exp_f32 v151, v151
    s_setprio 2
    buffer_load_dwordx4 v[96:99], v16, s[28:31], 0 offen offset:3168
    v_exp_f32 v152, v152
    v_exp_f32 v153, v153
    v_exp_f32 v154, v154
    v_smfmac_f32_32x32x32_bf16 v[168:183], v[76:79], v[144:151], v7
    v_exp_f32 v155, v155
    buffer_load_dwordx4 v[100:103], v16, s[28:31], s50 offen offset:0
    v_exp_f32 v156, v156
    v_exp_f32 v157, v157
    s_waitcnt vmcnt(10)
    v_mfma_f32_32x32x16_bf16 v[136:151], v[48:51], v[28:31], 0
    v_exp_f32 v158, v158
    v_exp_f32 v159, v159
    buffer_load_dwordx4 v[60:63], v15, s[28:31], s44 offen offset:1024
    v_exp_f32 v160, v160
    v_exp_f32 v161, v161
    v_exp_f32 v162, v162
    s_waitcnt vmcnt(7)
    v_smfmac_f32_32x32x32_bf16 v[168:183], v[80:83], v[152:159], v7
    v_exp_f32 v163, v163
    v_exp_f32 v164, v164
    v_exp_f32 v165, v165
    v_exp_f32 v166, v166
    v_exp_f32 v167, v167
    s_setprio 1
    buffer_load_dwordx4 v[104:107], v16, s[28:31], s50 offen offset:528
    v_exp_f32 v136, v136
    v_exp_f32 v137, v137
    v_exp_f32 v138, v138
    v_smfmac_f32_32x32x32_bf16 v[168:183], v[84:87], v[160:167], v7
    s_lshl_b32 s22, s20, 10
    v_add_u32 v1, s22, v17
    v_mov_b32 v34, 0
    s_waitcnt vmcnt(10)
    ds_write_b128 v1, v[232:235]
    v_exp_f32 v139, v139
    buffer_load_dwordx4 v[108:111], v16, s[28:31], s50 offen offset:1056
    v_dot2c_f32_bf16 v34, v232, v232
    v_dot2c_f32_bf16 v34, v233, v233
    v_dot2c_f32_bf16 v34, v234, v234
    v_dot2c_f32_bf16 v34, v235, v235
    v_max_f32 v32, v32, v33
    s_nop 0
    v_exp_f32 v140, v140
    v_max_f32_dpp v32, v32, v32 row_ror:8 row_mask:0xf bank_mask:0xf
    v_mov_b32 v35, v34
    v_exp_f32 v141, v141
    v_max_f32_dpp v32, v32, v32 row_ror:4 row_mask:0xf bank_mask:0xf
    v_permlane32_swap_b32 v34, v35
    s_waitcnt vmcnt(8)
    v_mfma_f32_32x32x16_bf16 v[152:167], v[52:55], v[28:31], 0
    v_exp_f32 v142, v142
    v_max_f32_dpp v32, v32, v32 row_ror:2 row_mask:0xf bank_mask:0xf
    v_add_f32 v34, v34, v35
    v_exp_f32 v143, v143
    buffer_load_dwordx4 v[64:67], v15, s[28:31], s44 offen offset:2048
    v_max_f32_dpp v32, v32, v32 row_ror:1 row_mask:0xf bank_mask:0xf
    v_mov_b32 v33, v32
    s_nop 0
    v_exp_f32 v144, v144
    v_permlane32_swap_b32 v32, v33
    v_max_f32 v32, v32, v33
    v_mov_b32 v33, v32
    s_nop 0
    v_exp_f32 v145, v145
    v_permlane16_swap_b32 v32, v33
    v_max_f32 v32, v32, v33
    v_mul_f32 v32, v32, v34
    v_mov_b32 v33, 0x44c03bd7
    v_cmp_nle_f32 vcc, v32, v33
    s_lshl_b32 s22, s20, 2
    s_add_u32 s22, s22, 124928
    v_exp_f32 v146, v146
    s_cmp_lg_u64 vcc, 0
    s_cselect_b32 s23, 1, 0
    v_mov_b32 v1, s22
    v_mov_b32 v2, s23
    ds_write_b32 v1, v2
    v_mov_b32 v1, 124928
    s_waitcnt vmcnt(7)
    v_smfmac_f32_32x32x32_bf16 v[168:183], v[88:91], v[136:143], v7
    v_exp_f32 v147, v147
    v_exp_f32 v148, v148
    v_exp_f32 v149, v149
    v_exp_f32 v150, v150
    v_exp_f32 v151, v151
    s_setprio 0
    buffer_load_dwordx4 v[112:115], v16, s[28:31], s50 offen offset:1584
    v_exp_f32 v152, v152
    v_exp_f32 v153, v153
    v_exp_f32 v154, v154
    v_smfmac_f32_32x32x32_bf16 v[168:183], v[92:95], v[144:151], v7
    v_exp_f32 v155, v155
    buffer_load_dwordx4 v[116:119], v16, s[28:31], s50 offen offset:2112
    v_exp_f32 v156, v156
    v_exp_f32 v157, v157
    s_waitcnt vmcnt(8)
    v_mfma_f32_32x32x16_bf16 v[136:151], v[56:59], v[28:31], 0
    v_exp_f32 v158, v158
    v_exp_f32 v159, v159
    buffer_load_dwordx4 v[68:71], v15, s[28:31], s44 offen offset:3072
    v_exp_f32 v160, v160
    v_exp_f32 v161, v161
    v_exp_f32 v162, v162
    s_waitcnt vmcnt(7)
    v_smfmac_f32_32x32x32_bf16 v[168:183], v[96:99], v[152:159], v7
    v_exp_f32 v163, v163
    v_exp_f32 v164, v164
    v_exp_f32 v165, v165
    v_exp_f32 v166, v166
    v_exp_f32 v167, v167
    s_setprio 3
    buffer_load_dwordx4 v[120:123], v16, s[28:31], s50 offen offset:2640
    s_waitcnt lgkmcnt(0)
    s_barrier
    ds_read_b128 v[32:35], v1
    ds_read_b128 v[36:39], v1 offset:16
    v_exp_f32 v136, v136
    v_exp_f32 v137, v137
    v_exp_f32 v138, v138
    v_smfmac_f32_32x32x32_bf16 v[168:183], v[100:103], v[160:167], v7
    v_exp_f32 v139, v139
    buffer_load_dwordx4 v[124:127], v16, s[28:31], s50 offen offset:3168
    v_exp_f32 v140, v140
    s_waitcnt lgkmcnt(0)
    v_or3_b32 v32, v32, v33, v34
    v_or3_b32 v35, v35, v36, v37
    v_or3_b32 v32, v32, v38, v39
    v_or_b32 v32, v32, v35
    s_nop 0
    v_readfirstlane_b32 s22, v32
    s_cmp_lg_u32 s22, 0
    s_cbranch_scc1 K2_SLOW
    v_exp_f32 v141, v141
    s_waitcnt vmcnt(8)
    v_mfma_f32_32x32x16_bf16 v[152:167], v[60:63], v[28:31], 0
    v_exp_f32 v142, v142
    v_exp_f32 v143, v143
    v_exp_f32 v144, v144
    v_exp_f32 v145, v145
    v_exp_f32 v146, v146
    s_waitcnt vmcnt(6)
    v_smfmac_f32_32x32x32_bf16 v[168:183], v[104:107], v[136:143], v7
    v_exp_f32 v147, v147
    v_exp_f32 v148, v148
    v_exp_f32 v149, v149
    v_exp_f32 v150, v150
    v_exp_f32 v151, v151
    s_setprio 2
    buffer_load_dwordx4 v[128:131], v16, s[28:31], s51 offen offset:0
    v_exp_f32 v152, v152
    v_exp_f32 v153, v153
    v_exp_f32 v154, v154
    v_smfmac_f32_32x32x32_bf16 v[168:183], v[108:111], v[144:151], v7
    v_exp_f32 v155, v155
    buffer_load_dwordx4 v[132:135], v16, s[28:31], s51 offen offset:528
    v_exp_f32 v156, v156
    v_exp_f32 v157, v157
    s_waitcnt vmcnt(7)
    v_mfma_f32_32x32x16_bf16 v[136:151], v[64:67], v[28:31], 0
    v_exp_f32 v158, v158
    v_exp_f32 v159, v159
    v_exp_f32 v160, v160
    v_exp_f32 v161, v161
    v_exp_f32 v162, v162
    s_waitcnt vmcnt(5)
    v_smfmac_f32_32x32x32_bf16 v[168:183], v[112:115], v[152:159], v7
    v_exp_f32 v163, v163
    v_exp_f32 v164, v164
    v_exp_f32 v165, v165
    v_exp_f32 v166, v166
    v_exp_f32 v167, v167
    s_setprio 1
    v_exp_f32 v136, v136
    v_exp_f32 v137, v137
    v_exp_f32 v138, v138
    v_smfmac_f32_32x32x32_bf16 v[168:183], v[116:119], v[160:167], v7
    v_exp_f32 v139, v139
    v_exp_f32 v140, v140
    v_exp_f32 v141, v141
    s_waitcnt vmcnt(4)
    v_mfma_f32_32x32x16_bf16 v[152:167], v[68:71], v[28:31], 0
    v_exp_f32 v142, v142
    v_exp_f32 v143, v143
    v_exp_f32 v144, v144
    v_exp_f32 v145, v145
    ds_read_b128 v[28:31], v17 offset:1024
    v_exp_f32 v146, v146
    s_waitcnt vmcnt(2)
    v_smfmac_f32_32x32x32_bf16 v[168:183], v[120:123], v[136:143], v7
    v_exp_f32 v147, v147
    v_exp_f32 v148, v148
    s_cmp_lt_u32 s20, 6
    s_cbranch_scc1 K2_PW
    buffer_load_dword v4, v6, s[32:35], s48 offen
K2_PW:
    v_exp_f32 v149, v149
    v_exp_f32 v150, v150
    v_exp_f32 v151, v151
    s_setprio 0
    v_exp_f32 v152, v152
    v_exp_f32 v153, v153
    v_exp_f32 v154, v154
    v_smfmac_f32_32x32x32_bf16 v[168:183], v[124:127], v[144:151], v7
    v_exp_f32 v155, v155
    v_exp_f32 v156, v156
    v_exp_f32 v157, v157
    s_waitcnt lgkmcnt(0)
    v_mfma_f32_32x32x16_bf16 v[136:151], v[40:43], v[28:31], 0
    v_exp_f32 v158, v158
    v_exp_f32 v159, v159
    v_exp_f32 v160, v160
    v_exp_f32 v161, v161
    v_exp_f32 v162, v162
    s_waitcnt vmcnt(0)
    v_smfmac_f32_32x32x32_bf16 v[168:183], v[128:131], v[152:159], v7
    v_exp_f32 v163, v163
    v_exp_f32 v164, v164
    v_exp_f32 v165, v165
    v_exp_f32 v166, v166
    v_exp_f32 v167, v167
    s_setprio 3
    v_exp_f32 v136, v136
    v_exp_f32 v137, v137
    v_exp_f32 v138, v138
    v_smfmac_f32_32x32x32_bf16 v[168:183], v[132:135], v[160:167], v7
    v_exp_f32 v139, v139
    v_exp_f32 v140, v140
    v_exp_f32 v141, v141
    v_mfma_f32_32x32x16_bf16 v[152:167], v[44:47], v[28:31], 0
    v_exp_f32 v142, v142
    v_exp_f32 v143, v143
    v_exp_f32 v144, v144
    v_exp_f32 v145, v145
    v_exp_f32 v146, v146
    v_smfmac_f32_32x32x32_bf16 v[184:199], v[72:75], v[136:143], v7
    v_exp_f32 v147, v147
    v_exp_f32 v148, v148
    v_exp_f32 v149, v149
    s_nop 0
    v_exp_f32 v150, v150
    v_exp_f32 v151, v151
    s_setprio 2
    v_mov_b32 v23, 1
    v_exp_f32 v152, v152
    ds_write_b128 v9, v[168:171]
    v_exp_f32 v153, v153
    v_exp_f32 v154, v154
    v_smfmac_f32_32x32x32_bf16 v[184:199], v[76:79], v[144:151], v7
    ds_write_b128 v9, v[172:175] offset:1024
    v_exp_f32 v155, v155
    s_lshl_b32 s22, s21, 13
    s_lshl_b32 s23, s20, 10
    s_add_u32 s22, s22, s23
    s_mul_i32 s23, s20, 1040
    s_add_u32 m0, s23, 126976
    s_nop 0
    buffer_load_dwordx4 v8, s[36:39], s22 offen lds
    v_exp_f32 v156, v156
    ds_write_b32 v10, v176
    v_exp_f32 v157, v157
    v_mfma_f32_32x32x16_bf16 v[136:151], v[48:51], v[28:31], 0
    v_exp_f32 v158, v158
    ds_write_b32 v21, v23
    v_exp_f32 v159, v159
    v_exp_f32 v160, v160
    v_exp_f32 v161, v161
    v_exp_f32 v162, v162
    v_smfmac_f32_32x32x32_bf16 v[184:199], v[80:83], v[152:159], v7
    v_exp_f32 v163, v163
    v_exp_f32 v164, v164
    s_mov_b32 s46, 0
    buffer_load_dwordx4 v[200:203], v15, s[32:35], s46 offen offset:0
    v_exp_f32 v165, v165
    v_exp_f32 v166, v166
    v_exp_f32 v167, v167
    s_setprio 1
    v_exp_f32 v136, v136
    v_exp_f32 v137, v137
    v_exp_f32 v138, v138
    v_smfmac_f32_32x32x32_bf16 v[184:199], v[84:87], v[160:167], v7
    v_exp_f32 v139, v139
    v_exp_f32 v140, v140
    v_exp_f32 v141, v141
    v_mfma_f32_32x32x16_bf16 v[152:167], v[52:55], v[28:31], 0
    v_exp_f32 v142, v142
    v_exp_f32 v143, v143
    v_exp_f32 v144, v144
    v_exp_f32 v145, v145
    v_exp_f32 v146, v146
    v_smfmac_f32_32x32x32_bf16 v[184:199], v[88:91], v[136:143], v7
    v_exp_f32 v147, v147
    v_exp_f32 v148, v148
    s_cmp_lg_u32 s20, 0
    s_cbranch_scc1 K2_PAF10
    buffer_load_dword v4, v6, s[56:59], s49 offen
K2_PAF10:
    s_waitcnt lgkmcnt(0)
    s_mov_b32 s46, 0
    buffer_load_dwordx4 v[204:207], v15, s[32:35], s46 offen offset:1024
    v_exp_f32 v149, v149
    v_exp_f32 v150, v150
    v_exp_f32 v151, v151
    s_setprio 0
    ds_read_b32 v22, v19
    v_exp_f32 v152, v152
    v_exp_f32 v153, v153
    v_exp_f32 v154, v154
    v_smfmac_f32_32x32x32_bf16 v[184:199], v[92:95], v[144:151], v7
    v_exp_f32 v155, v155
    s_cmp_lg_u32 s20, 7
    s_cbranch_scc1 K2_B1F
    s_add_u32 s24, s14, 0
    s_addc_u32 s25, s15, 0
    s_movk_i32 s26, 2752
    s_lshl_b32 s22, s6, 6
    v_lshlrev_b32 v4, 2, v0
    s_mov_b32 m0, 147456
    s_nop 0
    buffer_load_dword v4, s[24:27], s22 offen lds
K2_B1F:
    v_exp_f32 v156, v156
    v_exp_f32 v157, v157
    v_mfma_f32_32x32x16_bf16 v[136:151], v[56:59], v[28:31], 0
    v_exp_f32 v158, v158
    s_cmp_lg_u32 s47, 0
    s_cbranch_scc1 K2_NAF1
    s_waitcnt lgkmcnt(0)
    v_cmp_gt_u32 vcc, 1, v22
    s_cbranch_vccnz K2_RAF1
K2_CAF1:
    ds_read_b128 v[32:35], v12
    ds_read_b128 v[36:39], v12 offset:16
    ds_read_b64 v[216:217], v11 offset:0
    ds_read_b64 v[218:219], v11 offset:2048
    ds_read_b64 v[220:221], v11 offset:4096
    ds_read_b64 v[222:223], v11 offset:6144
    ds_read_b64 v[224:225], v11 offset:8192
    ds_read_b64 v[226:227], v11 offset:10240
    ds_read_b64 v[228:229], v11 offset:12288
    ds_read_b64 v[230:231], v11 offset:14336
K2_NAF1:
    v_exp_f32 v159, v159
    v_exp_f32 v160, v160
    v_mfma_f32_32x32x16_bf16 v[168:183], v[24:27], v[24:27], 0
    v_exp_f32 v161, v161
    v_exp_f32 v162, v162
    v_exp_f32 v163, v163
    v_smfmac_f32_32x32x32_bf16 v[184:199], v[96:99], v[152:159], v7
    v_exp_f32 v164, v164
    s_mov_b32 s46, 0
    buffer_load_dwordx4 v[208:211], v15, s[32:35], s46 offen offset:2048
    v_exp_f32 v165, v165
    v_exp_f32 v166, v166
    v_exp_f32 v167, v167
    s_setprio 3
    v_exp_f32 v136, v136
    v_exp_f32 v137, v137
    v_exp_f32 v138, v138
    v_smfmac_f32_32x32x32_bf16 v[184:199], v[100:103], v[160:167], v7
    s_cmp_lg_u32 s47, 0
    s_cbranch_scc1 K2_NBF1
    s_waitcnt lgkmcnt(0)
    v_pk_add_f32 v[32:33], v[32:33], v[34:35]
    v_pk_add_f32 v[36:37], v[36:37], v[38:39]
    v_pk_add_f32 v[216:217], v[216:217], v[218:219]
    v_pk_add_f32 v[220:221], v[220:221], v[222:223]
    v_pk_add_f32 v[224:225], v[224:225], v[226:227]
    v_pk_add_f32 v[228:229], v[228:229], v[230:231]
    v_pk_add_f32 v[32:33], v[32:33], v[36:37]
    v_pk_add_f32 v[216:217], v[216:217], v[220:221]
    v_add_f32 v32, v32, v33
    v_pk_add_f32 v[224:225], v[224:225], v[228:229]
    v_rcp_f32 v32, v32
    v_pk_add_f32 v[216:217], v[216:217], v[224:225]
    v_pk_mul_f32 v[216:217], v[216:217], v[32:33] op_sel_hi:[1,0]
    v_cvt_pk_bf16_f32 v216, v216, v217
    ds_write_b32 v13, v216
    ds_write_b32 v21, v23 offset:32
K2_NBF1:
    v_exp_f32 v139, v139
    v_exp_f32 v140, v140
    v_exp_f32 v141, v141
    v_mfma_f32_32x32x16_bf16 v[152:167], v[60:63], v[28:31], 0
    v_exp_f32 v142, v142
    v_exp_f32 v143, v143
    s_mov_b32 s46, 4096
    buffer_load_dwordx4 v[216:219], v15, s[32:35], s46 offen offset:0
    v_exp_f32 v144, v144
    v_exp_f32 v145, v145
    v_exp_f32 v146, v146
    v_smfmac_f32_32x32x32_bf16 v[184:199], v[104:107], v[136:143], v7
    v_exp_f32 v147, v147
    v_exp_f32 v148, v148
    s_cmp_lg_u32 s20, 1
    s_cbranch_scc1 K2_PAF12
    buffer_load_dword v4, v6, s[56:59], s49 offen
K2_PAF12:
    s_mov_b32 s46, 0
    buffer_load_dwordx4 v[212:215], v15, s[32:35], s46 offen offset:3072
    v_exp_f32 v149, v149
    v_exp_f32 v150, v150
    v_exp_f32 v151, v151
    s_setprio 2
    v_exp_f32 v152, v152
    v_exp_f32 v153, v153
    v_exp_f32 v154, v154
    v_smfmac_f32_32x32x32_bf16 v[184:199], v[108:111], v[144:151], v7
    v_exp_f32 v155, v155
    v_exp_f32 v156, v156
    v_exp_f32 v157, v157
    v_mfma_f32_32x32x16_bf16 v[136:151], v[64:67], v[28:31], 0
    v_exp_f32 v158, v158
    v_exp_f32 v159, v159
    s_mov_b32 s46, 4096
    buffer_load_dwordx4 v[220:223], v15, s[32:35], s46 offen offset:1024
    v_exp_f32 v160, v160
    v_exp_f32 v161, v161
    v_exp_f32 v162, v162
    v_smfmac_f32_32x32x32_bf16 v[184:199], v[112:115], v[152:159], v7
    v_exp_f32 v163, v163
    v_exp_f32 v164, v164
    v_exp_f32 v165, v165
    v_exp_f32 v166, v166
    v_exp_f32 v167, v167
    s_setprio 1
    v_exp_f32 v136, v136
    s_mov_b32 s46, 4096
    buffer_load_dwordx4 v[224:227], v15, s[32:35], s46 offen offset:2048
    ds_read_b32 v22, v20 offset:0
    v_exp_f32 v137, v137
    v_exp_f32 v138, v138
    v_smfmac_f32_32x32x32_bf16 v[184:199], v[116:119], v[160:167], v7
    v_exp_f32 v139, v139
    v_exp_f32 v140, v140
    v_exp_f32 v141, v141
    v_mfma_f32_32x32x16_bf16 v[152:167], v[68:71], v[28:31], 0
    v_exp_f32 v142, v142
    v_exp_f32 v143, v143
    s_waitcnt lgkmcnt(0)
    v_cmp_gt_u32 vcc, 1, v22
    s_cbranch_vccnz K2_RDF1
K2_CDF1:
    ds_read_b128 v[232:235], v14 offset:0
    ds_read_b128 v[236:239], v14 offset:512
    v_exp_f32 v144, v144
    v_exp_f32 v145, v145
    ds_read_b128 v[28:31], v17 offset:2048
    v_exp_f32 v146, v146
    v_smfmac_f32_32x32x32_bf16 v[184:199], v[120:123], v[136:143], v7
    v_exp_f32 v147, v147
    v_exp_f32 v148, v148
    s_cmp_lg_u32 s20, 2
    s_cbranch_scc1 K2_PAF14
    buffer_load_dword v4, v6, s[56:59], s49 offen
K2_PAF14:
    v_exp_f32 v149, v149
    v_exp_f32 v150, v150
    s_waitcnt lgkmcnt(0)
    s_waitcnt vmcnt(5)
    v_mfma_f32_16x16x32_bf16 v[240:243], v[200:203], v[232:235], 0
    v_exp_f32 v151, v151
    s_setprio 0
    v_exp_f32 v152, v152
    v_exp_f32 v153, v153
    v_exp_f32 v154, v154
    v_smfmac_f32_32x32x32_bf16 v[184:199], v[124:127], v[144:151], v7
    v_exp_f32 v155, v155
    v_exp_f32 v156, v156
    v_exp_f32 v157, v157
    s_waitcnt lgkmcnt(0)
    v_mfma_f32_32x32x16_bf16 v[136:151], v[40:43], v[28:31], 0
    v_exp_f32 v158, v158
    v_exp_f32 v159, v159
    s_mov_b32 s46, 4096
    buffer_load_dwordx4 v[228:231], v15, s[32:35], s46 offen offset:3072
    v_exp_f32 v160, v160
    v_mfma_f32_16x16x32_bf16 v[244:247], v[204:207], v[232:235], 0
    v_exp_f32 v161, v161
    v_exp_f32 v162, v162
    v_smfmac_f32_32x32x32_bf16 v[184:199], v[128:131], v[152:159], v7
    v_exp_f32 v163, v163
    v_exp_f32 v164, v164
    v_exp_f32 v165, v165
    v_exp_f32 v166, v166
    s_waitcnt vmcnt(3)
    v_mfma_f32_16x16x32_bf16 v[248:251], v[208:211], v[232:235], 0
    v_exp_f32 v167, v167
    s_setprio 3
    v_exp_f32 v136, v136
    v_exp_f32 v137, v137
    v_exp_f32 v138, v138
    v_smfmac_f32_32x32x32_bf16 v[184:199], v[132:135], v[160:167], v7
    v_exp_f32 v139, v139
    v_exp_f32 v140, v140
    v_exp_f32 v141, v141
    v_mfma_f32_32x32x16_bf16 v[152:167], v[44:47], v[28:31], 0
    v_exp_f32 v142, v142
    v_exp_f32 v143, v143
    v_exp_f32 v144, v144
    v_mfma_f32_16x16x32_bf16 v[252:255], v[212:215], v[232:235], 0
    v_exp_f32 v145, v145
    v_exp_f32 v146, v146
    v_smfmac_f32_32x32x32_bf16 v[168:183], v[72:75], v[136:143], v7
    v_exp_f32 v147, v147
    v_exp_f32 v148, v148
    s_cmp_lg_u32 s20, 3
    s_cbranch_scc1 K2_PAF16
    buffer_load_dword v4, v6, s[56:59], s49 offen
K2_PAF16:
    v_exp_f32 v149, v149
    v_exp_f32 v150, v150
    s_waitcnt vmcnt(2)
    v_mfma_f32_16x16x32_bf16 v[240:243], v[216:219], v[236:239], v[240:243]
    v_exp_f32 v151, v151
    s_setprio 2
    v_mov_b32 v23, 2
    v_exp_f32 v152, v152
    ds_write_b128 v9, v[184:187]
    v_exp_f32 v153, v153
    v_exp_f32 v154, v154
    v_smfmac_f32_32x32x32_bf16 v[168:183], v[76:79], v[144:151], v7
    ds_write_b128 v9, v[188:191] offset:1024
    v_exp_f32 v155, v155
    v_exp_f32 v156, v156
    ds_write_b32 v10, v192
    v_exp_f32 v157, v157
    v_mfma_f32_32x32x16_bf16 v[136:151], v[48:51], v[28:31], 0
    v_exp_f32 v158, v158
    ds_write_b32 v21, v23
    v_exp_f32 v159, v159
    v_exp_f32 v160, v160
    v_mfma_f32_16x16x32_bf16 v[244:247], v[220:223], v[236:239], v[244:247]
    v_exp_f32 v161, v161
    v_exp_f32 v162, v162
    v_smfmac_f32_32x32x32_bf16 v[168:183], v[80:83], v[152:159], v7
    v_exp_f32 v163, v163
    v_exp_f32 v164, v164
    s_mov_b32 s46, 65536
    buffer_load_dwordx4 v[200:203], v15, s[32:35], s46 offen offset:0
    v_exp_f32 v165, v165
    v_exp_f32 v166, v166
    s_waitcnt vmcnt(2)
    v_mfma_f32_16x16x32_bf16 v[248:251], v[224:227], v[236:239], v[248:251]
    v_exp_f32 v167, v167
    s_setprio 1
    v_exp_f32 v136, v136
    v_exp_f32 v137, v137
    v_exp_f32 v138, v138
    v_smfmac_f32_32x32x32_bf16 v[168:183], v[84:87], v[160:167], v7
    v_exp_f32 v139, v139
    v_exp_f32 v140, v140
    v_exp_f32 v141, v141
    v_mfma_f32_32x32x16_bf16 v[152:167], v[52:55], v[28:31], 0
    v_exp_f32 v142, v142
    v_exp_f32 v143, v143
    v_exp_f32 v144, v144
    s_waitcnt vmcnt(1)
    v_mfma_f32_16x16x32_bf16 v[252:255], v[228:231], v[236:239], v[252:255]
    v_exp_f32 v145, v145
    v_exp_f32 v146, v146
    v_smfmac_f32_32x32x32_bf16 v[168:183], v[88:91], v[136:143], v7
    v_exp_f32 v147, v147
    v_exp_f32 v148, v148
    s_cmp_lg_u32 s20, 4
    s_cbranch_scc1 K2_PAF18
    buffer_load_dword v4, v6, s[56:59], s49 offen
K2_PAF18:
    s_waitcnt lgkmcnt(0)
    s_mov_b32 s46, 65536
    buffer_load_dwordx4 v[204:207], v15, s[32:35], s46 offen offset:1024
    v_exp_f32 v149, v149
    v_exp_f32 v150, v150
    v_exp_f32 v151, v151
    s_setprio 0
    ds_read_b32 v22, v19
    v_exp_f32 v152, v152
    v_exp_f32 v153, v153
    v_exp_f32 v154, v154
    v_smfmac_f32_32x32x32_bf16 v[168:183], v[92:95], v[144:151], v7
    v_exp_f32 v155, v155
    v_exp_f32 v156, v156
    v_exp_f32 v157, v157
    v_mfma_f32_32x32x16_bf16 v[136:151], v[56:59], v[28:31], 0
    v_exp_f32 v158, v158
    s_cmp_lg_u32 s47, 1
    s_cbranch_scc1 K2_NAF2
    s_waitcnt lgkmcnt(0)
    v_cmp_gt_u32 vcc, 2, v22
    s_cbranch_vccnz K2_RAF2
K2_CAF2:
    ds_read_b128 v[32:35], v12
    ds_read_b128 v[36:39], v12 offset:16
    ds_read_b64 v[216:217], v11 offset:0
    ds_read_b64 v[218:219], v11 offset:2048
    ds_read_b64 v[220:221], v11 offset:4096
    ds_read_b64 v[222:223], v11 offset:6144
    ds_read_b64 v[224:225], v11 offset:8192
    ds_read_b64 v[226:227], v11 offset:10240
    ds_read_b64 v[228:229], v11 offset:12288
    ds_read_b64 v[230:231], v11 offset:14336
K2_NAF2:
    v_exp_f32 v159, v159
    v_exp_f32 v160, v160
    v_mfma_f32_32x32x16_bf16 v[184:199], v[24:27], v[24:27], 0
    v_exp_f32 v161, v161
    v_exp_f32 v162, v162
    v_exp_f32 v163, v163
    v_smfmac_f32_32x32x32_bf16 v[168:183], v[96:99], v[152:159], v7
    v_exp_f32 v164, v164
    s_mov_b32 s46, 65536
    buffer_load_dwordx4 v[208:211], v15, s[32:35], s46 offen offset:2048
    v_exp_f32 v165, v165
    v_exp_f32 v166, v166
    v_exp_f32 v167, v167
    s_setprio 3
    v_exp_f32 v136, v136
    v_exp_f32 v137, v137
    v_exp_f32 v138, v138
    v_smfmac_f32_32x32x32_bf16 v[168:183], v[100:103], v[160:167], v7
    s_cmp_lg_u32 s47, 1
    s_cbranch_scc1 K2_NBF2
    s_waitcnt lgkmcnt(0)
    v_pk_add_f32 v[32:33], v[32:33], v[34:35]
    v_pk_add_f32 v[36:37], v[36:37], v[38:39]
    v_pk_add_f32 v[216:217], v[216:217], v[218:219]
    v_pk_add_f32 v[220:221], v[220:221], v[222:223]
    v_pk_add_f32 v[224:225], v[224:225], v[226:227]
    v_pk_add_f32 v[228:229], v[228:229], v[230:231]
    v_pk_add_f32 v[32:33], v[32:33], v[36:37]
    v_pk_add_f32 v[216:217], v[216:217], v[220:221]
    v_add_f32 v32, v32, v33
    v_pk_add_f32 v[224:225], v[224:225], v[228:229]
    v_rcp_f32 v32, v32
    v_pk_add_f32 v[216:217], v[216:217], v[224:225]
    v_pk_mul_f32 v[216:217], v[216:217], v[32:33] op_sel_hi:[1,0]
    v_cvt_pk_bf16_f32 v216, v216, v217
    ds_write_b32 v13, v216
    ds_write_b32 v21, v23 offset:32
K2_NBF2:
    v_exp_f32 v139, v139
    v_exp_f32 v140, v140
    v_exp_f32 v141, v141
    v_mfma_f32_32x32x16_bf16 v[152:167], v[60:63], v[28:31], 0
    v_exp_f32 v142, v142
    v_exp_f32 v143, v143
    s_mov_b32 s46, 69632
    buffer_load_dwordx4 v[216:219], v15, s[32:35], s46 offen offset:0
    v_exp_f32 v144, v144
    v_exp_f32 v145, v145
    v_exp_f32 v146, v146
    v_smfmac_f32_32x32x32_bf16 v[168:183], v[104:107], v[136:143], v7
    v_exp_f32 v147, v147
    v_exp_f32 v148, v148
    s_cmp_lg_u32 s20, 5
    s_cbranch_scc1 K2_PAF20
    buffer_load_dword v4, v6, s[56:59], s49 offen
K2_PAF20:
    s_mov_b32 s46, 65536
    buffer_load_dwordx4 v[212:215], v15, s[32:35], s46 offen offset:3072
    v_exp_f32 v149, v149
    v_exp_f32 v150, v150
    v_exp_f32 v151, v151
    s_setprio 2
    v_exp_f32 v152, v152
    v_exp_f32 v153, v153
    v_exp_f32 v154, v154
    v_smfmac_f32_32x32x32_bf16 v[168:183], v[108:111], v[144:151], v7
    v_exp_f32 v155, v155
    v_exp_f32 v156, v156
    v_exp_f32 v157, v157
    v_mfma_f32_32x32x16_bf16 v[136:151], v[64:67], v[28:31], 0
    v_exp_f32 v158, v158
    v_exp_f32 v159, v159
    s_mov_b32 s46, 69632
    buffer_load_dwordx4 v[220:223], v15, s[32:35], s46 offen offset:1024
    v_exp_f32 v160, v160
    v_exp_f32 v161, v161
    v_exp_f32 v162, v162
    v_smfmac_f32_32x32x32_bf16 v[168:183], v[112:115], v[152:159], v7
    v_exp_f32 v163, v163
    v_exp_f32 v164, v164
    v_exp_f32 v165, v165
    v_exp_f32 v166, v166
    v_exp_f32 v167, v167
    s_setprio 1
    v_exp_f32 v136, v136
    s_mov_b32 s46, 69632
    buffer_load_dwordx4 v[224:227], v15, s[32:35], s46 offen offset:2048
    ds_read_b32 v22, v20 offset:16
    v_exp_f32 v137, v137
    v_exp_f32 v138, v138
    v_smfmac_f32_32x32x32_bf16 v[168:183], v[116:119], v[160:167], v7
    v_exp_f32 v139, v139
    v_exp_f32 v140, v140
    v_exp_f32 v141, v141
    v_mfma_f32_32x32x16_bf16 v[152:167], v[68:71], v[28:31], 0
    v_exp_f32 v142, v142
    v_exp_f32 v143, v143
    s_waitcnt lgkmcnt(0)
    v_cmp_gt_u32 vcc, 2, v22
    s_cbranch_vccnz K2_RDF2
K2_CDF2:
    ds_read_b128 v[232:235], v14 offset:0
    ds_read_b128 v[236:239], v14 offset:512
    v_exp_f32 v144, v144
    v_exp_f32 v145, v145
    ds_read_b128 v[28:31], v17 offset:3072
    v_exp_f32 v146, v146
    v_smfmac_f32_32x32x32_bf16 v[168:183], v[120:123], v[136:143], v7
    v_exp_f32 v147, v147
    v_exp_f32 v148, v148
    s_cmp_lg_u32 s20, 0
    s_cbranch_scc1 K2_PBF22
    buffer_load_dword v5, v6, s[40:43], s60 offen
K2_PBF22:
    v_exp_f32 v149, v149
    v_exp_f32 v150, v150
    s_waitcnt lgkmcnt(0)
    s_waitcnt vmcnt(5)
    v_mfma_f32_16x16x32_bf16 v[240:243], v[200:203], v[232:235], v[240:243]
    v_exp_f32 v151, v151
    s_setprio 0
    v_exp_f32 v152, v152
    v_exp_f32 v153, v153
    v_exp_f32 v154, v154
    v_smfmac_f32_32x32x32_bf16 v[168:183], v[124:127], v[144:151], v7
    v_exp_f32 v155, v155
    v_exp_f32 v156, v156
    v_exp_f32 v157, v157
    s_waitcnt lgkmcnt(0)
    v_mfma_f32_32x32x16_bf16 v[136:151], v[40:43], v[28:31], 0
    v_exp_f32 v158, v158
    v_exp_f32 v159, v159
    s_mov_b32 s46, 69632
    buffer_load_dwordx4 v[228:231], v15, s[32:35], s46 offen offset:3072
    v_exp_f32 v160, v160
    v_mfma_f32_16x16x32_bf16 v[244:247], v[204:207], v[232:235], v[244:247]
    v_exp_f32 v161, v161
    v_exp_f32 v162, v162
    v_smfmac_f32_32x32x32_bf16 v[168:183], v[128:131], v[152:159], v7
    v_exp_f32 v163, v163
    v_exp_f32 v164, v164
    v_exp_f32 v165, v165
    v_exp_f32 v166, v166
    s_waitcnt vmcnt(3)
    v_mfma_f32_16x16x32_bf16 v[248:251], v[208:211], v[232:235], v[248:251]
    v_exp_f32 v167, v167
    s_setprio 3
    v_exp_f32 v136, v136
    v_exp_f32 v137, v137
    v_exp_f32 v138, v138
    v_smfmac_f32_32x32x32_bf16 v[168:183], v[132:135], v[160:167], v7
    v_exp_f32 v139, v139
    v_exp_f32 v140, v140
    v_exp_f32 v141, v141
    v_mfma_f32_32x32x16_bf16 v[152:167], v[44:47], v[28:31], 0
    v_exp_f32 v142, v142
    v_exp_f32 v143, v143
    v_exp_f32 v144, v144
    v_mfma_f32_16x16x32_bf16 v[252:255], v[212:215], v[232:235], v[252:255]
    v_exp_f32 v145, v145
    v_exp_f32 v146, v146
    v_smfmac_f32_32x32x32_bf16 v[184:199], v[72:75], v[136:143], v7
    v_exp_f32 v147, v147
    v_exp_f32 v148, v148
    s_cmp_lg_u32 s20, 1
    s_cbranch_scc1 K2_PBF24
    buffer_load_dword v5, v6, s[40:43], s60 offen
K2_PBF24:
    v_exp_f32 v149, v149
    v_exp_f32 v150, v150
    s_waitcnt vmcnt(2)
    v_mfma_f32_16x16x32_bf16 v[240:243], v[216:219], v[236:239], v[240:243]
    v_exp_f32 v151, v151
    s_setprio 2
    v_mov_b32 v23, 3
    v_exp_f32 v152, v152
    ds_write_b128 v9, v[168:171]
    v_exp_f32 v153, v153
    v_exp_f32 v154, v154
    v_smfmac_f32_32x32x32_bf16 v[184:199], v[76:79], v[144:151], v7
    ds_write_b128 v9, v[172:175] offset:1024
    v_exp_f32 v155, v155
    v_exp_f32 v156, v156
    ds_write_b32 v10, v176
    v_exp_f32 v157, v157
    v_mfma_f32_32x32x16_bf16 v[136:151], v[48:51], v[28:31], 0
    v_exp_f32 v158, v158
    ds_write_b32 v21, v23
    v_exp_f32 v159, v159
    v_exp_f32 v160, v160
    v_mfma_f32_16x16x32_bf16 v[244:247], v[220:223], v[236:239], v[244:247]
    v_exp_f32 v161, v161
    v_exp_f32 v162, v162
    v_smfmac_f32_32x32x32_bf16 v[184:199], v[80:83], v[152:159], v7
    v_exp_f32 v163, v163
    v_exp_f32 v164, v164
    s_mov_b32 s46, 131072
    buffer_load_dwordx4 v[200:203], v15, s[32:35], s46 offen offset:0
    v_exp_f32 v165, v165
    v_exp_f32 v166, v166
    s_waitcnt vmcnt(2)
    v_mfma_f32_16x16x32_bf16 v[248:251], v[224:227], v[236:239], v[248:251]
    v_exp_f32 v167, v167
    s_setprio 1
    v_exp_f32 v136, v136
    v_exp_f32 v137, v137
    v_exp_f32 v138, v138
    v_smfmac_f32_32x32x32_bf16 v[184:199], v[84:87], v[160:167], v7
    v_exp_f32 v139, v139
    v_exp_f32 v140, v140
    v_exp_f32 v141, v141
    v_mfma_f32_32x32x16_bf16 v[152:167], v[52:55], v[28:31], 0
    v_exp_f32 v142, v142
    v_exp_f32 v143, v143
    v_exp_f32 v144, v144
    s_waitcnt vmcnt(1)
    v_mfma_f32_16x16x32_bf16 v[252:255], v[228:231], v[236:239], v[252:255]
    v_exp_f32 v145, v145
    v_exp_f32 v146, v146
    v_smfmac_f32_32x32x32_bf16 v[184:199], v[88:91], v[136:143], v7
    v_exp_f32 v147, v147
    v_exp_f32 v148, v148
    s_cmp_lg_u32 s20, 2
    s_cbranch_scc1 K2_PBF26
    buffer_load_dword v5, v6, s[40:43], s60 offen
K2_PBF26:
    s_waitcnt lgkmcnt(0)
    s_mov_b32 s46, 131072
    buffer_load_dwordx4 v[204:207], v15, s[32:35], s46 offen offset:1024
    v_exp_f32 v149, v149
    v_exp_f32 v150, v150
    v_exp_f32 v151, v151
    s_setprio 0
    ds_read_b32 v22, v19
    v_exp_f32 v152, v152
    v_exp_f32 v153, v153
    v_exp_f32 v154, v154
    v_smfmac_f32_32x32x32_bf16 v[184:199], v[92:95], v[144:151], v7
    v_exp_f32 v155, v155
    v_exp_f32 v156, v156
    v_exp_f32 v157, v157
    v_mfma_f32_32x32x16_bf16 v[136:151], v[56:59], v[28:31], 0
    v_exp_f32 v158, v158
    s_cmp_lg_u32 s47, 0
    s_cbranch_scc1 K2_NAF3
    s_waitcnt lgkmcnt(0)
    v_cmp_gt_u32 vcc, 3, v22
    s_cbranch_vccnz K2_RAF3
K2_CAF3:
    ds_read_b128 v[32:35], v12
    ds_read_b128 v[36:39], v12 offset:16
    ds_read_b64 v[216:217], v11 offset:0
    ds_read_b64 v[218:219], v11 offset:2048
    ds_read_b64 v[220:221], v11 offset:4096
    ds_read_b64 v[222:223], v11 offset:6144
    ds_read_b64 v[224:225], v11 offset:8192
    ds_read_b64 v[226:227], v11 offset:10240
    ds_read_b64 v[228:229], v11 offset:12288
    ds_read_b64 v[230:231], v11 offset:14336
K2_NAF3:
    v_exp_f32 v159, v159
    v_exp_f32 v160, v160
    v_mfma_f32_32x32x16_bf16 v[168:183], v[24:27], v[24:27], 0
    v_exp_f32 v161, v161
    v_exp_f32 v162, v162
    v_exp_f32 v163, v163
    v_smfmac_f32_32x32x32_bf16 v[184:199], v[96:99], v[152:159], v7
    v_exp_f32 v164, v164
    s_mov_b32 s46, 131072
    buffer_load_dwordx4 v[208:211], v15, s[32:35], s46 offen offset:2048
    v_exp_f32 v165, v165
    v_exp_f32 v166, v166
    v_exp_f32 v167, v167
    s_setprio 3
    v_exp_f32 v136, v136
    v_exp_f32 v137, v137
    v_exp_f32 v138, v138
    v_smfmac_f32_32x32x32_bf16 v[184:199], v[100:103], v[160:167], v7
    s_cmp_lg_u32 s47, 0
    s_cbranch_scc1 K2_NBF3
    s_waitcnt lgkmcnt(0)
    v_pk_add_f32 v[32:33], v[32:33], v[34:35]
    v_pk_add_f32 v[36:37], v[36:37], v[38:39]
    v_pk_add_f32 v[216:217], v[216:217], v[218:219]
    v_pk_add_f32 v[220:221], v[220:221], v[222:223]
    v_pk_add_f32 v[224:225], v[224:225], v[226:227]
    v_pk_add_f32 v[228:229], v[228:229], v[230:231]
    v_pk_add_f32 v[32:33], v[32:33], v[36:37]
    v_pk_add_f32 v[216:217], v[216:217], v[220:221]
    v_add_f32 v32, v32, v33
    v_pk_add_f32 v[224:225], v[224:225], v[228:229]
    v_rcp_f32 v32, v32
    v_pk_add_f32 v[216:217], v[216:217], v[224:225]
    v_pk_mul_f32 v[216:217], v[216:217], v[32:33] op_sel_hi:[1,0]
    v_cvt_pk_bf16_f32 v216, v216, v217
    ds_write_b32 v13, v216
    ds_write_b32 v21, v23 offset:32
K2_NBF3:
    v_exp_f32 v139, v139
    v_exp_f32 v140, v140
    v_exp_f32 v141, v141
    v_mfma_f32_32x32x16_bf16 v[152:167], v[60:63], v[28:31], 0
    v_exp_f32 v142, v142
    v_exp_f32 v143, v143
    s_mov_b32 s46, 135168
    buffer_load_dwordx4 v[216:219], v15, s[32:35], s46 offen offset:0
    v_exp_f32 v144, v144
    v_exp_f32 v145, v145
    v_exp_f32 v146, v146
    v_smfmac_f32_32x32x32_bf16 v[184:199], v[104:107], v[136:143], v7
    v_exp_f32 v147, v147
    v_exp_f32 v148, v148
    s_cmp_lg_u32 s20, 3
    s_cbranch_scc1 K2_PBF28
    buffer_load_dword v5, v6, s[40:43], s60 offen
K2_PBF28:
    s_mov_b32 s46, 131072
    buffer_load_dwordx4 v[212:215], v15, s[32:35], s46 offen offset:3072
    v_exp_f32 v149, v149
    v_exp_f32 v150, v150
    v_exp_f32 v151, v151
    s_setprio 2
    v_exp_f32 v152, v152
    v_exp_f32 v153, v153
    v_exp_f32 v154, v154
    v_smfmac_f32_32x32x32_bf16 v[184:199], v[108:111], v[144:151], v7
    v_exp_f32 v155, v155
    v_exp_f32 v156, v156
    v_exp_f32 v157, v157
    v_mfma_f32_32x32x16_bf16 v[136:151], v[64:67], v[28:31], 0
    v_exp_f32 v158, v158
    v_exp_f32 v159, v159
    s_mov_b32 s46, 135168
    buffer_load_dwordx4 v[220:223], v15, s[32:35], s46 offen offset:1024
    v_exp_f32 v160, v160
    v_exp_f32 v161, v161
    v_exp_f32 v162, v162
    v_smfmac_f32_32x32x32_bf16 v[184:199], v[112:115], v[152:159], v7
    v_exp_f32 v163, v163
    v_exp_f32 v164, v164
    v_exp_f32 v165, v165
    v_exp_f32 v166, v166
    v_exp_f32 v167, v167
    s_setprio 1
    v_exp_f32 v136, v136
    s_mov_b32 s46, 135168
    buffer_load_dwordx4 v[224:227], v15, s[32:35], s46 offen offset:2048
    ds_read_b32 v22, v20 offset:0
    v_exp_f32 v137, v137
    v_exp_f32 v138, v138
    v_smfmac_f32_32x32x32_bf16 v[184:199], v[116:119], v[160:167], v7
    v_exp_f32 v139, v139
    v_exp_f32 v140, v140
    v_exp_f32 v141, v141
    v_mfma_f32_32x32x16_bf16 v[152:167], v[68:71], v[28:31], 0
    v_exp_f32 v142, v142
    v_exp_f32 v143, v143
    s_waitcnt lgkmcnt(0)
    v_cmp_gt_u32 vcc, 3, v22
    s_cbranch_vccnz K2_RDF3
K2_CDF3:
    ds_read_b128 v[232:235], v14 offset:0
    ds_read_b128 v[236:239], v14 offset:512
    v_exp_f32 v144, v144
    v_exp_f32 v145, v145
    ds_read_b128 v[28:31], v17 offset:4096
    v_exp_f32 v146, v146
    v_smfmac_f32_32x32x32_bf16 v[184:199], v[120:123], v[136:143], v7
    v_exp_f32 v147, v147
    v_exp_f32 v148, v148
    s_cmp_lg_u32 s20, 4
    s_cbranch_scc1 K2_PBF30
    buffer_load_dword v5, v6, s[40:43], s60 offen
K2_PBF30:
    v_exp_f32 v149, v149
    v_exp_f32 v150, v150
    s_waitcnt lgkmcnt(0)
    s_waitcnt vmcnt(5)
    v_mfma_f32_16x16x32_bf16 v[240:243], v[200:203], v[232:235], v[240:243]
    v_exp_f32 v151, v151
    s_setprio 0
    v_exp_f32 v152, v152
    v_exp_f32 v153, v153
    v_exp_f32 v154, v154
    v_smfmac_f32_32x32x32_bf16 v[184:199], v[124:127], v[144:151], v7
    v_exp_f32 v155, v155
    v_exp_f32 v156, v156
    v_exp_f32 v157, v157
    s_waitcnt lgkmcnt(0)
    v_mfma_f32_32x32x16_bf16 v[136:151], v[40:43], v[28:31], 0
    v_exp_f32 v158, v158
    v_exp_f32 v159, v159
    s_mov_b32 s46, 135168
    buffer_load_dwordx4 v[228:231], v15, s[32:35], s46 offen offset:3072
    v_exp_f32 v160, v160
    v_mfma_f32_16x16x32_bf16 v[244:247], v[204:207], v[232:235], v[244:247]
    v_exp_f32 v161, v161
    v_exp_f32 v162, v162
    v_smfmac_f32_32x32x32_bf16 v[184:199], v[128:131], v[152:159], v7
    v_exp_f32 v163, v163
    v_exp_f32 v164, v164
    v_exp_f32 v165, v165
    v_exp_f32 v166, v166
    s_waitcnt vmcnt(3)
    v_mfma_f32_16x16x32_bf16 v[248:251], v[208:211], v[232:235], v[248:251]
    v_exp_f32 v167, v167
    s_setprio 3
    v_exp_f32 v136, v136
    v_exp_f32 v137, v137
    v_exp_f32 v138, v138
    v_smfmac_f32_32x32x32_bf16 v[184:199], v[132:135], v[160:167], v7
    v_exp_f32 v139, v139
    v_exp_f32 v140, v140
    v_exp_f32 v141, v141
    v_mfma_f32_32x32x16_bf16 v[152:167], v[44:47], v[28:31], 0
    v_exp_f32 v142, v142
    v_exp_f32 v143, v143
    v_exp_f32 v144, v144
    v_mfma_f32_16x16x32_bf16 v[252:255], v[212:215], v[232:235], v[252:255]
    v_exp_f32 v145, v145
    v_exp_f32 v146, v146
    v_smfmac_f32_32x32x32_bf16 v[168:183], v[72:75], v[136:143], v7
    v_exp_f32 v147, v147
    v_exp_f32 v148, v148
    s_cmp_lg_u32 s20, 5
    s_cbranch_scc1 K2_PBF32
    buffer_load_dword v5, v6, s[40:43], s60 offen
K2_PBF32:
    v_exp_f32 v149, v149
    v_exp_f32 v150, v150
    s_waitcnt vmcnt(2)
    v_mfma_f32_16x16x32_bf16 v[240:243], v[216:219], v[236:239], v[240:243]
    v_exp_f32 v151, v151
    s_setprio 2
    v_mov_b32 v23, 4
    v_exp_f32 v152, v152
    ds_write_b128 v9, v[184:187]
    v_exp_f32 v153, v153
    v_exp_f32 v154, v154
    v_smfmac_f32_32x32x32_bf16 v[168:183], v[76:79], v[144:151], v7
    ds_write_b128 v9, v[188:191] offset:1024
    v_exp_f32 v155, v155
    v_exp_f32 v156, v156
    ds_write_b32 v10, v192
    v_exp_f32 v157, v157
    v_mfma_f32_32x32x16_bf16 v[136:151], v[48:51], v[28:31], 0
    v_exp_f32 v158, v158
    ds_write_b32 v21, v23
    v_exp_f32 v159, v159
    v_exp_f32 v160, v160
    v_mfma_f32_16x16x32_bf16 v[244:247], v[220:223], v[236:239], v[244:247]
    v_exp_f32 v161, v161
    v_exp_f32 v162, v162
    v_smfmac_f32_32x32x32_bf16 v[168:183], v[80:83], v[152:159], v7
    v_exp_f32 v163, v163
    v_exp_f32 v164, v164
    s_mov_b32 s46, 196608
    buffer_load_dwordx4 v[200:203], v15, s[32:35], s46 offen offset:0
    v_exp_f32 v165, v165
    v_exp_f32 v166, v166
    s_waitcnt vmcnt(2)
    v_mfma_f32_16x16x32_bf16 v[248:251], v[224:227], v[236:239], v[248:251]
    v_exp_f32 v167, v167
    s_setprio 1
    v_exp_f32 v136, v136
    v_exp_f32 v137, v137
    v_exp_f32 v138, v138
    v_smfmac_f32_32x32x32_bf16 v[168:183], v[84:87], v[160:167], v7
    v_exp_f32 v139, v139
    v_exp_f32 v140, v140
    v_exp_f32 v141, v141
    v_mfma_f32_32x32x16_bf16 v[152:167], v[52:55], v[28:31], 0
    v_exp_f32 v142, v142
    v_exp_f32 v143, v143
    v_exp_f32 v144, v144
    s_waitcnt vmcnt(1)
    v_mfma_f32_16x16x32_bf16 v[252:255], v[228:231], v[236:239], v[252:255]
    v_exp_f32 v145, v145
    v_exp_f32 v146, v146
    v_smfmac_f32_32x32x32_bf16 v[168:183], v[88:91], v[136:143], v7
    v_exp_f32 v147, v147
    v_exp_f32 v148, v148
    s_waitcnt lgkmcnt(0)
    s_mov_b32 s46, 196608
    buffer_load_dwordx4 v[204:207], v15, s[32:35], s46 offen offset:1024
    v_exp_f32 v149, v149
    v_exp_f32 v150, v150
    v_exp_f32 v151, v151
    s_setprio 0
    ds_read_b32 v22, v19
    v_exp_f32 v152, v152
    v_exp_f32 v153, v153
    v_exp_f32 v154, v154
    v_smfmac_f32_32x32x32_bf16 v[168:183], v[92:95], v[144:151], v7
    v_exp_f32 v155, v155
    v_exp_f32 v156, v156
    v_exp_f32 v157, v157
    v_mfma_f32_32x32x16_bf16 v[136:151], v[56:59], v[28:31], 0
    v_exp_f32 v158, v158
    s_cmp_lg_u32 s47, 1
    s_cbranch_scc1 K2_NAF4
    s_waitcnt lgkmcnt(0)
    v_cmp_gt_u32 vcc, 4, v22
    s_cbranch_vccnz K2_RAF4
K2_CAF4:
    ds_read_b128 v[32:35], v12
    ds_read_b128 v[36:39], v12 offset:16
    ds_read_b64 v[216:217], v11 offset:0
    ds_read_b64 v[218:219], v11 offset:2048
    ds_read_b64 v[220:221], v11 offset:4096
    ds_read_b64 v[222:223], v11 offset:6144
    ds_read_b64 v[224:225], v11 offset:8192
    ds_read_b64 v[226:227], v11 offset:10240
    ds_read_b64 v[228:229], v11 offset:12288
    ds_read_b64 v[230:231], v11 offset:14336
K2_NAF4:
    v_exp_f32 v159, v159
    v_exp_f32 v160, v160
    v_mfma_f32_32x32x16_bf16 v[184:199], v[24:27], v[24:27], 0
    v_exp_f32 v161, v161
    v_exp_f32 v162, v162
    v_exp_f32 v163, v163
    v_smfmac_f32_32x32x32_bf16 v[168:183], v[96:99], v[152:159], v7
    v_exp_f32 v164, v164
    s_mov_b32 s46, 196608
    buffer_load_dwordx4 v[208:211], v15, s[32:35], s46 offen offset:2048
    v_exp_f32 v165, v165
    v_exp_f32 v166, v166
    v_exp_f32 v167, v167
    s_setprio 3
    v_exp_f32 v136, v136
    v_exp_f32 v137, v137
    v_exp_f32 v138, v138
    v_smfmac_f32_32x32x32_bf16 v[168:183], v[100:103], v[160:167], v7
    s_cmp_lg_u32 s47, 1
    s_cbranch_scc1 K2_NBF4
    s_waitcnt lgkmcnt(0)
    v_pk_add_f32 v[32:33], v[32:33], v[34:35]
    v_pk_add_f32 v[36:37], v[36:37], v[38:39]
    v_pk_add_f32 v[216:217], v[216:217], v[218:219]
    v_pk_add_f32 v[220:221], v[220:221], v[222:223]
    v_pk_add_f32 v[224:225], v[224:225], v[226:227]
    v_pk_add_f32 v[228:229], v[228:229], v[230:231]
    v_pk_add_f32 v[32:33], v[32:33], v[36:37]
    v_pk_add_f32 v[216:217], v[216:217], v[220:221]
    v_add_f32 v32, v32, v33
    v_pk_add_f32 v[224:225], v[224:225], v[228:229]
    v_rcp_f32 v32, v32
    v_pk_add_f32 v[216:217], v[216:217], v[224:225]
    v_pk_mul_f32 v[216:217], v[216:217], v[32:33] op_sel_hi:[1,0]
    v_cvt_pk_bf16_f32 v216, v216, v217
    ds_write_b32 v13, v216
    ds_write_b32 v21, v23 offset:32
K2_NBF4:
    v_exp_f32 v139, v139
    s_add_u32 s22, s61, 0
    s_and_b32 s22, s22, 15
    s_mul_i32 s22, s22, 44032
    s_add_u32 m0, s7, 0
    s_nop 0
    buffer_load_dwordx4 v18, s[56:59], s22 offen offset:0 lds
    v_exp_f32 v140, v140
    v_exp_f32 v141, v141
    v_mfma_f32_32x32x16_bf16 v[152:167], v[60:63], v[28:31], 0
    v_exp_f32 v142, v142
    v_exp_f32 v143, v143
    s_mov_b32 s46, 200704
    buffer_load_dwordx4 v[216:219], v15, s[32:35], s46 offen offset:0
    v_exp_f32 v144, v144
    v_exp_f32 v145, v145
    v_exp_f32 v146, v146
    v_smfmac_f32_32x32x32_bf16 v[168:183], v[104:107], v[136:143], v7
    v_exp_f32 v147, v147
    v_exp_f32 v148, v148
    s_mov_b32 s46, 196608
    buffer_load_dwordx4 v[212:215], v15, s[32:35], s46 offen offset:3072
    v_exp_f32 v149, v149
    v_exp_f32 v150, v150
    v_exp_f32 v151, v151
    s_setprio 2
    v_exp_f32 v152, v152
    v_exp_f32 v153, v153
    v_exp_f32 v154, v154
    v_smfmac_f32_32x32x32_bf16 v[168:183], v[108:111], v[144:151], v7
    v_exp_f32 v155, v155
    v_exp_f32 v156, v156
    v_exp_f32 v157, v157
    v_mfma_f32_32x32x16_bf16 v[136:151], v[64:67], v[28:31], 0
    v_exp_f32 v158, v158
    v_exp_f32 v159, v159
    s_mov_b32 s46, 200704
    buffer_load_dwordx4 v[220:223], v15, s[32:35], s46 offen offset:1024
    v_exp_f32 v160, v160
    v_exp_f32 v161, v161
    v_exp_f32 v162, v162
    v_smfmac_f32_32x32x32_bf16 v[168:183], v[112:115], v[152:159], v7
    v_exp_f32 v163, v163
    v_exp_f32 v164, v164
    v_exp_f32 v165, v165
    v_exp_f32 v166, v166
    v_exp_f32 v167, v167
    s_setprio 1
    v_exp_f32 v136, v136
    s_mov_b32 s46, 200704
    buffer_load_dwordx4 v[224:227], v15, s[32:35], s46 offen offset:2048
    ds_read_b32 v22, v20 offset:16
    v_exp_f32 v137, v137
    v_exp_f32 v138, v138
    v_smfmac_f32_32x32x32_bf16 v[168:183], v[116:119], v[160:167], v7
    v_exp_f32 v139, v139
    s_add_u32 s22, s61, 0
    s_and_b32 s22, s22, 15
    s_mul_i32 s22, s22, 44032
    s_add_u32 m0, s7, 960
    s_nop 0
    buffer_load_dwordx4 v18, s[56:59], s22 offen offset:64 lds
    v_exp_f32 v140, v140
    v_exp_f32 v141, v141
    v_mfma_f32_32x32x16_bf16 v[152:167], v[68:71], v[28:31], 0
    v_exp_f32 v142, v142
    v_exp_f32 v143, v143
    s_waitcnt lgkmcnt(0)
    v_cmp_gt_u32 vcc, 4, v22
    s_cbranch_vccnz K2_RDF4
K2_CDF4:
    ds_read_b128 v[232:235], v14 offset:0
    ds_read_b128 v[236:239], v14 offset:512
    v_exp_f32 v144, v144
    v_exp_f32 v145, v145
    ds_read_b128 v[28:31], v17 offset:5120
    v_exp_f32 v146, v146
    v_smfmac_f32_32x32x32_bf16 v[168:183], v[120:123], v[136:143], v7
    v_exp_f32 v147, v147
    v_exp_f32 v148, v148
    v_exp_f32 v149, v149
    v_exp_f32 v150, v150
    s_waitcnt lgkmcnt(0)
    s_waitcnt vmcnt(7)
    v_mfma_f32_16x16x32_bf16 v[240:243], v[200:203], v[232:235], v[240:243]
    v_exp_f32 v151, v151
    s_setprio 0
    v_exp_f32 v152, v152
    v_exp_f32 v153, v153
    v_exp_f32 v154, v154
    v_smfmac_f32_32x32x32_bf16 v[168:183], v[124:127], v[144:151], v7
    v_exp_f32 v155, v155
    v_exp_f32 v156, v156
    v_exp_f32 v157, v157
    s_waitcnt lgkmcnt(0)
    v_mfma_f32_32x32x16_bf16 v[136:151], v[40:43], v[28:31], 0
    v_exp_f32 v158, v158
    v_exp_f32 v159, v159
    s_mov_b32 s46, 200704
    buffer_load_dwordx4 v[228:231], v15, s[32:35], s46 offen offset:3072
    v_exp_f32 v160, v160
    v_mfma_f32_16x16x32_bf16 v[244:247], v[204:207], v[232:235], v[244:247]
    v_exp_f32 v161, v161
    v_exp_f32 v162, v162
    v_smfmac_f32_32x32x32_bf16 v[168:183], v[128:131], v[152:159], v7
    v_exp_f32 v163, v163
    v_exp_f32 v164, v164
    v_exp_f32 v165, v165
    v_exp_f32 v166, v166
    s_waitcnt vmcnt(4)
    v_mfma_f32_16x16x32_bf16 v[248:251], v[208:211], v[232:235], v[248:251]
    v_exp_f32 v167, v167
    s_setprio 3
    v_exp_f32 v136, v136
    v_exp_f32 v137, v137
    v_exp_f32 v138, v138
    v_smfmac_f32_32x32x32_bf16 v[168:183], v[132:135], v[160:167], v7
    v_exp_f32 v139, v139
    s_add_u32 s22, s61, 0
    s_and_b32 s22, s22, 15
    s_mul_i32 s22, s22, 44032
    s_add_u32 m0, s7, 1920
    s_nop 0
    buffer_load_dwordx4 v18, s[56:59], s22 offen offset:128 lds
    v_exp_f32 v140, v140
    v_exp_f32 v141, v141
    v_mfma_f32_32x32x16_bf16 v[152:167], v[44:47], v[28:31], 0
    v_exp_f32 v142, v142
    v_exp_f32 v143, v143
    v_exp_f32 v144, v144
    v_mfma_f32_16x16x32_bf16 v[252:255], v[212:215], v[232:235], v[252:255]
    v_exp_f32 v145, v145
    v_exp_f32 v146, v146
    v_smfmac_f32_32x32x32_bf16 v[184:199], v[72:75], v[136:143], v7
    v_exp_f32 v147, v147
    v_exp_f32 v148, v148
    v_exp_f32 v149, v149
    v_exp_f32 v150, v150
    s_waitcnt vmcnt(4)
    v_mfma_f32_16x16x32_bf16 v[240:243], v[216:219], v[236:239], v[240:243]
    v_exp_f32 v151, v151
    s_setprio 2
    v_mov_b32 v23, 5
    v_exp_f32 v152, v152
    ds_write_b128 v9, v[168:171]
    v_exp_f32 v153, v153
    v_exp_f32 v154, v154
    v_smfmac_f32_32x32x32_bf16 v[184:199], v[76:79], v[144:151], v7
    ds_write_b128 v9, v[172:175] offset:1024
    v_exp_f32 v155, v155
    v_exp_f32 v156, v156
    ds_write_b32 v10, v176
    v_exp_f32 v157, v157
    v_mfma_f32_32x32x16_bf16 v[136:151], v[48:51], v[28:31], 0
    v_exp_f32 v158, v158
    ds_write_b32 v21, v23
    v_exp_f32 v159, v159
    v_exp_f32 v160, v160
    v_mfma_f32_16x16x32_bf16 v[244:247], v[220:223], v[236:239], v[244:247]
    v_exp_f32 v161, v161
    v_exp_f32 v162, v162
    v_smfmac_f32_32x32x32_bf16 v[184:199], v[80:83], v[152:159], v7
    v_exp_f32 v163, v163
    v_exp_f32 v164, v164
    s_mov_b32 s46, 262144
    buffer_load_dwordx4 v[200:203], v15, s[32:35], s46 offen offset:0
    v_exp_f32 v165, v165
    v_exp_f32 v166, v166
    s_waitcnt vmcnt(4)
    v_mfma_f32_16x16x32_bf16 v[248:251], v[224:227], v[236:239], v[248:251]
    v_exp_f32 v167, v167
    s_setprio 1
    v_exp_f32 v136, v136
    v_exp_f32 v137, v137
    v_exp_f32 v138, v138
    v_smfmac_f32_32x32x32_bf16 v[184:199], v[84:87], v[160:167], v7
    v_exp_f32 v139, v139
    s_add_u32 s22, s61, 1
    s_and_b32 s22, s22, 15
    s_mul_i32 s22, s22, 44032
    s_add_u32 m0, s7, 3072
    s_nop 0
    buffer_load_dwordx4 v18, s[56:59], s22 offen offset:0 lds
    v_exp_f32 v140, v140
    v_exp_f32 v141, v141
    v_mfma_f32_32x32x16_bf16 v[152:167], v[52:55], v[28:31], 0
    v_exp_f32 v142, v142
    v_exp_f32 v143, v143
    v_exp_f32 v144, v144
    s_waitcnt vmcnt(3)
    v_mfma_f32_16x16x32_bf16 v[252:255], v[228:231], v[236:239], v[252:255]
    v_exp_f32 v145, v145
    v_exp_f32 v146, v146
    v_smfmac_f32_32x32x32_bf16 v[184:199], v[88:91], v[136:143], v7
    v_exp_f32 v147, v147
    v_exp_f32 v148, v148
    s_waitcnt lgkmcnt(0)
    s_mov_b32 s46, 262144
    buffer_load_dwordx4 v[204:207], v15, s[32:35], s46 offen offset:1024
    v_exp_f32 v149, v149
    v_exp_f32 v150, v150
    v_exp_f32 v151, v151
    s_setprio 0
    ds_read_b32 v22, v19
    v_exp_f32 v152, v152
    v_exp_f32 v153, v153
    v_exp_f32 v154, v154
    v_smfmac_f32_32x32x32_bf16 v[184:199], v[92:95], v[144:151], v7
    v_exp_f32 v155, v155
    v_exp_f32 v156, v156
    v_exp_f32 v157, v157
    v_mfma_f32_32x32x16_bf16 v[136:151], v[56:59], v[28:31], 0
    v_exp_f32 v158, v158
    s_cmp_lg_u32 s47, 0
    s_cbranch_scc1 K2_NAF5
    s_waitcnt lgkmcnt(0)
    v_cmp_gt_u32 vcc, 5, v22
    s_cbranch_vccnz K2_RAF5
K2_CAF5:
    ds_read_b128 v[32:35], v12
    ds_read_b128 v[36:39], v12 offset:16
    ds_read_b64 v[216:217], v11 offset:0
    ds_read_b64 v[218:219], v11 offset:2048
    ds_read_b64 v[220:221], v11 offset:4096
    ds_read_b64 v[222:223], v11 offset:6144
    ds_read_b64 v[224:225], v11 offset:8192
    ds_read_b64 v[226:227], v11 offset:10240
    ds_read_b64 v[228:229], v11 offset:12288
    ds_read_b64 v[230:231], v11 offset:14336
K2_NAF5:
    v_exp_f32 v159, v159
    v_exp_f32 v160, v160
    v_mfma_f32_32x32x16_bf16 v[168:183], v[24:27], v[24:27], 0
    v_exp_f32 v161, v161
    v_exp_f32 v162, v162
    v_exp_f32 v163, v163
    v_smfmac_f32_32x32x32_bf16 v[184:199], v[96:99], v[152:159], v7
    v_exp_f32 v164, v164
    s_mov_b32 s46, 262144
    buffer_load_dwordx4 v[208:211], v15, s[32:35], s46 offen offset:2048
    v_exp_f32 v165, v165
    v_exp_f32 v166, v166
    v_exp_f32 v167, v167
    s_setprio 3
    v_exp_f32 v136, v136
    v_exp_f32 v137, v137
    v_exp_f32 v138, v138
    v_smfmac_f32_32x32x32_bf16 v[184:199], v[100:103], v[160:167], v7
    s_cmp_lg_u32 s47, 0
    s_cbranch_scc1 K2_NBF5
    s_waitcnt lgkmcnt(0)
    v_pk_add_f32 v[32:33], v[32:33], v[34:35]
    v_pk_add_f32 v[36:37], v[36:37], v[38:39]
    v_pk_add_f32 v[216:217], v[216:217], v[218:219]
    v_pk_add_f32 v[220:221], v[220:221], v[222:223]
    v_pk_add_f32 v[224:225], v[224:225], v[226:227]
    v_pk_add_f32 v[228:229], v[228:229], v[230:231]
    v_pk_add_f32 v[32:33], v[32:33], v[36:37]
    v_pk_add_f32 v[216:217], v[216:217], v[220:221]
    v_add_f32 v32, v32, v33
    v_pk_add_f32 v[224:225], v[224:225], v[228:229]
    v_rcp_f32 v32, v32
    v_pk_add_f32 v[216:217], v[216:217], v[224:225]
    v_pk_mul_f32 v[216:217], v[216:217], v[32:33] op_sel_hi:[1,0]
    v_cvt_pk_bf16_f32 v216, v216, v217
    ds_write_b32 v13, v216
    ds_write_b32 v21, v23 offset:32
K2_NBF5:
    v_exp_f32 v139, v139
    s_add_u32 s22, s61, 1
    s_and_b32 s22, s22, 15
    s_mul_i32 s22, s22, 44032
    s_add_u32 m0, s7, 4032
    s_nop 0
    buffer_load_dwordx4 v18, s[56:59], s22 offen offset:64 lds
    v_exp_f32 v140, v140
    v_exp_f32 v141, v141
    v_mfma_f32_32x32x16_bf16 v[152:167], v[60:63], v[28:31], 0
    v_exp_f32 v142, v142
    v_exp_f32 v143, v143
    s_mov_b32 s46, 266240
    buffer_load_dwordx4 v[216:219], v15, s[32:35], s46 offen offset:0
    v_exp_f32 v144, v144
    v_exp_f32 v145, v145
    v_exp_f32 v146, v146
    v_smfmac_f32_32x32x32_bf16 v[184:199], v[104:107], v[136:143], v7
    v_exp_f32 v147, v147
    v_exp_f32 v148, v148
    s_mov_b32 s46, 262144
    buffer_load_dwordx4 v[212:215], v15, s[32:35], s46 offen offset:3072
    v_exp_f32 v149, v149
    v_exp_f32 v150, v150
    v_exp_f32 v151, v151
    s_setprio 2
    v_exp_f32 v152, v152
    v_exp_f32 v153, v153
    v_exp_f32 v154, v154
    v_smfmac_f32_32x32x32_bf16 v[184:199], v[108:111], v[144:151], v7
    v_exp_f32 v155, v155
    v_exp_f32 v156, v156
    v_exp_f32 v157, v157
    v_mfma_f32_32x32x16_bf16 v[136:151], v[64:67], v[28:31], 0
    v_exp_f32 v158, v158
    v_exp_f32 v159, v159
    s_mov_b32 s46, 266240
    buffer_load_dwordx4 v[220:223], v15, s[32:35], s46 offen offset:1024
    v_exp_f32 v160, v160
    v_exp_f32 v161, v161
    v_exp_f32 v162, v162
    v_smfmac_f32_32x32x32_bf16 v[184:199], v[112:115], v[152:159], v7
    v_exp_f32 v163, v163
    v_exp_f32 v164, v164
    v_exp_f32 v165, v165
    v_exp_f32 v166, v166
    v_exp_f32 v167, v167
    s_setprio 1
    v_exp_f32 v136, v136
    s_mov_b32 s46, 266240
    buffer_load_dwordx4 v[224:227], v15, s[32:35], s46 offen offset:2048
    ds_read_b32 v22, v20 offset:0
    v_exp_f32 v137, v137
    v_exp_f32 v138, v138
    v_smfmac_f32_32x32x32_bf16 v[184:199], v[116:119], v[160:167], v7
    v_exp_f32 v139, v139
    s_add_u32 s22, s61, 1
    s_and_b32 s22, s22, 15
    s_mul_i32 s22, s22, 44032
    s_add_u32 m0, s7, 4992
    s_nop 0
    buffer_load_dwordx4 v18, s[56:59], s22 offen offset:128 lds
    v_exp_f32 v140, v140
    v_exp_f32 v141, v141
    v_mfma_f32_32x32x16_bf16 v[152:167], v[68:71], v[28:31], 0
    v_exp_f32 v142, v142
    v_exp_f32 v143, v143
    s_waitcnt lgkmcnt(0)
    v_cmp_gt_u32 vcc, 5, v22
    s_cbranch_vccnz K2_RDF5
K2_CDF5:
    ds_read_b128 v[232:235], v14 offset:0
    ds_read_b128 v[236:239], v14 offset:512
    v_exp_f32 v144, v144
    v_exp_f32 v145, v145
    ds_read_b128 v[28:31], v17 offset:6144
    v_exp_f32 v146, v146
    v_smfmac_f32_32x32x32_bf16 v[184:199], v[120:123], v[136:143], v7
    v_exp_f32 v147, v147
    v_exp_f32 v148, v148
    v_exp_f32 v149, v149
    v_exp_f32 v150, v150
    s_waitcnt lgkmcnt(0)
    s_waitcnt vmcnt(7)
    v_mfma_f32_16x16x32_bf16 v[240:243], v[200:203], v[232:235], v[240:243]
    v_exp_f32 v151, v151
    s_setprio 0
    v_exp_f32 v152, v152
    v_exp_f32 v153, v153
    v_exp_f32 v154, v154
    v_smfmac_f32_32x32x32_bf16 v[184:199], v[124:127], v[144:151], v7
    v_exp_f32 v155, v155
    v_exp_f32 v156, v156
    v_exp_f32 v157, v157
    s_waitcnt lgkmcnt(0)
    v_mfma_f32_32x32x16_bf16 v[136:151], v[40:43], v[28:31], 0
    v_exp_f32 v158, v158
    v_exp_f32 v159, v159
    s_mov_b32 s46, 266240
    buffer_load_dwordx4 v[228:231], v15, s[32:35], s46 offen offset:3072
    v_exp_f32 v160, v160
    v_mfma_f32_16x16x32_bf16 v[244:247], v[204:207], v[232:235], v[244:247]
    v_exp_f32 v161, v161
    v_exp_f32 v162, v162
    v_smfmac_f32_32x32x32_bf16 v[184:199], v[128:131], v[152:159], v7
    v_exp_f32 v163, v163
    v_exp_f32 v164, v164
    v_exp_f32 v165, v165
    v_exp_f32 v166, v166
    s_waitcnt vmcnt(4)
    v_mfma_f32_16x16x32_bf16 v[248:251], v[208:211], v[232:235], v[248:251]
    v_exp_f32 v167, v167
    s_setprio 3
    v_exp_f32 v136, v136
    v_exp_f32 v137, v137
    v_exp_f32 v138, v138
    v_smfmac_f32_32x32x32_bf16 v[184:199], v[132:135], v[160:167], v7
    v_exp_f32 v139, v139
    s_add_u32 s22, s61, 2
    s_and_b32 s22, s22, 15
    s_mul_i32 s22, s22, 44032
    s_add_u32 m0, s7, 6144
    s_nop 0
    buffer_load_dwordx4 v18, s[56:59], s22 offen offset:0 lds
    v_exp_f32 v140, v140
    v_exp_f32 v141, v141
    v_mfma_f32_32x32x16_bf16 v[152:167], v[44:47], v[28:31], 0
    v_exp_f32 v142, v142
    v_exp_f32 v143, v143
    v_exp_f32 v144, v144
    v_mfma_f32_16x16x32_bf16 v[252:255], v[212:215], v[232:235], v[252:255]
    v_exp_f32 v145, v145
    v_exp_f32 v146, v146
    v_smfmac_f32_32x32x32_bf16 v[168:183], v[72:75], v[136:143], v7
    v_exp_f32 v147, v147
    v_exp_f32 v148, v148
    v_exp_f32 v149, v149
    v_exp_f32 v150, v150
    s_waitcnt vmcnt(4)
    v_mfma_f32_16x16x32_bf16 v[240:243], v[216:219], v[236:239], v[240:243]
    v_exp_f32 v151, v151
    s_setprio 2
    v_mov_b32 v23, 6
    v_exp_f32 v152, v152
    ds_write_b128 v9, v[184:187]
    v_exp_f32 v153, v153
    v_exp_f32 v154, v154
    v_smfmac_f32_32x32x32_bf16 v[168:183], v[76:79], v[144:151], v7
    ds_write_b128 v9, v[188:191] offset:1024
    v_exp_f32 v155, v155
    v_exp_f32 v156, v156
    ds_write_b32 v10, v192
    v_exp_f32 v157, v157
    v_mfma_f32_32x32x16_bf16 v[136:151], v[48:51], v[28:31], 0
    v_exp_f32 v158, v158
    ds_write_b32 v21, v23
    v_exp_f32 v159, v159
    v_exp_f32 v160, v160
    v_mfma_f32_16x16x32_bf16 v[244:247], v[220:223], v[236:239], v[244:247]
    v_exp_f32 v161, v161
    v_exp_f32 v162, v162
    v_smfmac_f32_32x32x32_bf16 v[168:183], v[80:83], v[152:159], v7
    v_exp_f32 v163, v163
    v_exp_f32 v164, v164
    s_mov_b32 s46, 327680
    buffer_load_dwordx4 v[200:203], v15, s[32:35], s46 offen offset:0
    v_exp_f32 v165, v165
    v_exp_f32 v166, v166
    s_waitcnt vmcnt(4)
    v_mfma_f32_16x16x32_bf16 v[248:251], v[224:227], v[236:239], v[248:251]
    v_exp_f32 v167, v167
    s_setprio 1
    v_exp_f32 v136, v136
    v_exp_f32 v137, v137
    v_exp_f32 v138, v138
    v_smfmac_f32_32x32x32_bf16 v[168:183], v[84:87], v[160:167], v7
    v_exp_f32 v139, v139
    s_add_u32 s22, s61, 2
    s_and_b32 s22, s22, 15
    s_mul_i32 s22, s22, 44032
    s_add_u32 m0, s7, 7104
    s_nop 0
    buffer_load_dwordx4 v18, s[56:59], s22 offen offset:64 lds
    v_exp_f32 v140, v140
    v_exp_f32 v141, v141
    v_mfma_f32_32x32x16_bf16 v[152:167], v[52:55], v[28:31], 0
    v_exp_f32 v142, v142
    v_exp_f32 v143, v143
    v_exp_f32 v144, v144
    s_waitcnt vmcnt(3)
    v_mfma_f32_16x16x32_bf16 v[252:255], v[228:231], v[236:239], v[252:255]
    v_exp_f32 v145, v145
    v_exp_f32 v146, v146
    v_smfmac_f32_32x32x32_bf16 v[168:183], v[88:91], v[136:143], v7
    v_exp_f32 v147, v147
    v_exp_f32 v148, v148
    s_waitcnt lgkmcnt(0)
    s_mov_b32 s46, 327680
    buffer_load_dwordx4 v[204:207], v15, s[32:35], s46 offen offset:1024
    v_exp_f32 v149, v149
    v_exp_f32 v150, v150
    v_exp_f32 v151, v151
    s_setprio 0
    ds_read_b32 v22, v19
    v_exp_f32 v152, v152
    v_exp_f32 v153, v153
    v_exp_f32 v154, v154
    v_smfmac_f32_32x32x32_bf16 v[168:183], v[92:95], v[144:151], v7
    v_exp_f32 v155, v155
    v_exp_f32 v156, v156
    v_exp_f32 v157, v157
    v_mfma_f32_32x32x16_bf16 v[136:151], v[56:59], v[28:31], 0
    v_exp_f32 v158, v158
    s_cmp_lg_u32 s47, 1
    s_cbranch_scc1 K2_NAF6
    s_waitcnt lgkmcnt(0)
    v_cmp_gt_u32 vcc, 6, v22
    s_cbranch_vccnz K2_RAF6
K2_CAF6:
    ds_read_b128 v[32:35], v12
    ds_read_b128 v[36:39], v12 offset:16
    ds_read_b64 v[216:217], v11 offset:0
    ds_read_b64 v[218:219], v11 offset:2048
    ds_read_b64 v[220:221], v11 offset:4096
    ds_read_b64 v[222:223], v11 offset:6144
    ds_read_b64 v[224:225], v11 offset:8192
    ds_read_b64 v[226:227], v11 offset:10240
    ds_read_b64 v[228:229], v11 offset:12288
    ds_read_b64 v[230:231], v11 offset:14336
K2_NAF6:
    v_exp_f32 v159, v159
    v_exp_f32 v160, v160
    v_mfma_f32_32x32x16_bf16 v[184:199], v[24:27], v[24:27], 0
    v_exp_f32 v161, v161
    v_exp_f32 v162, v162
    v_exp_f32 v163, v163
    v_smfmac_f32_32x32x32_bf16 v[168:183], v[96:99], v[152:159], v7
    v_exp_f32 v164, v164
    s_mov_b32 s46, 327680
    buffer_load_dwordx4 v[208:211], v15, s[32:35], s46 offen offset:2048
    v_exp_f32 v165, v165
    v_exp_f32 v166, v166
    v_exp_f32 v167, v167
    s_setprio 3
    v_exp_f32 v136, v136
    v_exp_f32 v137, v137
    v_exp_f32 v138, v138
    v_smfmac_f32_32x32x32_bf16 v[168:183], v[100:103], v[160:167], v7
    s_cmp_lg_u32 s47, 1
    s_cbranch_scc1 K2_NBF6
    s_waitcnt lgkmcnt(0)
    v_pk_add_f32 v[32:33], v[32:33], v[34:35]
    v_pk_add_f32 v[36:37], v[36:37], v[38:39]
    v_pk_add_f32 v[216:217], v[216:217], v[218:219]
    v_pk_add_f32 v[220:221], v[220:221], v[222:223]
    v_pk_add_f32 v[224:225], v[224:225], v[226:227]
    v_pk_add_f32 v[228:229], v[228:229], v[230:231]
    v_pk_add_f32 v[32:33], v[32:33], v[36:37]
    v_pk_add_f32 v[216:217], v[216:217], v[220:221]
    v_add_f32 v32, v32, v33
    v_pk_add_f32 v[224:225], v[224:225], v[228:229]
    v_rcp_f32 v32, v32
    v_pk_add_f32 v[216:217], v[216:217], v[224:225]
    v_pk_mul_f32 v[216:217], v[216:217], v[32:33] op_sel_hi:[1,0]
    v_cvt_pk_bf16_f32 v216, v216, v217
    ds_write_b32 v13, v216
    ds_write_b32 v21, v23 offset:32
K2_NBF6:
    v_exp_f32 v139, v139
    s_add_u32 s22, s61, 2
    s_and_b32 s22, s22, 15
    s_mul_i32 s22, s22, 44032
    s_add_u32 m0, s7, 8064
    s_nop 0
    buffer_load_dwordx4 v18, s[56:59], s22 offen offset:128 lds
    v_exp_f32 v140, v140
    v_exp_f32 v141, v141
    v_mfma_f32_32x32x16_bf16 v[152:167], v[60:63], v[28:31], 0
    v_exp_f32 v142, v142
    v_exp_f32 v143, v143
    s_mov_b32 s46, 331776
    buffer_load_dwordx4 v[216:219], v15, s[32:35], s46 offen offset:0
    v_exp_f32 v144, v144
    v_exp_f32 v145, v145
    v_exp_f32 v146, v146
    v_smfmac_f32_32x32x32_bf16 v[168:183], v[104:107], v[136:143], v7
    v_exp_f32 v147, v147
    v_exp_f32 v148, v148
    s_mov_b32 s46, 327680
    buffer_load_dwordx4 v[212:215], v15, s[32:35], s46 offen offset:3072
    v_exp_f32 v149, v149
    v_exp_f32 v150, v150
    v_exp_f32 v151, v151
    s_setprio 2
    v_exp_f32 v152, v152
    v_exp_f32 v153, v153
    v_exp_f32 v154, v154
    v_smfmac_f32_32x32x32_bf16 v[168:183], v[108:111], v[144:151], v7
    v_exp_f32 v155, v155
    v_exp_f32 v156, v156
    v_exp_f32 v157, v157
    v_mfma_f32_32x32x16_bf16 v[136:151], v[64:67], v[28:31], 0
    v_exp_f32 v158, v158
    v_exp_f32 v159, v159
    s_mov_b32 s46, 331776
    buffer_load_dwordx4 v[220:223], v15, s[32:35], s46 offen offset:1024
    v_exp_f32 v160, v160
    v_exp_f32 v161, v161
    v_exp_f32 v162, v162
    v_smfmac_f32_32x32x32_bf16 v[168:183], v[112:115], v[152:159], v7
    v_exp_f32 v163, v163
    v_exp_f32 v164, v164
    v_exp_f32 v165, v165
    v_exp_f32 v166, v166
    v_exp_f32 v167, v167
    s_setprio 1
    v_exp_f32 v136, v136
    s_mov_b32 s46, 331776
    buffer_load_dwordx4 v[224:227], v15, s[32:35], s46 offen offset:2048
    ds_read_b32 v22, v20 offset:16
    v_exp_f32 v137, v137
    v_exp_f32 v138, v138
    v_smfmac_f32_32x32x32_bf16 v[168:183], v[116:119], v[160:167], v7
    v_exp_f32 v139, v139
    s_add_u32 s22, s61, 3
    s_and_b32 s22, s22, 15
    s_mul_i32 s22, s22, 44032
    s_add_u32 m0, s7, 9216
    s_nop 0
    buffer_load_dwordx4 v18, s[56:59], s22 offen offset:0 lds
    v_exp_f32 v140, v140
    v_exp_f32 v141, v141
    v_mfma_f32_32x32x16_bf16 v[152:167], v[68:71], v[28:31], 0
    v_exp_f32 v142, v142
    v_exp_f32 v143, v143
    s_waitcnt lgkmcnt(0)
    v_cmp_gt_u32 vcc, 6, v22
    s_cbranch_vccnz K2_RDF6
K2_CDF6:
    ds_read_b128 v[232:235], v14 offset:0
    ds_read_b128 v[236:239], v14 offset:512
    v_exp_f32 v144, v144
    v_exp_f32 v145, v145
    ds_read_b128 v[28:31], v17 offset:7168
    v_exp_f32 v146, v146
    v_smfmac_f32_32x32x32_bf16 v[168:183], v[120:123], v[136:143], v7
    v_exp_f32 v147, v147
    v_exp_f32 v148, v148
    v_exp_f32 v149, v149
    v_exp_f32 v150, v150
    s_waitcnt lgkmcnt(0)
    s_waitcnt vmcnt(7)
    v_mfma_f32_16x16x32_bf16 v[240:243], v[200:203], v[232:235], v[240:243]
    v_exp_f32 v151, v151
    s_setprio 0
    v_exp_f32 v152, v152
    v_exp_f32 v153, v153
    v_exp_f32 v154, v154
    v_smfmac_f32_32x32x32_bf16 v[168:183], v[124:127], v[144:151], v7
    v_exp_f32 v155, v155
    v_exp_f32 v156, v156
    v_exp_f32 v157, v157
    s_waitcnt lgkmcnt(0)
    v_mfma_f32_32x32x16_bf16 v[136:151], v[40:43], v[28:31], 0
    v_exp_f32 v158, v158
    v_exp_f32 v159, v159
    s_mov_b32 s46, 331776
    buffer_load_dwordx4 v[228:231], v15, s[32:35], s46 offen offset:3072
    v_exp_f32 v160, v160
    v_mfma_f32_16x16x32_bf16 v[244:247], v[204:207], v[232:235], v[244:247]
    v_exp_f32 v161, v161
    v_exp_f32 v162, v162
    v_smfmac_f32_32x32x32_bf16 v[168:183], v[128:131], v[152:159], v7
    v_exp_f32 v163, v163
    v_exp_f32 v164, v164
    v_exp_f32 v165, v165
    v_exp_f32 v166, v166
    s_waitcnt vmcnt(4)
    v_mfma_f32_16x16x32_bf16 v[248:251], v[208:211], v[232:235], v[248:251]
    v_exp_f32 v167, v167
    s_setprio 3
    v_exp_f32 v136, v136
    v_exp_f32 v137, v137
    v_exp_f32 v138, v138
    v_smfmac_f32_32x32x32_bf16 v[168:183], v[132:135], v[160:167], v7
    v_exp_f32 v139, v139
    s_add_u32 s22, s61, 3
    s_and_b32 s22, s22, 15
    s_mul_i32 s22, s22, 44032
    s_add_u32 m0, s7, 10176
    s_nop 0
    buffer_load_dwordx4 v18, s[56:59], s22 offen offset:64 lds
    v_exp_f32 v140, v140
    v_exp_f32 v141, v141
    v_mfma_f32_32x32x16_bf16 v[152:167], v[44:47], v[28:31], 0
    v_exp_f32 v142, v142
    v_exp_f32 v143, v143
    v_exp_f32 v144, v144
    v_mfma_f32_16x16x32_bf16 v[252:255], v[212:215], v[232:235], v[252:255]
    v_exp_f32 v145, v145
    v_exp_f32 v146, v146
    v_smfmac_f32_32x32x32_bf16 v[184:199], v[72:75], v[136:143], v7
    v_exp_f32 v147, v147
    v_exp_f32 v148, v148
    v_exp_f32 v149, v149
    v_exp_f32 v150, v150
    s_waitcnt vmcnt(4)
    v_mfma_f32_16x16x32_bf16 v[240:243], v[216:219], v[236:239], v[240:243]
    v_exp_f32 v151, v151
    s_setprio 2
    v_mov_b32 v23, 7
    v_exp_f32 v152, v152
    ds_write_b128 v9, v[168:171]
    v_exp_f32 v153, v153
    v_exp_f32 v154, v154
    v_smfmac_f32_32x32x32_bf16 v[184:199], v[76:79], v[144:151], v7
    ds_write_b128 v9, v[172:175] offset:1024
    v_exp_f32 v155, v155
    v_exp_f32 v156, v156
    ds_write_b32 v10, v176
    v_exp_f32 v157, v157
    v_mfma_f32_32x32x16_bf16 v[136:151], v[48:51], v[28:31], 0
    v_exp_f32 v158, v158
    ds_write_b32 v21, v23
    v_exp_f32 v159, v159
    v_exp_f32 v160, v160
    v_mfma_f32_16x16x32_bf16 v[244:247], v[220:223], v[236:239], v[244:247]
    v_exp_f32 v161, v161
    v_exp_f32 v162, v162
    v_smfmac_f32_32x32x32_bf16 v[184:199], v[80:83], v[152:159], v7
    v_exp_f32 v163, v163
    v_exp_f32 v164, v164
    s_mov_b32 s46, 393216
    buffer_load_dwordx4 v[200:203], v15, s[32:35], s46 offen offset:0
    v_exp_f32 v165, v165
    v_exp_f32 v166, v166
    s_waitcnt vmcnt(4)
    v_mfma_f32_16x16x32_bf16 v[248:251], v[224:227], v[236:239], v[248:251]
    v_exp_f32 v167, v167
    s_setprio 1
    v_exp_f32 v136, v136
    s_and_b32 s51, s5, 7
    s_lshl_b32 s60, s51, 3
    s_add_u32 s60, s60, s20
    s_mul_i32 s60, s60, 22528
    v_exp_f32 v137, v137
    v_exp_f32 v138, v138
    v_smfmac_f32_32x32x32_bf16 v[184:199], v[84:87], v[160:167], v7
    v_exp_f32 v139, v139
    s_add_u32 s22, s61, 3
    s_and_b32 s22, s22, 15
    s_mul_i32 s22, s22, 44032
    s_add_u32 m0, s7, 11136
    s_nop 0
    buffer_load_dwordx4 v18, s[56:59], s22 offen offset:128 lds
    v_exp_f32 v140, v140
    v_exp_f32 v141, v141
    v_mfma_f32_32x32x16_bf16 v[152:167], v[52:55], v[28:31], 0
    v_exp_f32 v142, v142
    v_exp_f32 v143, v143
    v_exp_f32 v144, v144
    s_waitcnt vmcnt(3)
    v_mfma_f32_16x16x32_bf16 v[252:255], v[228:231], v[236:239], v[252:255]
    v_exp_f32 v145, v145
    v_exp_f32 v146, v146
    v_smfmac_f32_32x32x32_bf16 v[184:199], v[88:91], v[136:143], v7
    v_exp_f32 v147, v147
    v_exp_f32 v148, v148
    s_waitcnt lgkmcnt(0)
    s_mov_b32 s46, 393216
    buffer_load_dwordx4 v[204:207], v15, s[32:35], s46 offen offset:1024
    v_exp_f32 v149, v149
    v_exp_f32 v150, v150
    v_exp_f32 v151, v151
    s_setprio 0
    ds_read_b32 v22, v19
    v_exp_f32 v152, v152
    v_exp_f32 v153, v153
    v_exp_f32 v154, v154
    v_smfmac_f32_32x32x32_bf16 v[184:199], v[92:95], v[144:151], v7
    v_exp_f32 v155, v155
    s_mov_b32 s46, 458752
    buffer_load_dwordx4 v[40:43], v15, s[32:35], s46 offen offset:0
    v_exp_f32 v156, v156
    v_exp_f32 v157, v157
    v_mfma_f32_32x32x16_bf16 v[136:151], v[56:59], v[28:31], 0
    v_exp_f32 v158, v158
    s_cmp_lg_u32 s47, 0
    s_cbranch_scc1 K2_NAF7
    s_waitcnt lgkmcnt(0)
    v_cmp_gt_u32 vcc, 7, v22
    s_cbranch_vccnz K2_RAF7
K2_CAF7:
    ds_read_b128 v[32:35], v12
    ds_read_b128 v[36:39], v12 offset:16
    ds_read_b64 v[216:217], v11 offset:0
    ds_read_b64 v[218:219], v11 offset:2048
    ds_read_b64 v[220:221], v11 offset:4096
    ds_read_b64 v[222:223], v11 offset:6144
    ds_read_b64 v[224:225], v11 offset:8192
    ds_read_b64 v[226:227], v11 offset:10240
    ds_read_b64 v[228:229], v11 offset:12288
    ds_read_b64 v[230:231], v11 offset:14336
K2_NAF7:
    v_exp_f32 v159, v159
    v_exp_f32 v160, v160
    v_mfma_f32_32x32x16_bf16 v[168:183], v[24:27], v[24:27], 0
    v_exp_f32 v161, v161
    v_exp_f32 v162, v162
    v_exp_f32 v163, v163
    v_smfmac_f32_32x32x32_bf16 v[184:199], v[96:99], v[152:159], v7
    v_exp_f32 v164, v164
    s_mov_b32 s46, 393216
    buffer_load_dwordx4 v[208:211], v15, s[32:35], s46 offen offset:2048
    v_exp_f32 v165, v165
    v_exp_f32 v166, v166
    v_exp_f32 v167, v167
    s_setprio 3
    v_exp_f32 v136, v136
    v_exp_f32 v137, v137
    v_exp_f32 v138, v138
    v_smfmac_f32_32x32x32_bf16 v[184:199], v[100:103], v[160:167], v7
    s_cmp_lg_u32 s47, 0
    s_cbranch_scc1 K2_NBF7
    s_waitcnt lgkmcnt(0)
    v_pk_add_f32 v[32:33], v[32:33], v[34:35]
    v_pk_add_f32 v[36:37], v[36:37], v[38:39]
    v_pk_add_f32 v[216:217], v[216:217], v[218:219]
    v_pk_add_f32 v[220:221], v[220:221], v[222:223]
    v_pk_add_f32 v[224:225], v[224:225], v[226:227]
    v_pk_add_f32 v[228:229], v[228:229], v[230:231]
    v_pk_add_f32 v[32:33], v[32:33], v[36:37]
    v_pk_add_f32 v[216:217], v[216:217], v[220:221]
    v_add_f32 v32, v32, v33
    v_pk_add_f32 v[224:225], v[224:225], v[228:229]
    v_rcp_f32 v32, v32
    v_pk_add_f32 v[216:217], v[216:217], v[224:225]
    v_pk_mul_f32 v[216:217], v[216:217], v[32:33] op_sel_hi:[1,0]
    v_cvt_pk_bf16_f32 v216, v216, v217
    ds_write_b32 v13, v216
    ds_write_b32 v21, v23 offset:32
K2_NBF7:
    v_exp_f32 v139, v139
    s_mov_b32 s46, 458752
    buffer_load_dwordx4 v[44:47], v15, s[32:35], s46 offen offset:1024
    v_exp_f32 v140, v140
    v_exp_f32 v141, v141
    v_mfma_f32_32x32x16_bf16 v[152:167], v[60:63], v[28:31], 0
    v_exp_f32 v142, v142
    v_exp_f32 v143, v143
    s_mov_b32 s46, 397312
    buffer_load_dwordx4 v[216:219], v15, s[32:35], s46 offen offset:0
    v_exp_f32 v144, v144
    v_exp_f32 v145, v145
    v_exp_f32 v146, v146
    v_smfmac_f32_32x32x32_bf16 v[184:199], v[104:107], v[136:143], v7
    v_exp_f32 v147, v147
    v_exp_f32 v148, v148
    s_mov_b32 s46, 393216
    buffer_load_dwordx4 v[212:215], v15, s[32:35], s46 offen offset:3072
    v_exp_f32 v149, v149
    v_exp_f32 v150, v150
    v_exp_f32 v151, v151
    s_mov_b32 s46, 462848
    buffer_load_dwordx4 v[56:59], v15, s[32:35], s46 offen offset:0
    s_setprio 2
    v_exp_f32 v152, v152
    v_exp_f32 v153, v153
    v_exp_f32 v154, v154
    v_smfmac_f32_32x32x32_bf16 v[184:199], v[108:111], v[144:151], v7
    v_exp_f32 v155, v155
    s_mov_b32 s46, 458752
    buffer_load_dwordx4 v[48:51], v15, s[32:35], s46 offen offset:2048
    v_exp_f32 v156, v156
    v_exp_f32 v157, v157
    v_mfma_f32_32x32x16_bf16 v[136:151], v[64:67], v[28:31], 0
    v_exp_f32 v158, v158
    v_exp_f32 v159, v159
    s_mov_b32 s46, 397312
    buffer_load_dwordx4 v[220:223], v15, s[32:35], s46 offen offset:1024
    v_exp_f32 v160, v160
    v_exp_f32 v161, v161
    v_exp_f32 v162, v162
    v_smfmac_f32_32x32x32_bf16 v[184:199], v[112:115], v[152:159], v7
    v_exp_f32 v163, v163
    v_exp_f32 v164, v164
    v_exp_f32 v165, v165
    v_exp_f32 v166, v166
    v_exp_f32 v167, v167
    s_mov_b32 s46, 462848
    buffer_load_dwordx4 v[60:63], v15, s[32:35], s46 offen offset:1024
    s_setprio 1
    v_exp_f32 v136, v136
    s_mov_b32 s46, 397312
    buffer_load_dwordx4 v[224:227], v15, s[32:35], s46 offen offset:2048
    ds_read_b32 v22, v20 offset:0
    v_exp_f32 v137, v137
    v_exp_f32 v138, v138
    v_smfmac_f32_32x32x32_bf16 v[184:199], v[116:119], v[160:167], v7
    v_exp_f32 v139, v139
    s_mov_b32 s46, 458752
    buffer_load_dwordx4 v[52:55], v15, s[32:35], s46 offen offset:3072
    v_exp_f32 v140, v140
    v_exp_f32 v141, v141
    v_mfma_f32_32x32x16_bf16 v[152:167], v[68:71], v[28:31], 0
    v_exp_f32 v142, v142
    v_exp_f32 v143, v143
    s_waitcnt lgkmcnt(0)
    v_cmp_gt_u32 vcc, 7, v22
    s_cbranch_vccnz K2_RDF7
K2_CDF7:
    ds_read_b128 v[232:235], v14 offset:0
    ds_read_b128 v[236:239], v14 offset:512
    v_exp_f32 v144, v144
    v_exp_f32 v145, v145
    v_exp_f32 v146, v146
    v_smfmac_f32_32x32x32_bf16 v[184:199], v[120:123], v[136:143], v7
    v_exp_f32 v147, v147
    v_exp_f32 v148, v148
    v_exp_f32 v149, v149
    v_exp_f32 v150, v150
    s_waitcnt lgkmcnt(0)
    s_waitcnt vmcnt(11)
    v_mfma_f32_16x16x32_bf16 v[240:243], v[200:203], v[232:235], v[240:243]
    v_exp_f32 v151, v151
    s_mov_b32 s46, 462848
    buffer_load_dwordx4 v[64:67], v15, s[32:35], s46 offen offset:2048
    s_setprio 0
    v_exp_f32 v152, v152
    v_exp_f32 v153, v153
    v_exp_f32 v154, v154
    v_smfmac_f32_32x32x32_bf16 v[184:199], v[124:127], v[144:151], v7
    v_exp_f32 v155, v155
    v_exp_f32 v156, v156
    v_exp_f32 v157, v157
    v_exp_f32 v158, v158
    v_exp_f32 v159, v159
    s_mov_b32 s46, 397312
    buffer_load_dwordx4 v[228:231], v15, s[32:35], s46 offen offset:3072
    v_exp_f32 v160, v160
    v_mfma_f32_16x16x32_bf16 v[244:247], v[204:207], v[232:235], v[244:247]
    v_exp_f32 v161, v161
    v_exp_f32 v162, v162
    v_smfmac_f32_32x32x32_bf16 v[184:199], v[128:131], v[152:159], v7
    v_exp_f32 v163, v163
    v_exp_f32 v164, v164
    v_exp_f32 v165, v165
    v_exp_f32 v166, v166
    s_waitcnt vmcnt(8)
    v_mfma_f32_16x16x32_bf16 v[248:251], v[208:211], v[232:235], v[248:251]
    v_exp_f32 v167, v167
    s_mov_b32 s46, 462848
    buffer_load_dwordx4 v[68:71], v15, s[32:35], s46 offen offset:3072
    s_nop 1
    v_smfmac_f32_32x32x32_bf16 v[184:199], v[132:135], v[160:167], v7
K2_TAIL:
    s_setprio 0
    s_add_u32 s46, s51, 0
    s_sub_u32 s23, s46, 11
    s_cselect_b32 s46, s46, s23
    s_lshl_b32 s46, s46, 11
    s_add_u32 s46, s46, s60
    buffer_load_dwordx4 v[80:83], v8, s[40:43], s46 offen offset:0
    buffer_load_dwordx4 v[84:87], v8, s[40:43], s46 offen offset:1024
    s_add_u32 s46, s51, 1
    s_sub_u32 s23, s46, 11
    s_cselect_b32 s46, s46, s23
    s_lshl_b32 s46, s46, 11
    s_add_u32 s46, s46, s60
    buffer_load_dwordx4 v[88:91], v8, s[40:43], s46 offen offset:0
    buffer_load_dwordx4 v[92:95], v8, s[40:43], s46 offen offset:1024
    v_mfma_f32_16x16x32_bf16 v[252:255], v[212:215], v[232:235], v[252:255]
    ds_write_b128 v9, v[184:187]
    ds_write_b128 v9, v[188:191] offset:1024
    ds_write_b32 v10, v192
    s_waitcnt vmcnt(5)
    v_mfma_f32_16x16x32_bf16 v[240:243], v[216:219], v[236:239], v[240:243]
    v_mfma_f32_16x16x32_bf16 v[244:247], v[220:223], v[236:239], v[244:247]
    v_mfma_f32_16x16x32_bf16 v[248:251], v[224:227], v[236:239], v[248:251]
    v_mfma_f32_16x16x32_bf16 v[252:255], v[228:231], v[236:239], v[252:255]
    v_and_b32 v1, 7, v0
    v_lshrrev_b32 v2, 4, v0
    v_bfe_u32 v4, v0, 3, 1
    v_lshlrev_b32 v16, 10, v1
    v_lshl_add_u32 v16, v4, 6, v16
    s_lshl_b32 s50, s21, 13
    s_lshl_b32 s23, s20, 7
    s_add_u32 s50, s50, s23
    s_add_u32 s23, s23, 126976
    v_lshl_add_u32 v3, v1, 4, v16
    v_lshl_add_u32 v3, v2, 3, v3
    v_add_u32 v3, s23, v3
    v_bfe_u32 v2, v0, 4, 1
    v_lshl_add_u32 v16, v2, 5, v16
    v_lshrrev_b32 v5, 5, v0
    v_lshl_add_u32 v16, v5, 4, v16
    s_waitcnt lgkmcnt(0)
    s_barrier
    ds_read_b64 v[72:73], v3 offset:0
    ds_read_b64 v[74:75], v3 offset:32
    s_cmp_lg_u32 s47, 1
    s_cbranch_scc1 K2_NT
    ds_read_b128 v[32:35], v12
    ds_read_b128 v[36:39], v12 offset:16
    ds_read_b64 v[216:217], v11 offset:0
    ds_read_b64 v[218:219], v11 offset:2048
    ds_read_b64 v[220:221], v11 offset:4096
    ds_read_b64 v[222:223], v11 offset:6144
    ds_read_b64 v[224:225], v11 offset:8192
    ds_read_b64 v[226:227], v11 offset:10240
    ds_read_b64 v[228:229], v11 offset:12288
    ds_read_b64 v[230:231], v11 offset:14336
    s_waitcnt lgkmcnt(0)
    v_pk_add_f32 v[32:33], v[32:33], v[34:35]
    v_pk_add_f32 v[36:37], v[36:37], v[38:39]
    v_pk_add_f32 v[216:217], v[216:217], v[218:219]
    v_pk_add_f32 v[220:221], v[220:221], v[222:223]
    v_pk_add_f32 v[224:225], v[224:225], v[226:227]
    v_pk_add_f32 v[228:229], v[228:229], v[230:231]
    v_pk_add_f32 v[32:33], v[32:33], v[36:37]
    v_pk_add_f32 v[216:217], v[216:217], v[220:221]
    v_add_f32 v32, v32, v33
    v_pk_add_f32 v[224:225], v[224:225], v[228:229]
    v_rcp_f32 v32, v32
    v_pk_add_f32 v[216:217], v[216:217], v[224:225]
    v_pk_mul_f32 v[216:217], v[216:217], v[32:33] op_sel_hi:[1,0]
    v_cvt_pk_bf16_f32 v216, v216, v217
    ds_write_b32 v13, v216
K2_NT:
    s_add_u32 s46, s51, 2
    s_sub_u32 s23, s46, 11
    s_cselect_b32 s46, s46, s23
    s_lshl_b32 s46, s46, 11
    s_add_u32 s46, s46, s60
    buffer_load_dwordx4 v[96:99], v8, s[40:43], s46 offen offset:0
    buffer_load_dwordx4 v[100:103], v8, s[40:43], s46 offen offset:1024
    s_add_u32 s46, s51, 3
    s_sub_u32 s23, s46, 11
    s_cselect_b32 s46, s46, s23
    s_lshl_b32 s46, s46, 11
    s_add_u32 s46, s46, s60
    buffer_load_dwordx4 v[104:107], v8, s[40:43], s46 offen offset:0
    buffer_load_dwordx4 v[108:111], v8, s[40:43], s46 offen offset:1024
    s_add_u32 s24, s16, 0x300000
    s_addc_u32 s25, s17, 0
    s_mov_b32 s26, 0x200000
    s_mov_b32 s27, 0x20000
    s_mov_b32 s48, 0xff00ff00
    s_mov_b32 s49, 0xff00ff00
    s_waitcnt lgkmcnt(0)
    v_lshlrev_b32 v176, 16, v72
    v_and_b32 v177, 0xffff0000, v72
    v_lshlrev_b32 v178, 16, v73
    v_and_b32 v179, 0xffff0000, v73
    v_lshlrev_b32 v180, 16, v74
    v_and_b32 v181, 0xffff0000, v74
    v_lshlrev_b32 v182, 16, v75
    v_and_b32 v183, 0xffff0000, v75
    s_barrier
    ds_read_b128 v[232:235], v14 offset:0
    ds_read_b128 v[236:239], v14 offset:512
    s_waitcnt vmcnt(8) lgkmcnt(1)
    v_mfma_f32_16x16x32_bf16 v[240:243], v[40:43], v[232:235], v[240:243]
    v_mfma_f32_16x16x32_bf16 v[244:247], v[44:47], v[232:235], v[244:247]
    v_mfma_f32_16x16x32_bf16 v[248:251], v[48:51], v[232:235], v[248:251]
    v_mfma_f32_16x16x32_bf16 v[252:255], v[52:55], v[232:235], v[252:255]
    s_waitcnt lgkmcnt(0)
    v_mfma_f32_16x16x32_bf16 v[240:243], v[56:59], v[236:239], v[240:243]
    v_mfma_f32_16x16x32_bf16 v[248:251], v[64:67], v[236:239], v[248:251]
    v_mfma_f32_16x16x32_bf16 v[244:247], v[60:63], v[236:239], v[244:247]
    v_mfma_f32_16x16x32_bf16 v[252:255], v[68:71], v[236:239], v[252:255]
    s_add_u32 s46, s51, 4
    s_sub_u32 s23, s46, 11
    s_cselect_b32 s46, s46, s23
    s_lshl_b32 s46, s46, 11
    s_add_u32 s46, s46, s60
    buffer_load_dwordx4 v[112:115], v8, s[40:43], s46 offen offset:0
    buffer_load_dwordx4 v[116:119], v8, s[40:43], s46 offen offset:1024
    s_add_u32 s46, s51, 5
    s_sub_u32 s23, s46, 11
    s_cselect_b32 s46, s46, s23
    s_lshl_b32 s46, s46, 11
    s_add_u32 s46, s46, s60
    buffer_load_dwordx4 v[120:123], v8, s[40:43], s46 offen offset:0
    buffer_load_dwordx4 v[124:127], v8, s[40:43], s46 offen offset:1024
    v_cndmask_b32 v168, v240, v248, s[48:49]
    v_cndmask_b32 v169, v241, v249, s[48:49]
    v_cndmask_b32 v170, v242, v250, s[48:49]
    v_cndmask_b32 v171, v243, v251, s[48:49]
    v_cndmask_b32 v172, v244, v252, s[48:49]
    v_cndmask_b32 v173, v245, v253, s[48:49]
    v_cndmask_b32 v174, v246, v254, s[48:49]
    v_cndmask_b32 v175, v247, v255, s[48:49]
    v_pk_add_f32 v[168:169], v[168:169], v[176:177]
    v_pk_add_f32 v[170:171], v[170:171], v[178:179]
    v_pk_add_f32 v[172:173], v[172:173], v[180:181]
    v_pk_add_f32 v[174:175], v[174:175], v[182:183]
    v_pk_mul_f32 v[220:221], v[168:169], v[168:169]
    v_pk_add_f32 v[216:217], v[168:169], v[170:171]
    v_pk_mul_f32 v[222:223], v[170:171], v[170:171]
    v_pk_add_f32 v[218:219], v[172:173], v[174:175]
    v_pk_fma_f32 v[220:221], v[172:173], v[172:173], v[220:221]
    v_pk_fma_f32 v[222:223], v[174:175], v[174:175], v[222:223]
    v_pk_add_f32 v[216:217], v[216:217], v[218:219]
    v_pk_add_f32 v[220:221], v[220:221], v[222:223]
    v_add_f32 v216, v216, v217
    v_add_f32 v217, v220, v221
    v_mov_b32 v218, v216
    v_mov_b32 v219, v217
    v_cvt_pk_bf16_f32 v184, v168, v169
    v_permlane32_swap_b32 v216, v218
    v_permlane32_swap_b32 v217, v219
    v_pk_add_f32 v[216:217], v[216:217], v[218:219]
    v_mov_b32 v218, v216
    v_mov_b32 v219, v217
    v_cvt_pk_bf16_f32 v185, v170, v171
    v_permlane16_swap_b32 v216, v218
    v_permlane16_swap_b32 v217, v219
    v_pk_add_f32 v[216:217], v[216:217], v[218:219]
    v_cvt_pk_bf16_f32 v186, v172, v173
    v_cvt_pk_bf16_f32 v187, v174, v175
    v_add_f32_dpp v216, v216, v216 row_ror:8 row_mask:0xf bank_mask:0xf
    v_add_f32_dpp v217, v217, v217 row_ror:8 row_mask:0xf bank_mask:0xf
    s_lshl_b32 s23, s20, 3
    s_add_u32 s23, s23, 125056
    v_lshlrev_b32 v6, 6, v1
    v_add_u32 v5, s23, v6
    v_add_u32 v6, 125056, v6
    ds_write_b64 v5, v[216:217]
    s_add_u32 s46, s51, 6
    s_sub_u32 s23, s46, 11
    s_cselect_b32 s46, s46, s23
    s_lshl_b32 s46, s46, 11
    s_add_u32 s46, s46, s60
    buffer_load_dwordx4 v[128:131], v8, s[40:43], s46 offen offset:0
    buffer_load_dwordx4 v[132:135], v8, s[40:43], s46 offen offset:1024
    s_add_u32 s46, s51, 7
    s_sub_u32 s23, s46, 11
    s_cselect_b32 s46, s46, s23
    s_lshl_b32 s46, s46, 11
    s_add_u32 s46, s46, s60
    buffer_load_dwordx4 v[136:139], v8, s[40:43], s46 offen offset:0
    buffer_load_dwordx4 v[140:143], v8, s[40:43], s46 offen offset:1024
    s_waitcnt lgkmcnt(0)
    s_barrier
    ds_read_b128 v[200:203], v6 offset:0
    ds_read_b128 v[204:207], v6 offset:16
    ds_read_b128 v[208:211], v6 offset:32
    ds_read_b128 v[212:215], v6 offset:48
    v_permlane16_swap_b32 v184, v186
    v_permlane16_swap_b32 v185, v187
    buffer_store_dwordx4 v[184:187], v16, s[24:27], s50 offen sc1
    s_lshr_b32 s22, s21, 2
    s_lshl_b32 s22, s22, 15
    s_lshl_b32 s23, s20, 12
    s_add_u32 s22, s22, s23
    s_and_b32 s23, s21, 3
    s_lshl_b32 s23, s23, 7
    s_add_u32 s22, s22, s23
    v_lshlrev_b32 v5, 4, v1
    v_lshl_add_u32 v5, v4, 11, v5
    v_lshrrev_b32 v1, 5, v0
    v_lshl_add_u32 v5, v1, 9, v5
    v_lshl_add_u32 v5, v2, 10, v5
    s_waitcnt lgkmcnt(0)
    v_pk_add_f32 v[218:219], v[200:201], v[202:203]
    v_pk_add_f32 v[220:221], v[204:205], v[206:207]
    v_pk_add_f32 v[222:223], v[208:209], v[210:211]
    v_pk_add_f32 v[224:225], v[212:213], v[214:215]
    v_pk_add_f32 v[218:219], v[218:219], v[220:221]
    v_pk_add_f32 v[222:223], v[222:223], v[224:225]
    v_pk_add_f32 v[218:219], v[218:219], v[222:223]
    v_mul_f32 v218, 0x3b000000, v218
    v_mul_f32 v219, 0x3b000000, v219
    v_fma_f32 v219, -v218, v218, v219
    v_max_f32 v219, 0, v219
    v_add_f32 v222, 0x3727c5ac, v219
    v_rsq_f32 v222, v222
    v_pk_add_f32 v[168:169], v[168:169], v[218:219] op_sel_hi:[1,0] neg_lo:[0,1] neg_hi:[0,1]
    v_pk_add_f32 v[170:171], v[170:171], v[218:219] op_sel_hi:[1,0] neg_lo:[0,1] neg_hi:[0,1]
    v_pk_add_f32 v[172:173], v[172:173], v[218:219] op_sel_hi:[1,0] neg_lo:[0,1] neg_hi:[0,1]
    v_pk_add_f32 v[174:175], v[174:175], v[218:219] op_sel_hi:[1,0] neg_lo:[0,1] neg_hi:[0,1]
    v_pk_mul_f32 v[168:169], v[168:169], v[222:223] op_sel_hi:[1,0]
    v_pk_mul_f32 v[170:171], v[170:171], v[222:223] op_sel_hi:[1,0]
    v_pk_mul_f32 v[172:173], v[172:173], v[222:223] op_sel_hi:[1,0]
    v_pk_mul_f32 v[174:175], v[174:175], v[222:223] op_sel_hi:[1,0]
    v_cvt_pk_bf16_f32 v188, v168, v169
    v_cvt_pk_bf16_f32 v189, v170, v171
    v_cvt_pk_bf16_f32 v190, v172, v173
    v_cvt_pk_bf16_f32 v191, v174, v175
    s_nop 1
    v_permlane16_swap_b32 v188, v190
    v_permlane16_swap_b32 v189, v191
    buffer_store_dwordx4 v[188:191], v5, s[52:55], s22 offen sc1
    s_add_u32 s28, s16, 0x230000
    s_addc_u32 s29, s17, 0
    s_mov_b32 s30, 0x2000
    s_mov_b32 s31, 0x20000
    s_add_u32 s32, s16, 0x700000
    s_addc_u32 s33, s17, 0
    s_mov_b32 s34, 0x560000
    s_mov_b32 s35, 0x20000
    s_waitcnt vmcnt(0)
    s_barrier
    s_cmp_lg_u32 s20, 0
    s_cbranch_scc1 K2_NOSIG0
    s_lshl_b32 s22, s4, 8
    s_lshl_b32 s23, s5, 2
    s_add_u32 s23, s23, s22
    v_mov_b32 v1, 0
    v_mov_b32 v2, 1
    s_mov_b64 exec, 1
    s_add_u32 s22, s23, 4096
    buffer_store_dword v2, v1, s[28:31], s22 offen offset:0
    buffer_store_dword v2, v1, s[28:31], s23 offen offset:0 sc1
    s_mov_b64 exec, -1
K2_NOSIG0:
    s_cmp_eq_u32 s5, 15
    s_cbranch_scc1 K2_SKIP1
    v_lshrrev_b32 v3, 5, v0
    v_lshlrev_b32 v3, 3, v3
    v_add_u32 v3, 147456, v3
    s_cmp_eq_u32 s47, 0
    s_cselect_b32 s44, -1, 0
    s_and_b32 s46, s44, 0xffff0000
    ds_read_b64 v[40:41], v3 offset:0
    ds_read_b64 v[42:43], v3 offset:16
    ds_read_b64 v[44:45], v3 offset:32
    ds_read_b64 v[46:47], v3 offset:48
    ds_read_b64 v[48:49], v3 offset:64
    ds_read_b64 v[50:51], v3 offset:80
    ds_read_b64 v[52:53], v3 offset:96
    ds_read_b64 v[54:55], v3 offset:112
    ds_read_b64 v[56:57], v3 offset:128
    ds_read_b64 v[58:59], v3 offset:144
    ds_read_b64 v[60:61], v3 offset:160
    ds_read_b64 v[62:63], v3 offset:176
    s_waitcnt lgkmcnt(0)
    v_and_b32 v169, s46, v40
    v_and_b32 v40, s44, v40
    v_lshlrev_b32 v168, 16, v40
    v_and_b32 v171, s46, v41
    v_and_b32 v41, s44, v41
    v_lshlrev_b32 v170, 16, v41
    v_and_b32 v173, s46, v42
    v_and_b32 v42, s44, v42
    v_lshlrev_b32 v172, 16, v42
    v_and_b32 v175, s46, v43
    v_and_b32 v43, s44, v43
    v_lshlrev_b32 v174, 16, v43
    v_and_b32 v177, s46, v44
    v_and_b32 v44, s44, v44
    v_lshlrev_b32 v176, 16, v44
    v_and_b32 v179, s46, v45
    v_and_b32 v45, s44, v45
    v_lshlrev_b32 v178, 16, v45
    v_and_b32 v181, s46, v46
    v_and_b32 v46, s44, v46
    v_lshlrev_b32 v180, 16, v46
    v_and_b32 v183, s46, v47
    v_and_b32 v47, s44, v47
    v_lshlrev_b32 v182, 16, v47
    v_and_b32 v185, s46, v48
    v_and_b32 v48, s44, v48
    v_lshlrev_b32 v184, 16, v48
    v_and_b32 v187, s46, v49
    v_and_b32 v49, s44, v49
    v_lshlrev_b32 v186, 16, v49
    v_and_b32 v189, s46, v50
    v_and_b32 v50, s44, v50
    v_lshlrev_b32 v188, 16, v50
    v_and_b32 v191, s46, v51
    v_and_b32 v51, s44, v51
    v_lshlrev_b32 v190, 16, v51
    v_and_b32 v193, s46, v52
    v_and_b32 v52, s44, v52
    v_lshlrev_b32 v192, 16, v52
    v_and_b32 v195, s46, v53
    v_and_b32 v53, s44, v53
    v_lshlrev_b32 v194, 16, v53
    v_and_b32 v197, s46, v54
    v_and_b32 v54, s44, v54
    v_lshlrev_b32 v196, 16, v54
    v_and_b32 v199, s46, v55
    v_and_b32 v55, s44, v55
    v_lshlrev_b32 v198, 16, v55
    v_and_b32 v241, s46, v56
    v_and_b32 v56, s44, v56
    v_lshlrev_b32 v240, 16, v56
    v_and_b32 v243, s46, v57
    v_and_b32 v57, s44, v57
    v_lshlrev_b32 v242, 16, v57
    v_and_b32 v245, s46, v58
    v_and_b32 v58, s44, v58
    v_lshlrev_b32 v244, 16, v58
    v_and_b32 v247, s46, v59
    v_and_b32 v59, s44, v59
    v_lshlrev_b32 v246, 16, v59
    v_and_b32 v249, s46, v60
    v_and_b32 v60, s44, v60
    v_lshlrev_b32 v248, 16, v60
    v_and_b32 v251, s46, v61
    v_and_b32 v61, s44, v61
    v_lshlrev_b32 v250, 16, v61
    v_and_b32 v253, s46, v62
    v_and_b32 v62, s44, v62
    v_lshlrev_b32 v252, 16, v62
    v_and_b32 v255, s46, v63
    v_and_b32 v63, s44, v63
    v_lshlrev_b32 v254, 16, v63
    s_and_b32 s50, s20, 3
    s_lshl_b32 s22, s4, 2
    s_add_u32 s50, s50, s22
    v_lshrrev_b32 v3, 5, v0
    v_lshlrev_b32 v3, 9, v3
    v_bfe_u32 v4, v0, 2, 2
    v_lshl_add_u32 v3, v4, 6, v3
    v_bfe_u32 v4, v0, 4, 1
    v_lshl_add_u32 v3, v4, 5, v3
    v_and_b32 v4, 3, v0
    v_lshl_add_u32 v3, v4, 3, v3
    s_mul_i32 s22, s47, 49152
    v_add_u32 v9, s22, v3
    s_mul_i32 s22, s20, 6144
    s_add_u32 s22, s22, 98304
    v_add_u32 v10, s22, v8
    s_xor_b32 s22, s20, 4
    s_mul_i32 s22, s22, 6144
    s_add_u32 s22, s22, 98304
    v_add_u32 v11, s22, v8
    s_lshl_b32 s45, s50, 15
    s_lshl_b32 s22, s47, 14
    s_add_u32 s45, s45, s22
    ds_read_b64_tr_b16 v[72:73], v9 offset:0
    ds_read_b64_tr_b16 v[74:75], v9 offset:256
    ds_read_b64_tr_b16 v[76:77], v9 offset:1024
    ds_read_b64_tr_b16 v[78:79], v9 offset:1280
    ds_read_b64_tr_b16 v[232:233], v9 offset:2048
    ds_read_b64_tr_b16 v[234:235], v9 offset:2304
    ds_read_b64_tr_b16 v[236:237], v9 offset:3072
    ds_read_b64_tr_b16 v[238:239], v9 offset:3328
    ds_read_b64_tr_b16 v[32:33], v9 offset:4096
    ds_read_b64_tr_b16 v[34:35], v9 offset:4352
    s_cmp_lg_u32 s20, 0
    s_cbranch_scc1 K2_NOPOLL0
    s_lshl_b32 s22, s4, 8
    s_add_u32 s46, s22, 4096
    v_and_b32 v1, 15, v0
    v_lshlrev_b32 v1, 2, v1
    s_mov_b32 s44, 0x400000
    s_mov_b32 s48, 0
K2_POLL0:
    s_sub_u32 s44, s44, 1
    s_cbranch_scc1 K2_NOPOLL0
    s_and_b32 s23, s44, 7
    s_cselect_b32 s23, s46, s22
    buffer_load_dword v2, v1, s[28:31], s23 offen offset:0 sc1
    s_waitcnt vmcnt(0)
    v_cmp_ne_u32 vcc, 0, v2
    s_or_b32 s48, s48, vcc_lo
    s_and_b32 s23, s48, 0xffff
    s_cmp_lg_u32 s23, 0xffff
    s_cbranch_scc1 K2_POLL0
K2_NOPOLL0:
    s_barrier
    s_add_u32 s46, s5, 0
    s_and_b32 s46, s46, 15
    s_lshl_b32 s46, s46, 10
    s_add_u32 s46, s46, s45
    buffer_load_dwordx4 v[40:43], v8, s[52:55], s46 offen sc1
    s_add_u32 s46, s5, 1
    s_and_b32 s46, s46, 15
    s_lshl_b32 s46, s46, 10
    s_add_u32 s46, s46, s45
    buffer_load_dwordx4 v[44:47], v8, s[52:55], s46 offen sc1
    s_add_u32 s46, s5, 2
    s_and_b32 s46, s46, 15
    s_lshl_b32 s46, s46, 10
    s_add_u32 s46, s46, s45
    buffer_load_dwordx4 v[48:51], v8, s[52:55], s46 offen sc1
    s_add_u32 s46, s5, 3
    s_and_b32 s46, s46, 15
    s_lshl_b32 s46, s46, 10
    s_add_u32 s46, s46, s45
    buffer_load_dwordx4 v[52:55], v8, s[52:55], s46 offen sc1
    s_add_u32 s46, s5, 4
    s_and_b32 s46, s46, 15
    s_lshl_b32 s46, s46, 10
    s_add_u32 s46, s46, s45
    buffer_load_dwordx4 v[56:59], v8, s[52:55], s46 offen sc1
    s_add_u32 s46, s5, 5
    s_and_b32 s46, s46, 15
    s_lshl_b32 s46, s46, 10
    s_add_u32 s46, s46, s45
    buffer_load_dwordx4 v[60:63], v8, s[52:55], s46 offen sc1
    s_add_u32 s46, s5, 6
    s_and_b32 s46, s46, 15
    s_lshl_b32 s46, s46, 10
    s_add_u32 s46, s46, s45
    buffer_load_dwordx4 v[64:67], v8, s[52:55], s46 offen sc1
    s_add_u32 s46, s5, 7
    s_and_b32 s46, s46, 15
    s_lshl_b32 s46, s46, 10
    s_add_u32 s46, s46, s45
    buffer_load_dwordx4 v[68:71], v8, s[52:55], s46 offen sc1
    s_add_u32 s46, s5, 8
    s_and_b32 s46, s46, 15
    s_lshl_b32 s46, s46, 10
    s_add_u32 s46, s46, s45
    buffer_load_dwordx4 v[200:203], v8, s[52:55], s46 offen sc1
    s_add_u32 s46, s5, 9
    s_and_b32 s46, s46, 15
    s_lshl_b32 s46, s46, 10
    s_add_u32 s46, s46, s45
    buffer_load_dwordx4 v[204:207], v8, s[52:55], s46 offen sc1
    s_add_u32 s46, s5, 10
    s_and_b32 s46, s46, 15
    s_lshl_b32 s46, s46, 10
    s_add_u32 s46, s46, s45
    buffer_load_dwordx4 v[208:211], v8, s[52:55], s46 offen sc1
    s_add_u32 s46, s5, 11
    s_and_b32 s46, s46, 15
    s_lshl_b32 s46, s46, 10
    s_add_u32 s46, s46, s45
    buffer_load_dwordx4 v[212:215], v8, s[52:55], s46 offen sc1
    s_add_u32 s46, s5, 12
    s_and_b32 s46, s46, 15
    s_lshl_b32 s46, s46, 10
    s_add_u32 s46, s46, s45
    buffer_load_dwordx4 v[216:219], v8, s[52:55], s46 offen sc1
    s_add_u32 s46, s5, 13
    s_and_b32 s46, s46, 15
    s_lshl_b32 s46, s46, 10
    s_add_u32 s46, s46, s45
    buffer_load_dwordx4 v[220:223], v8, s[52:55], s46 offen sc1
    s_add_u32 s46, s5, 14
    s_and_b32 s46, s46, 15
    s_lshl_b32 s46, s46, 10
    s_add_u32 s46, s46, s45
    buffer_load_dwordx4 v[224:227], v8, s[52:55], s46 offen sc1
    s_add_u32 s46, s5, 15
    s_and_b32 s46, s46, 15
    s_lshl_b32 s46, s46, 10
    s_add_u32 s46, s46, s45
    buffer_load_dwordx4 v[228:231], v8, s[52:55], s46 offen sc1
    s_waitcnt vmcnt(15) lgkmcnt(8)
    v_mfma_f32_32x32x16_bf16 v[168:183], v[72:75], v[40:43], v[168:183]
    ds_read_b64_tr_b16 v[36:37], v9 offset:5120
    ds_read_b64_tr_b16 v[38:39], v9 offset:5376
    s_waitcnt lgkmcnt(8)
    v_mfma_f32_32x32x16_bf16 v[184:199], v[76:79], v[40:43], v[184:199]
    ds_read_b64_tr_b16 v[28:29], v9 offset:6144
    ds_read_b64_tr_b16 v[30:31], v9 offset:6400
    s_waitcnt lgkmcnt(8)
    v_mfma_f32_32x32x16_bf16 v[240:255], v[232:235], v[40:43], v[240:255]
    ds_read_b64_tr_b16 v[24:25], v9 offset:7168
    ds_read_b64_tr_b16 v[26:27], v9 offset:7424
    s_waitcnt vmcnt(14) lgkmcnt(8)
    v_mfma_f32_32x32x16_bf16 v[168:183], v[236:239], v[44:47], v[168:183]
    ds_read_b64_tr_b16 v[72:73], v9 offset:8192
    ds_read_b64_tr_b16 v[74:75], v9 offset:8448
    s_waitcnt lgkmcnt(8)
    v_mfma_f32_32x32x16_bf16 v[184:199], v[32:35], v[44:47], v[184:199]
    ds_read_b64_tr_b16 v[76:77], v9 offset:9216
    ds_read_b64_tr_b16 v[78:79], v9 offset:9472
    s_waitcnt lgkmcnt(8)
    v_mfma_f32_32x32x16_bf16 v[240:255], v[36:39], v[44:47], v[240:255]
    ds_read_b64_tr_b16 v[232:233], v9 offset:10240
    ds_read_b64_tr_b16 v[234:235], v9 offset:10496
    s_waitcnt vmcnt(13) lgkmcnt(8)
    v_mfma_f32_32x32x16_bf16 v[168:183], v[28:31], v[48:51], v[168:183]
    ds_read_b64_tr_b16 v[236:237], v9 offset:11264
    ds_read_b64_tr_b16 v[238:239], v9 offset:11520
    s_waitcnt lgkmcnt(8)
    v_mfma_f32_32x32x16_bf16 v[184:199], v[24:27], v[48:51], v[184:199]
    ds_read_b64_tr_b16 v[32:33], v9 offset:12288
    ds_read_b64_tr_b16 v[34:35], v9 offset:12544
    s_waitcnt lgkmcnt(8)
    v_mfma_f32_32x32x16_bf16 v[240:255], v[72:75], v[48:51], v[240:255]
    ds_read_b64_tr_b16 v[36:37], v9 offset:13312
    ds_read_b64_tr_b16 v[38:39], v9 offset:13568
    s_waitcnt vmcnt(12) lgkmcnt(8)
    v_mfma_f32_32x32x16_bf16 v[168:183], v[76:79], v[52:55], v[168:183]
    ds_read_b64_tr_b16 v[28:29], v9 offset:14336
    ds_read_b64_tr_b16 v[30:31], v9 offset:14592
    s_waitcnt lgkmcnt(8)
    v_mfma_f32_32x32x16_bf16 v[184:199], v[232:235], v[52:55], v[184:199]
    ds_read_b64_tr_b16 v[24:25], v9 offset:15360
    ds_read_b64_tr_b16 v[26:27], v9 offset:15616
    s_waitcnt lgkmcnt(8)
    v_mfma_f32_32x32x16_bf16 v[240:255], v[236:239], v[52:55], v[240:255]
    ds_read_b64_tr_b16 v[72:73], v9 offset:16384
    ds_read_b64_tr_b16 v[74:75], v9 offset:16640
    s_waitcnt vmcnt(11) lgkmcnt(8)
    v_mfma_f32_32x32x16_bf16 v[168:183], v[32:35], v[56:59], v[168:183]
    ds_read_b64_tr_b16 v[76:77], v9 offset:17408
    ds_read_b64_tr_b16 v[78:79], v9 offset:17664
    s_waitcnt lgkmcnt(8)
    v_mfma_f32_32x32x16_bf16 v[184:199], v[36:39], v[56:59], v[184:199]
    ds_read_b64_tr_b16 v[232:233], v9 offset:18432
    ds_read_b64_tr_b16 v[234:235], v9 offset:18688
    s_waitcnt lgkmcnt(8)
    v_mfma_f32_32x32x16_bf16 v[240:255], v[28:31], v[56:59], v[240:255]
    ds_read_b64_tr_b16 v[236:237], v9 offset:19456
    ds_read_b64_tr_b16 v[238:239], v9 offset:19712
    s_waitcnt vmcnt(10) lgkmcnt(8)
    v_mfma_f32_32x32x16_bf16 v[168:183], v[24:27], v[60:63], v[168:183]
    ds_read_b64_tr_b16 v[32:33], v9 offset:20480
    ds_read_b64_tr_b16 v[34:35], v9 offset:20736
    s_waitcnt lgkmcnt(8)
    v_mfma_f32_32x32x16_bf16 v[184:199], v[72:75], v[60:63], v[184:199]
    ds_read_b64_tr_b16 v[36:37], v9 offset:21504
    ds_read_b64_tr_b16 v[38:39], v9 offset:21760
    s_waitcnt lgkmcnt(8)
    v_mfma_f32_32x32x16_bf16 v[240:255], v[76:79], v[60:63], v[240:255]
    ds_read_b64_tr_b16 v[28:29], v9 offset:22528
    ds_read_b64_tr_b16 v[30:31], v9 offset:22784
    s_waitcnt vmcnt(9) lgkmcnt(8)
    v_mfma_f32_32x32x16_bf16 v[168:183], v[232:235], v[64:67], v[168:183]
    ds_read_b64_tr_b16 v[24:25], v9 offset:23552
    ds_read_b64_tr_b16 v[26:27], v9 offset:23808
    s_waitcnt lgkmcnt(8)
    v_mfma_f32_32x32x16_bf16 v[184:199], v[236:239], v[64:67], v[184:199]
    ds_read_b64_tr_b16 v[72:73], v9 offset:24576
    ds_read_b64_tr_b16 v[74:75], v9 offset:24832
    s_waitcnt lgkmcnt(8)
    v_mfma_f32_32x32x16_bf16 v[240:255], v[32:35], v[64:67], v[240:255]
    ds_read_b64_tr_b16 v[76:77], v9 offset:25600
    ds_read_b64_tr_b16 v[78:79], v9 offset:25856
    s_waitcnt vmcnt(8) lgkmcnt(8)
    v_mfma_f32_32x32x16_bf16 v[168:183], v[36:39], v[68:71], v[168:183]
    ds_read_b64_tr_b16 v[232:233], v9 offset:26624
    ds_read_b64_tr_b16 v[234:235], v9 offset:26880
    s_waitcnt lgkmcnt(8)
    v_mfma_f32_32x32x16_bf16 v[184:199], v[28:31], v[68:71], v[184:199]
    ds_read_b64_tr_b16 v[236:237], v9 offset:27648
    ds_read_b64_tr_b16 v[238:239], v9 offset:27904
    s_waitcnt lgkmcnt(8)
    v_mfma_f32_32x32x16_bf16 v[240:255], v[24:27], v[68:71], v[240:255]
    ds_read_b64_tr_b16 v[32:33], v9 offset:28672
    ds_read_b64_tr_b16 v[34:35], v9 offset:28928
    s_waitcnt vmcnt(7) lgkmcnt(8)
    v_mfma_f32_32x32x16_bf16 v[168:183], v[72:75], v[200:203], v[168:183]
    ds_read_b64_tr_b16 v[36:37], v9 offset:29696
    ds_read_b64_tr_b16 v[38:39], v9 offset:29952
    s_waitcnt lgkmcnt(8)
    v_mfma_f32_32x32x16_bf16 v[184:199], v[76:79], v[200:203], v[184:199]
    ds_read_b64_tr_b16 v[28:29], v9 offset:30720
    ds_read_b64_tr_b16 v[30:31], v9 offset:30976
    s_waitcnt lgkmcnt(8)
    v_mfma_f32_32x32x16_bf16 v[240:255], v[232:235], v[200:203], v[240:255]
    ds_read_b64_tr_b16 v[24:25], v9 offset:31744
    ds_read_b64_tr_b16 v[26:27], v9 offset:32000
    s_waitcnt vmcnt(6) lgkmcnt(8)
    v_mfma_f32_32x32x16_bf16 v[168:183], v[236:239], v[204:207], v[168:183]
    ds_read_b64_tr_b16 v[72:73], v9 offset:32768
    ds_read_b64_tr_b16 v[74:75], v9 offset:33024
    s_waitcnt lgkmcnt(8)
    v_mfma_f32_32x32x16_bf16 v[184:199], v[32:35], v[204:207], v[184:199]
    ds_read_b64_tr_b16 v[76:77], v9 offset:33792
    ds_read_b64_tr_b16 v[78:79], v9 offset:34048
    s_waitcnt lgkmcnt(8)
    v_mfma_f32_32x32x16_bf16 v[240:255], v[36:39], v[204:207], v[240:255]
    ds_read_b64_tr_b16 v[232:233], v9 offset:34816
    ds_read_b64_tr_b16 v[234:235], v9 offset:35072
    s_waitcnt vmcnt(5) lgkmcnt(8)
    v_mfma_f32_32x32x16_bf16 v[168:183], v[28:31], v[208:211], v[168:183]
    ds_read_b64_tr_b16 v[236:237], v9 offset:35840
    ds_read_b64_tr_b16 v[238:239], v9 offset:36096
    s_waitcnt lgkmcnt(8)
    v_mfma_f32_32x32x16_bf16 v[184:199], v[24:27], v[208:211], v[184:199]
    ds_read_b64_tr_b16 v[32:33], v9 offset:36864
    ds_read_b64_tr_b16 v[34:35], v9 offset:37120
    s_waitcnt lgkmcnt(8)
    v_mfma_f32_32x32x16_bf16 v[240:255], v[72:75], v[208:211], v[240:255]
    ds_read_b64_tr_b16 v[36:37], v9 offset:37888
    ds_read_b64_tr_b16 v[38:39], v9 offset:38144
    s_add_u32 s46, s51, 8
    s_sub_u32 s23, s46, 11
    s_cselect_b32 s46, s46, s23
    s_lshl_b32 s46, s46, 11
    s_add_u32 s46, s46, s60
    buffer_load_dwordx4 v[144:147], v8, s[40:43], s46 offen offset:0
    buffer_load_dwordx4 v[148:151], v8, s[40:43], s46 offen offset:1024
    s_waitcnt vmcnt(6) lgkmcnt(8)
    v_mfma_f32_32x32x16_bf16 v[168:183], v[76:79], v[212:215], v[168:183]
    ds_read_b64_tr_b16 v[28:29], v9 offset:38912
    ds_read_b64_tr_b16 v[30:31], v9 offset:39168
    s_waitcnt lgkmcnt(8)
    v_mfma_f32_32x32x16_bf16 v[184:199], v[232:235], v[212:215], v[184:199]
    ds_read_b64_tr_b16 v[24:25], v9 offset:39936
    ds_read_b64_tr_b16 v[26:27], v9 offset:40192
    s_waitcnt lgkmcnt(8)
    v_mfma_f32_32x32x16_bf16 v[240:255], v[236:239], v[212:215], v[240:255]
    ds_read_b64_tr_b16 v[72:73], v9 offset:40960
    ds_read_b64_tr_b16 v[74:75], v9 offset:41216
    s_add_u32 s46, s51, 9
    s_sub_u32 s23, s46, 11
    s_cselect_b32 s46, s46, s23
    s_lshl_b32 s46, s46, 11
    s_add_u32 s46, s46, s60
    buffer_load_dwordx4 v[152:155], v8, s[40:43], s46 offen offset:0
    buffer_load_dwordx4 v[156:159], v8, s[40:43], s46 offen offset:1024
    s_waitcnt vmcnt(7) lgkmcnt(8)
    v_mfma_f32_32x32x16_bf16 v[168:183], v[32:35], v[216:219], v[168:183]
    ds_read_b64_tr_b16 v[76:77], v9 offset:41984
    ds_read_b64_tr_b16 v[78:79], v9 offset:42240
    s_waitcnt lgkmcnt(8)
    v_mfma_f32_32x32x16_bf16 v[184:199], v[36:39], v[216:219], v[184:199]
    ds_read_b64_tr_b16 v[232:233], v9 offset:43008
    ds_read_b64_tr_b16 v[234:235], v9 offset:43264
    s_waitcnt lgkmcnt(8)
    v_mfma_f32_32x32x16_bf16 v[240:255], v[28:31], v[216:219], v[240:255]
    ds_read_b64_tr_b16 v[236:237], v9 offset:44032
    ds_read_b64_tr_b16 v[238:239], v9 offset:44288
    s_add_u32 s46, s51, 10
    s_sub_u32 s23, s46, 11
    s_cselect_b32 s46, s46, s23
    s_lshl_b32 s46, s46, 11
    s_add_u32 s46, s46, s60
    buffer_load_dwordx4 v[160:163], v8, s[40:43], s46 offen offset:0
    buffer_load_dwordx4 v[164:167], v8, s[40:43], s46 offen offset:1024
    s_waitcnt vmcnt(8) lgkmcnt(8)
    v_mfma_f32_32x32x16_bf16 v[168:183], v[24:27], v[220:223], v[168:183]
    ds_read_b64_tr_b16 v[32:33], v9 offset:45056
    ds_read_b64_tr_b16 v[34:35], v9 offset:45312
    s_waitcnt lgkmcnt(8)
    v_mfma_f32_32x32x16_bf16 v[184:199], v[72:75], v[220:223], v[184:199]
    ds_read_b64_tr_b16 v[36:37], v9 offset:46080
    ds_read_b64_tr_b16 v[38:39], v9 offset:46336
    s_waitcnt lgkmcnt(8)
    v_mfma_f32_32x32x16_bf16 v[240:255], v[76:79], v[220:223], v[240:255]
    ds_read_b64_tr_b16 v[28:29], v9 offset:47104
    ds_read_b64_tr_b16 v[30:31], v9 offset:47360
    s_waitcnt vmcnt(7) lgkmcnt(8)
    v_mfma_f32_32x32x16_bf16 v[168:183], v[232:235], v[224:227], v[168:183]
    ds_read_b64_tr_b16 v[24:25], v9 offset:48128
    ds_read_b64_tr_b16 v[26:27], v9 offset:48384
    s_waitcnt lgkmcnt(8)
    v_mfma_f32_32x32x16_bf16 v[184:199], v[236:239], v[224:227], v[184:199]
    s_waitcnt lgkmcnt(6)
    v_mfma_f32_32x32x16_bf16 v[240:255], v[32:35], v[224:227], v[240:255]
    s_waitcnt vmcnt(6) lgkmcnt(4)
    v_mfma_f32_32x32x16_bf16 v[168:183], v[36:39], v[228:231], v[168:183]
    s_waitcnt lgkmcnt(2)
    v_mfma_f32_32x32x16_bf16 v[184:199], v[28:31], v[228:231], v[184:199]
    s_waitcnt lgkmcnt(0)
    v_mfma_f32_32x32x16_bf16 v[240:255], v[24:27], v[228:231], v[240:255]
K2_NW3:
    s_mul_i32 s22, s50, 86
    s_lshl_b32 s23, s6, 1
    s_add_u32 s22, s22, s23
    s_mul_i32 s23, s47, 3
    s_add_u32 s22, s22, s23
    s_lshl_b32 s22, s22, 10
    s_cmp_eq_u32 s5, 14
    s_cselect_b32 s23, 0x1000000, s22
    s_nop 5
    s_cmp_eq_u32 s47, 1
    s_cbranch_scc1 K2_EX1
    ds_write_b128 v10, v[192:195] offset:0
    ds_write_b128 v10, v[196:199] offset:1024
    ds_write_b128 v10, v[240:243] offset:2048
    ds_write_b128 v10, v[244:247] offset:3072
    ds_write_b128 v10, v[248:251] offset:4096
    ds_write_b128 v10, v[252:255] offset:5120
    s_waitcnt lgkmcnt(0)
    s_barrier
    ds_read_b128 v[40:43], v11 offset:0
    ds_read_b128 v[44:47], v11 offset:1024
    ds_read_b128 v[48:51], v11 offset:2048
    ds_read_b128 v[52:55], v11 offset:3072
    ds_read_b128 v[56:59], v11 offset:4096
    ds_read_b128 v[60:63], v11 offset:5120
    s_waitcnt lgkmcnt(4)
    v_pk_add_f32 v[168:169], v[168:169], v[40:41]
    v_pk_add_f32 v[170:171], v[170:171], v[42:43]
    v_pk_add_f32 v[172:173], v[172:173], v[44:45]
    v_pk_add_f32 v[174:175], v[174:175], v[46:47]
    v_max_f32 v168, 0, v168
    v_max_f32 v169, 0, v169
    v_max_f32 v170, 0, v170
    v_max_f32 v171, 0, v171
    v_max_f32 v172, 0, v172
    v_max_f32 v173, 0, v173
    v_max_f32 v174, 0, v174
    v_max_f32 v175, 0, v175
    v_pk_mul_f32 v[168:169], v[168:169], v[168:169]
    v_pk_mul_f32 v[170:171], v[170:171], v[170:171]
    v_pk_mul_f32 v[172:173], v[172:173], v[172:173]
    v_pk_mul_f32 v[174:175], v[174:175], v[174:175]
    v_cvt_pk_bf16_f32 v200, v168, v169
    v_cvt_pk_bf16_f32 v201, v170, v171
    v_cvt_pk_bf16_f32 v202, v172, v173
    v_cvt_pk_bf16_f32 v203, v174, v175
    buffer_store_dwordx4 v[200:203], v8, s[32:35], s23 offen offset:0 sc1
    s_waitcnt lgkmcnt(2)
    v_pk_add_f32 v[176:177], v[176:177], v[48:49]
    v_pk_add_f32 v[178:179], v[178:179], v[50:51]
    v_pk_add_f32 v[180:181], v[180:181], v[52:53]
    v_pk_add_f32 v[182:183], v[182:183], v[54:55]
    v_max_f32 v176, 0, v176
    v_max_f32 v177, 0, v177
    v_max_f32 v178, 0, v178
    v_max_f32 v179, 0, v179
    v_max_f32 v180, 0, v180
    v_max_f32 v181, 0, v181
    v_max_f32 v182, 0, v182
    v_max_f32 v183, 0, v183
    v_pk_mul_f32 v[176:177], v[176:177], v[176:177]
    v_pk_mul_f32 v[178:179], v[178:179], v[178:179]
    v_pk_mul_f32 v[180:181], v[180:181], v[180:181]
    v_pk_mul_f32 v[182:183], v[182:183], v[182:183]
    v_cvt_pk_bf16_f32 v204, v176, v177
    v_cvt_pk_bf16_f32 v205, v178, v179
    v_cvt_pk_bf16_f32 v206, v180, v181
    v_cvt_pk_bf16_f32 v207, v182, v183
    buffer_store_dwordx4 v[204:207], v8, s[32:35], s23 offen offset:1024 sc1
    s_waitcnt lgkmcnt(0)
    v_pk_add_f32 v[184:185], v[184:185], v[56:57]
    v_pk_add_f32 v[186:187], v[186:187], v[58:59]
    v_pk_add_f32 v[188:189], v[188:189], v[60:61]
    v_pk_add_f32 v[190:191], v[190:191], v[62:63]
    v_max_f32 v184, 0, v184
    v_max_f32 v185, 0, v185
    v_max_f32 v186, 0, v186
    v_max_f32 v187, 0, v187
    v_max_f32 v188, 0, v188
    v_max_f32 v189, 0, v189
    v_max_f32 v190, 0, v190
    v_max_f32 v191, 0, v191
    v_pk_mul_f32 v[184:185], v[184:185], v[184:185]
    v_pk_mul_f32 v[186:187], v[186:187], v[186:187]
    v_pk_mul_f32 v[188:189], v[188:189], v[188:189]
    v_pk_mul_f32 v[190:191], v[190:191], v[190:191]
    v_cvt_pk_bf16_f32 v208, v184, v185
    v_cvt_pk_bf16_f32 v209, v186, v187
    v_cvt_pk_bf16_f32 v210, v188, v189
    v_cvt_pk_bf16_f32 v211, v190, v191
    buffer_store_dwordx4 v[208:211], v8, s[32:35], s23 offen offset:2048 sc1
    s_branch K2_EXJ
K2_EX1:
    ds_write_b128 v10, v[168:171] offset:0
    ds_write_b128 v10, v[172:175] offset:1024
    ds_write_b128 v10, v[176:179] offset:2048
    ds_write_b128 v10, v[180:183] offset:3072
    ds_write_b128 v10, v[184:187] offset:4096
    ds_write_b128 v10, v[188:191] offset:5120
    s_waitcnt lgkmcnt(0)
    s_barrier
    ds_read_b128 v[40:43], v11 offset:0
    ds_read_b128 v[44:47], v11 offset:1024
    ds_read_b128 v[48:51], v11 offset:2048
    ds_read_b128 v[52:55], v11 offset:3072
    ds_read_b128 v[56:59], v11 offset:4096
    ds_read_b128 v[60:63], v11 offset:5120
    s_waitcnt lgkmcnt(4)
    v_pk_add_f32 v[192:193], v[192:193], v[40:41]
    v_pk_add_f32 v[194:195], v[194:195], v[42:43]
    v_pk_add_f32 v[196:197], v[196:197], v[44:45]
    v_pk_add_f32 v[198:199], v[198:199], v[46:47]
    v_max_f32 v192, 0, v192
    v_max_f32 v193, 0, v193
    v_max_f32 v194, 0, v194
    v_max_f32 v195, 0, v195
    v_max_f32 v196, 0, v196
    v_max_f32 v197, 0, v197
    v_max_f32 v198, 0, v198
    v_max_f32 v199, 0, v199
    v_pk_mul_f32 v[192:193], v[192:193], v[192:193]
    v_pk_mul_f32 v[194:195], v[194:195], v[194:195]
    v_pk_mul_f32 v[196:197], v[196:197], v[196:197]
    v_pk_mul_f32 v[198:199], v[198:199], v[198:199]
    v_cvt_pk_bf16_f32 v200, v192, v193
    v_cvt_pk_bf16_f32 v201, v194, v195
    v_cvt_pk_bf16_f32 v202, v196, v197
    v_cvt_pk_bf16_f32 v203, v198, v199
    buffer_store_dwordx4 v[200:203], v8, s[32:35], s23 offen offset:0 sc1
    s_waitcnt lgkmcnt(2)
    v_pk_add_f32 v[240:241], v[240:241], v[48:49]
    v_pk_add_f32 v[242:243], v[242:243], v[50:51]
    v_pk_add_f32 v[244:245], v[244:245], v[52:53]
    v_pk_add_f32 v[246:247], v[246:247], v[54:55]
    v_max_f32 v240, 0, v240
    v_max_f32 v241, 0, v241
    v_max_f32 v242, 0, v242
    v_max_f32 v243, 0, v243
    v_max_f32 v244, 0, v244
    v_max_f32 v245, 0, v245
    v_max_f32 v246, 0, v246
    v_max_f32 v247, 0, v247
    v_pk_mul_f32 v[240:241], v[240:241], v[240:241]
    v_pk_mul_f32 v[242:243], v[242:243], v[242:243]
    v_pk_mul_f32 v[244:245], v[244:245], v[244:245]
    v_pk_mul_f32 v[246:247], v[246:247], v[246:247]
    v_cvt_pk_bf16_f32 v204, v240, v241
    v_cvt_pk_bf16_f32 v205, v242, v243
    v_cvt_pk_bf16_f32 v206, v244, v245
    v_cvt_pk_bf16_f32 v207, v246, v247
    buffer_store_dwordx4 v[204:207], v8, s[32:35], s22 offen offset:1024 sc1
    s_waitcnt lgkmcnt(0)
    v_pk_add_f32 v[248:249], v[248:249], v[56:57]
    v_pk_add_f32 v[250:251], v[250:251], v[58:59]
    v_pk_add_f32 v[252:253], v[252:253], v[60:61]
    v_pk_add_f32 v[254:255], v[254:255], v[62:63]
    v_max_f32 v248, 0, v248
    v_max_f32 v249, 0, v249
    v_max_f32 v250, 0, v250
    v_max_f32 v251, 0, v251
    v_max_f32 v252, 0, v252
    v_max_f32 v253, 0, v253
    v_max_f32 v254, 0, v254
    v_max_f32 v255, 0, v255
    v_pk_mul_f32 v[248:249], v[248:249], v[248:249]
    v_pk_mul_f32 v[250:251], v[250:251], v[250:251]
    v_pk_mul_f32 v[252:253], v[252:253], v[252:253]
    v_pk_mul_f32 v[254:255], v[254:255], v[254:255]
    v_cvt_pk_bf16_f32 v208, v248, v249
    v_cvt_pk_bf16_f32 v209, v250, v251
    v_cvt_pk_bf16_f32 v210, v252, v253
    v_cvt_pk_bf16_f32 v211, v254, v255
    buffer_store_dwordx4 v[208:211], v8, s[32:35], s22 offen offset:2048 sc1
K2_EXJ:
    s_waitcnt vmcnt(0)
    s_barrier
    s_cmp_lg_u32 s20, 0
    s_cbranch_scc1 K2_NOSIG128
    s_lshl_b32 s22, s4, 8
    s_lshl_b32 s23, s5, 2
    s_add_u32 s23, s23, s22
    v_mov_b32 v1, 0
    v_mov_b32 v2, 1
    s_mov_b64 exec, 1
    s_add_u32 s22, s23, 4096
    buffer_store_dword v2, v1, s[28:31], s22 offen offset:128
    buffer_store_dword v2, v1, s[28:31], s23 offen offset:128 sc1
    s_mov_b64 exec, -1
K2_NOSIG128:
    s_branch K2_FFN2
K2_SKIP1:
    s_add_u32 s46, s51, 8
    s_sub_u32 s23, s46, 11
    s_cselect_b32 s46, s46, s23
    s_lshl_b32 s46, s46, 11
    s_add_u32 s46, s46, s60
    buffer_load_dwordx4 v[144:147], v8, s[40:43], s46 offen offset:0
    buffer_load_dwordx4 v[148:151], v8, s[40:43], s46 offen offset:1024
    s_add_u32 s46, s51, 9
    s_sub_u32 s23, s46, 11
    s_cselect_b32 s46, s46, s23
    s_lshl_b32 s46, s46, 11
    s_add_u32 s46, s46, s60
    buffer_load_dwordx4 v[152:155], v8, s[40:43], s46 offen offset:0
    buffer_load_dwordx4 v[156:159], v8, s[40:43], s46 offen offset:1024
    s_add_u32 s46, s51, 10
    s_sub_u32 s23, s46, 11
    s_cselect_b32 s46, s46, s23
    s_lshl_b32 s46, s46, 11
    s_add_u32 s46, s46, s60
    buffer_load_dwordx4 v[160:163], v8, s[40:43], s46 offen offset:0
    buffer_load_dwordx4 v[164:167], v8, s[40:43], s46 offen offset:1024
K2_FFN2:
    s_mov_b32 s36, s18
    s_mov_b32 s37, s19
    s_mov_b32 s38, 0x400
    s_mov_b32 s39, 0x20000
    s_mov_b32 s52, s10
    s_mov_b32 s53, s11
    s_mov_b32 s54, 0x200000
    s_mov_b32 s55, 0x20000
    s_lshl_b32 s22, s4, 1
    s_lshr_b32 s23, s5, 3
    s_add_u32 s22, s22, s23
    s_lshl_b32 s50, s22, 16
    s_mul_i32 s45, s22, 176128
    s_add_u32 s61, s45, 88064
    s_lshl_b32 s23, s20, 10
    s_add_u32 s45, s45, s23
    v_add_u32 v9, 88064, v8
    v_and_b32 v3, 31, v0
    v_mul_u32_u24 v3, 272, v3
    v_lshrrev_b32 v4, 5, v0
    v_lshl_add_u32 v3, v4, 4, v3
    s_mul_i32 s22, s20, 17408
    v_add_u32 v11, s22, v3
    v_lshrrev_b32 v3, 3, v0
    s_lshl_b32 s22, s20, 3
    v_add_u32 v3, s22, v3
    v_and_b32 v4, 7, v0
    v_mul_u32_u24 v12, 272, v3
    v_lshl_add_u32 v12, v4, 5, v12
    s_lshl_b32 s22, s51, 7
    v_lshlrev_b32 v13, 4, v4
    v_add_u32 v13, s22, v13
    v_lshl_add_u32 v10, v3, 10, v13
    s_cmp_lg_u32 s20, 0
    s_cbranch_scc1 K2_NOPOLL128
    s_lshl_b32 s22, s4, 8
    s_add_u32 s46, s22, 4096
    v_and_b32 v1, 15, v0
    v_lshlrev_b32 v1, 2, v1
    s_mov_b32 s44, 0x400000
    s_mov_b32 s48, 0
K2_POLL128:
    s_sub_u32 s44, s44, 1
    s_cbranch_scc1 K2_NOPOLL128
    s_and_b32 s23, s44, 7
    s_cselect_b32 s23, s46, s22
    buffer_load_dword v2, v1, s[28:31], s23 offen offset:128 sc1
    s_waitcnt vmcnt(0)
    v_cmp_ne_u32 vcc, 0, v2
    s_or_b32 s48, s48, vcc_lo
    s_and_b32 s23, s48, 0x7fff
    s_cmp_lg_u32 s23, 0x7fff
    s_cbranch_scc1 K2_POLL128
K2_NOPOLL128:
    s_barrier
    s_add_u32 s46, s51, 0
    s_sub_u32 s23, s46, 11
    s_cselect_b32 s46, s46, s23
    s_lshl_b32 s46, s46, 13
    s_add_u32 s46, s46, s45
    s_cmp_ge_u32 s46, s61
    s_cselect_b32 s46, 0x1000000, s46
    buffer_load_dwordx4 v[40:43], v8, s[32:35], s46 offen sc1
    buffer_load_dwordx4 v[44:47], v9, s[32:35], s46 offen sc1
    s_add_u32 s46, s51, 1
    s_sub_u32 s23, s46, 11
    s_cselect_b32 s46, s46, s23
    s_lshl_b32 s46, s46, 13
    s_add_u32 s46, s46, s45
    s_cmp_ge_u32 s46, s61
    s_cselect_b32 s46, 0x1000000, s46
    buffer_load_dwordx4 v[48:51], v8, s[32:35], s46 offen sc1
    buffer_load_dwordx4 v[52:55], v9, s[32:35], s46 offen sc1
    s_add_u32 s46, s51, 2
    s_sub_u32 s23, s46, 11
    s_cselect_b32 s46, s46, s23
    s_lshl_b32 s46, s46, 13
    s_add_u32 s46, s46, s45
    s_cmp_ge_u32 s46, s61
    s_cselect_b32 s46, 0x1000000, s46
    buffer_load_dwordx4 v[56:59], v8, s[32:35], s46 offen sc1
    buffer_load_dwordx4 v[60:63], v9, s[32:35], s46 offen sc1
    s_add_u32 s46, s51, 3
    s_sub_u32 s23, s46, 11
    s_cselect_b32 s46, s46, s23
    s_lshl_b32 s46, s46, 13
    s_add_u32 s46, s46, s45
    s_cmp_ge_u32 s46, s61
    s_cselect_b32 s46, 0x1000000, s46
    buffer_load_dwordx4 v[64:67], v8, s[32:35], s46 offen sc1
    buffer_load_dwordx4 v[68:71], v9, s[32:35], s46 offen sc1
    s_add_u32 s46, s51, 4
    s_sub_u32 s23, s46, 11
    s_cselect_b32 s46, s46, s23
    s_lshl_b32 s46, s46, 13
    s_add_u32 s46, s46, s45
    s_cmp_ge_u32 s46, s61
    s_cselect_b32 s46, 0x1000000, s46
    buffer_load_dwordx4 v[72:75], v8, s[32:35], s46 offen sc1
    buffer_load_dwordx4 v[76:79], v9, s[32:35], s46 offen sc1
    s_add_u32 s46, s51, 5
    s_sub_u32 s23, s46, 11
    s_cselect_b32 s46, s46, s23
    s_lshl_b32 s46, s46, 13
    s_add_u32 s46, s46, s45
    s_cmp_ge_u32 s46, s61
    s_cselect_b32 s46, 0x1000000, s46
    buffer_load_dwordx4 v[200:203], v8, s[32:35], s46 offen sc1
    buffer_load_dwordx4 v[204:207], v9, s[32:35], s46 offen sc1
    s_add_u32 s46, s51, 6
    s_sub_u32 s23, s46, 11
    s_cselect_b32 s46, s46, s23
    s_lshl_b32 s46, s46, 13
    s_add_u32 s46, s46, s45
    s_cmp_ge_u32 s46, s61
    s_cselect_b32 s46, 0x1000000, s46
    buffer_load_dwordx4 v[208:211], v8, s[32:35], s46 offen sc1
    buffer_load_dwordx4 v[212:215], v9, s[32:35], s46 offen sc1
    s_add_u32 s46, s51, 7
    s_sub_u32 s23, s46, 11
    s_cselect_b32 s46, s46, s23
    s_lshl_b32 s46, s46, 13
    s_add_u32 s46, s46, s45
    s_cmp_ge_u32 s46, s61
    s_cselect_b32 s46, 0x1000000, s46
    buffer_load_dwordx4 v[216:219], v8, s[32:35], s46 offen sc1
    buffer_load_dwordx4 v[220:223], v9, s[32:35], s46 offen sc1
    s_add_u32 s46, s51, 8
    s_sub_u32 s23, s46, 11
    s_cselect_b32 s46, s46, s23
    s_lshl_b32 s46, s46, 13
    s_add_u32 s46, s46, s45
    s_cmp_ge_u32 s46, s61
    s_cselect_b32 s46, 0x1000000, s46
    buffer_load_dwordx4 v[224:227], v8, s[32:35], s46 offen sc1
    buffer_load_dwordx4 v[228:231], v9, s[32:35], s46 offen sc1
    s_add_u32 s46, s51, 9
    s_sub_u32 s23, s46, 11
    s_cselect_b32 s46, s46, s23
    s_lshl_b32 s46, s46, 13
    s_add_u32 s46, s46, s45
    s_cmp_ge_u32 s46, s61
    s_cselect_b32 s46, 0x1000000, s46
    buffer_load_dwordx4 v[232:235], v8, s[32:35], s46 offen sc1
    buffer_load_dwordx4 v[236:239], v9, s[32:35], s46 offen sc1
    s_waitcnt vmcnt(18)
    v_mfma_f32_32x32x16_bf16 v[168:183], v[80:83], v[40:43], 0
    v_mfma_f32_32x32x16_bf16 v[184:199], v[80:83], v[44:47], 0
    v_mfma_f32_32x32x16_bf16 v[240:255], v[84:87], v[40:43], 0
    v_mfma_f32_32x32x16_bf16 v[24:39], v[84:87], v[44:47], 0
    s_add_u32 s46, s51, 10
    s_sub_u32 s23, s46, 11
    s_cselect_b32 s46, s46, s23
    s_lshl_b32 s46, s46, 13
    s_add_u32 s46, s46, s45
    s_cmp_ge_u32 s46, s61
    s_cselect_b32 s46, 0x1000000, s46
    buffer_load_dwordx4 v[40:43], v8, s[32:35], s46 offen sc1
    buffer_load_dwordx4 v[44:47], v9, s[32:35], s46 offen sc1
    s_waitcnt vmcnt(18)
    v_mfma_f32_32x32x16_bf16 v[168:183], v[88:91], v[48:51], v[168:183]
    v_mfma_f32_32x32x16_bf16 v[184:199], v[88:91], v[52:55], v[184:199]
    v_mfma_f32_32x32x16_bf16 v[240:255], v[92:95], v[48:51], v[240:255]
    v_mfma_f32_32x32x16_bf16 v[24:39], v[92:95], v[52:55], v[24:39]
    s_waitcnt vmcnt(16)
    v_mfma_f32_32x32x16_bf16 v[168:183], v[96:99], v[56:59], v[168:183]
    v_mfma_f32_32x32x16_bf16 v[184:199], v[96:99], v[60:63], v[184:199]
    v_mfma_f32_32x32x16_bf16 v[240:255], v[100:103], v[56:59], v[240:255]
    v_mfma_f32_32x32x16_bf16 v[24:39], v[100:103], v[60:63], v[24:39]
    s_waitcnt vmcnt(14)
    v_mfma_f32_32x32x16_bf16 v[168:183], v[104:107], v[64:67], v[168:183]
    v_mfma_f32_32x32x16_bf16 v[184:199], v[104:107], v[68:71], v[184:199]
    v_mfma_f32_32x32x16_bf16 v[240:255], v[108:111], v[64:67], v[240:255]
    v_mfma_f32_32x32x16_bf16 v[24:39], v[108:111], v[68:71], v[24:39]
    s_waitcnt vmcnt(12)
    v_mfma_f32_32x32x16_bf16 v[168:183], v[112:115], v[72:75], v[168:183]
    v_mfma_f32_32x32x16_bf16 v[184:199], v[112:115], v[76:79], v[184:199]
    v_mfma_f32_32x32x16_bf16 v[240:255], v[116:119], v[72:75], v[240:255]
    v_mfma_f32_32x32x16_bf16 v[24:39], v[116:119], v[76:79], v[24:39]
    s_waitcnt vmcnt(10)
    v_mfma_f32_32x32x16_bf16 v[168:183], v[120:123], v[200:203], v[168:183]
    v_mfma_f32_32x32x16_bf16 v[184:199], v[120:123], v[204:207], v[184:199]
    v_mfma_f32_32x32x16_bf16 v[240:255], v[124:127], v[200:203], v[240:255]
    v_mfma_f32_32x32x16_bf16 v[24:39], v[124:127], v[204:207], v[24:39]
    s_waitcnt vmcnt(8)
    v_mfma_f32_32x32x16_bf16 v[168:183], v[128:131], v[208:211], v[168:183]
    v_mfma_f32_32x32x16_bf16 v[184:199], v[128:131], v[212:215], v[184:199]
    v_mfma_f32_32x32x16_bf16 v[240:255], v[132:135], v[208:211], v[240:255]
    v_mfma_f32_32x32x16_bf16 v[24:39], v[132:135], v[212:215], v[24:39]
    s_waitcnt vmcnt(6)
    v_mfma_f32_32x32x16_bf16 v[168:183], v[136:139], v[216:219], v[168:183]
    v_mfma_f32_32x32x16_bf16 v[184:199], v[136:139], v[220:223], v[184:199]
    v_mfma_f32_32x32x16_bf16 v[240:255], v[140:143], v[216:219], v[240:255]
    v_mfma_f32_32x32x16_bf16 v[24:39], v[140:143], v[220:223], v[24:39]
    s_waitcnt vmcnt(4)
    v_mfma_f32_32x32x16_bf16 v[168:183], v[144:147], v[224:227], v[168:183]
    v_mfma_f32_32x32x16_bf16 v[184:199], v[144:147], v[228:231], v[184:199]
    v_mfma_f32_32x32x16_bf16 v[240:255], v[148:151], v[224:227], v[240:255]
    v_mfma_f32_32x32x16_bf16 v[24:39], v[148:151], v[228:231], v[24:39]
    s_waitcnt vmcnt(2)
    v_mfma_f32_32x32x16_bf16 v[168:183], v[152:155], v[232:235], v[168:183]
    v_mfma_f32_32x32x16_bf16 v[184:199], v[152:155], v[236:239], v[184:199]
    v_mfma_f32_32x32x16_bf16 v[240:255], v[156:159], v[232:235], v[240:255]
    v_mfma_f32_32x32x16_bf16 v[24:39], v[156:159], v[236:239], v[24:39]
    s_waitcnt vmcnt(0)
    v_mfma_f32_32x32x16_bf16 v[168:183], v[160:163], v[40:43], v[168:183]
    v_mfma_f32_32x32x16_bf16 v[184:199], v[160:163], v[44:47], v[184:199]
    v_mfma_f32_32x32x16_bf16 v[240:255], v[164:167], v[40:43], v[240:255]
    v_mfma_f32_32x32x16_bf16 v[24:39], v[164:167], v[44:47], v[24:39]
    buffer_load_dwordx4 v[200:203], v10, s[24:27], s50 offen sc1
    buffer_load_dwordx4 v[204:207], v13, s[36:39], 0 offen
    v_add_u32 v3, 52224, v12
    v_add_u32 v4, 104448, v12
    s_nop 7
    ds_write_b128 v11, v[168:171] offset:0
    ds_write_b128 v11, v[172:175] offset:32
    ds_write_b128 v11, v[176:179] offset:64
    ds_write_b128 v11, v[180:183] offset:96
    ds_write_b128 v11, v[184:187] offset:8704
    ds_write_b128 v11, v[188:191] offset:8736
    ds_write_b128 v11, v[192:195] offset:8768
    ds_write_b128 v11, v[196:199] offset:8800
    ds_write_b128 v11, v[240:243] offset:128
    ds_write_b128 v11, v[244:247] offset:160
    ds_write_b128 v11, v[248:251] offset:192
    ds_write_b128 v11, v[252:255] offset:224
    ds_write_b128 v11, v[24:27] offset:8832
    ds_write_b128 v11, v[28:31] offset:8864
    ds_write_b128 v11, v[32:35] offset:8896
    ds_write_b128 v11, v[36:39] offset:8928
    s_waitcnt vmcnt(0)
    v_lshlrev_b32 v216, 16, v200
    v_and_b32 v217, 0xffff0000, v200
    v_lshlrev_b32 v224, 16, v204
    v_and_b32 v225, 0xffff0000, v204
    v_lshlrev_b32 v218, 16, v201
    v_and_b32 v219, 0xffff0000, v201
    v_lshlrev_b32 v226, 16, v205
    v_and_b32 v227, 0xffff0000, v205
    v_lshlrev_b32 v220, 16, v202
    v_and_b32 v221, 0xffff0000, v202
    v_lshlrev_b32 v228, 16, v206
    v_and_b32 v229, 0xffff0000, v206
    v_lshlrev_b32 v222, 16, v203
    v_and_b32 v223, 0xffff0000, v203
    v_lshlrev_b32 v230, 16, v207
    v_and_b32 v231, 0xffff0000, v207
    v_pk_add_f32 v[216:217], v[216:217], v[224:225]
    v_pk_add_f32 v[218:219], v[218:219], v[226:227]
    v_pk_add_f32 v[220:221], v[220:221], v[228:229]
    v_pk_add_f32 v[222:223], v[222:223], v[230:231]
    s_waitcnt lgkmcnt(0)
    s_barrier
    ds_read_b128 v[80:83], v12 offset:0
    ds_read_b128 v[84:87], v12 offset:16
    ds_read_b128 v[88:91], v12 offset:17408
    ds_read_b128 v[92:95], v12 offset:17424
    ds_read_b128 v[96:99], v12 offset:34816
    ds_read_b128 v[100:103], v12 offset:34832
    ds_read_b128 v[104:107], v3 offset:0
    ds_read_b128 v[108:111], v3 offset:16
    ds_read_b128 v[112:115], v3 offset:17408
    ds_read_b128 v[116:119], v3 offset:17424
    ds_read_b128 v[120:123], v3 offset:34816
    ds_read_b128 v[124:127], v3 offset:34832
    ds_read_b128 v[128:131], v4 offset:0
    ds_read_b128 v[132:135], v4 offset:16
    ds_read_b128 v[136:139], v4 offset:17408
    ds_read_b128 v[140:143], v4 offset:17424
    s_waitcnt lgkmcnt(12)
    v_pk_add_f32 v[80:81], v[80:81], v[88:89]
    v_pk_add_f32 v[82:83], v[82:83], v[90:91]
    v_pk_add_f32 v[84:85], v[84:85], v[92:93]
    v_pk_add_f32 v[86:87], v[86:87], v[94:95]
    v_pk_add_f32 v[216:217], v[216:217], v[80:81]
    v_pk_add_f32 v[218:219], v[218:219], v[82:83]
    v_pk_add_f32 v[220:221], v[220:221], v[84:85]
    v_pk_add_f32 v[222:223], v[222:223], v[86:87]
    s_waitcnt lgkmcnt(8)
    v_pk_add_f32 v[96:97], v[96:97], v[104:105]
    v_pk_add_f32 v[98:99], v[98:99], v[106:107]
    v_pk_add_f32 v[100:101], v[100:101], v[108:109]
    v_pk_add_f32 v[102:103], v[102:103], v[110:111]
    v_pk_add_f32 v[216:217], v[216:217], v[96:97]
    v_pk_add_f32 v[218:219], v[218:219], v[98:99]
    v_pk_add_f32 v[220:221], v[220:221], v[100:101]
    v_pk_add_f32 v[222:223], v[222:223], v[102:103]
    s_waitcnt lgkmcnt(4)
    v_pk_add_f32 v[112:113], v[112:113], v[120:121]
    v_pk_add_f32 v[114:115], v[114:115], v[122:123]
    v_pk_add_f32 v[116:117], v[116:117], v[124:125]
    v_pk_add_f32 v[118:119], v[118:119], v[126:127]
    v_pk_add_f32 v[216:217], v[216:217], v[112:113]
    v_pk_add_f32 v[218:219], v[218:219], v[114:115]
    v_pk_add_f32 v[220:221], v[220:221], v[116:117]
    v_pk_add_f32 v[222:223], v[222:223], v[118:119]
    s_waitcnt lgkmcnt(0)
    v_pk_add_f32 v[128:129], v[128:129], v[136:137]
    v_pk_add_f32 v[130:131], v[130:131], v[138:139]
    v_pk_add_f32 v[132:133], v[132:133], v[140:141]
    v_pk_add_f32 v[134:135], v[134:135], v[142:143]
    v_pk_add_f32 v[216:217], v[216:217], v[128:129]
    v_pk_add_f32 v[218:219], v[218:219], v[130:131]
    v_pk_add_f32 v[220:221], v[220:221], v[132:133]
    v_pk_add_f32 v[222:223], v[222:223], v[134:135]
    v_cvt_pk_bf16_f32 v224, v216, v217
    v_cvt_pk_bf16_f32 v225, v218, v219
    v_cvt_pk_bf16_f32 v226, v220, v221
    v_cvt_pk_bf16_f32 v227, v222, v223
    buffer_store_dwordx4 v[224:227], v10, s[52:55], s50 offen
K2_END:
    s_endpgm
K2_SLOW:
    s_setprio 0
    buffer_load_dwordx4 v[128:131], v16, s[28:31], s51 offen offset:0
    buffer_load_dwordx4 v[132:135], v16, s[28:31], s51 offen offset:528
    s_nop 7
    s_nop 7
    v_mfma_f32_32x32x16_bf16 v[168:183], v[24:27], v[24:27], 0
    v_mfma_f32_32x32x16_bf16 v[184:199], v[24:27], v[24:27], 0
    v_and_b32 v1, 31, v0
    v_lshlrev_b32 v1, 2, v1
    v_add_u32 v1, 125952, v1
    s_lshl_b32 s22, s20, 7
    v_add_u32 v2, s22, v1
    v_mov_b32 v3, 0xff800000
    ds_write_b32 v2, v3
    s_waitcnt vmcnt(0) lgkmcnt(0)
    s_barrier
    v_mov_b32 v2, v1
    v_mov_b32 v4, v17
    s_mov_b32 s22, 0
K2_P1:
    ds_read_b128 v[28:31], v4
    v_mov_b32 v32, 0xff800000
    s_waitcnt lgkmcnt(0)
    v_mfma_f32_32x32x16_bf16 v[136:151], v[40:43], v[28:31], 0
    s_nop 7
    s_nop 3
    v_max3_f32 v32, v32, v136, v137
    v_max3_f32 v32, v32, v138, v139
    v_max3_f32 v32, v32, v140, v141
    v_max3_f32 v32, v32, v142, v143
    v_max3_f32 v32, v32, v144, v145
    v_max3_f32 v32, v32, v146, v147
    v_max3_f32 v32, v32, v148, v149
    v_max3_f32 v32, v32, v150, v151
    s_nop 1
    v_mfma_f32_32x32x16_bf16 v[136:151], v[44:47], v[28:31], 0
    s_nop 7
    s_nop 3
    v_max3_f32 v32, v32, v136, v137
    v_max3_f32 v32, v32, v138, v139
    v_max3_f32 v32, v32, v140, v141
    v_max3_f32 v32, v32, v142, v143
    v_max3_f32 v32, v32, v144, v145
    v_max3_f32 v32, v32, v146, v147
    v_max3_f32 v32, v32, v148, v149
    v_max3_f32 v32, v32, v150, v151
    s_nop 1
    v_mfma_f32_32x32x16_bf16 v[136:151], v[48:51], v[28:31], 0
    s_nop 7
    s_nop 3
    v_max3_f32 v32, v32, v136, v137
    v_max3_f32 v32, v32, v138, v139
    v_max3_f32 v32, v32, v140, v141
    v_max3_f32 v32, v32, v142, v143
    v_max3_f32 v32, v32, v144, v145
    v_max3_f32 v32, v32, v146, v147
    v_max3_f32 v32, v32, v148, v149
    v_max3_f32 v32, v32, v150, v151
    s_nop 1
    v_mfma_f32_32x32x16_bf16 v[136:151], v[52:55], v[28:31], 0
    s_nop 7
    s_nop 3
    v_max3_f32 v32, v32, v136, v137
    v_max3_f32 v32, v32, v138, v139
    v_max3_f32 v32, v32, v140, v141
    v_max3_f32 v32, v32, v142, v143
    v_max3_f32 v32, v32, v144, v145
    v_max3_f32 v32, v32, v146, v147
    v_max3_f32 v32, v32, v148, v149
    v_max3_f32 v32, v32, v150, v151
    s_nop 1
    v_mfma_f32_32x32x16_bf16 v[136:151], v[56:59], v[28:31], 0
    s_nop 7
    s_nop 3
    v_max3_f32 v32, v32, v136, v137
    v_max3_f32 v32, v32, v138, v139
    v_max3_f32 v32, v32, v140, v141
    v_max3_f32 v32, v32, v142, v143
    v_max3_f32 v32, v32, v144, v145
    v_max3_f32 v32, v32, v146, v147
    v_max3_f32 v32, v32, v148, v149
    v_max3_f32 v32, v32, v150, v151
    s_nop 1
    v_mfma_f32_32x32x16_bf16 v[136:151], v[60:63], v[28:31], 0
    s_nop 7
    s_nop 3
    v_max3_f32 v32, v32, v136, v137
    v_max3_f32 v32, v32, v138, v139
    v_max3_f32 v32, v32, v140, v141
    v_max3_f32 v32, v32, v142, v143
    v_max3_f32 v32, v32, v144, v145
    v_max3_f32 v32, v32, v146, v147
    v_max3_f32 v32, v32, v148, v149
    v_max3_f32 v32, v32, v150, v151
    s_nop 1
    v_mfma_f32_32x32x16_bf16 v[136:151], v[64:67], v[28:31], 0
    s_nop 7
    s_nop 3
    v_max3_f32 v32, v32, v136, v137
    v_max3_f32 v32, v32, v138, v139
    v_max3_f32 v32, v32, v140, v141
    v_max3_f32 v32, v32, v142, v143
    v_max3_f32 v32, v32, v144, v145
    v_max3_f32 v32, v32, v146, v147
    v_max3_f32 v32, v32, v148, v149
    v_max3_f32 v32, v32, v150, v151
    s_nop 1
    v_mfma_f32_32x32x16_bf16 v[136:151], v[68:71], v[28:31], 0
    s_nop 7
    s_nop 3
    v_max3_f32 v32, v32, v136, v137
    v_max3_f32 v32, v32, v138, v139
    v_max3_f32 v32, v32, v140, v141
    v_max3_f32 v32, v32, v142, v143
    v_max3_f32 v32, v32, v144, v145
    v_max3_f32 v32, v32, v146, v147
    v_max3_f32 v32, v32, v148, v149
    v_max3_f32 v32, v32, v150, v151
    s_nop 1
    ds_max_f32 v2, v32
    v_add_u32 v2, 128, v2
    v_add_u32 v4, 1024, v4
    s_add_u32 s22, s22, 1
    s_cmp_lt_u32 s22, 8
    s_cbranch_scc1 K2_P1
    ds_read_b128 v[28:31], v17
    s_waitcnt lgkmcnt(0)
    s_barrier
    ds_read_b32 v2, v1
    s_waitcnt lgkmcnt(0)
    v_mfma_f32_32x32x16_bf16 v[136:151], v[40:43], v[28:31], 0
    s_nop 7
    s_nop 3
    s_setprio 3
    v_sub_f32 v136, v136, v2
    v_exp_f32 v136, v136
    v_sub_f32 v137, v137, v2
    v_exp_f32 v137, v137
    v_sub_f32 v138, v138, v2
    v_exp_f32 v138, v138
    v_sub_f32 v139, v139, v2
    v_exp_f32 v139, v139
    v_sub_f32 v140, v140, v2
    v_exp_f32 v140, v140
    v_sub_f32 v141, v141, v2
    v_exp_f32 v141, v141
    v_mfma_f32_32x32x16_bf16 v[152:167], v[44:47], v[28:31], 0
    v_sub_f32 v142, v142, v2
    v_exp_f32 v142, v142
    v_sub_f32 v143, v143, v2
    v_exp_f32 v143, v143
    v_sub_f32 v144, v144, v2
    v_exp_f32 v144, v144
    v_sub_f32 v145, v145, v2
    v_exp_f32 v145, v145
    v_sub_f32 v146, v146, v2
    v_exp_f32 v146, v146
    v_smfmac_f32_32x32x32_bf16 v[168:183], v[72:75], v[136:143], v7
    v_sub_f32 v147, v147, v2
    v_exp_f32 v147, v147
    v_sub_f32 v148, v148, v2
    v_exp_f32 v148, v148
    v_sub_f32 v149, v149, v2
    v_exp_f32 v149, v149
    v_sub_f32 v150, v150, v2
    v_exp_f32 v150, v150
    v_sub_f32 v151, v151, v2
    v_exp_f32 v151, v151
    s_setprio 2
    v_sub_f32 v152, v152, v2
    v_exp_f32 v152, v152
    v_sub_f32 v153, v153, v2
    v_exp_f32 v153, v153
    v_sub_f32 v154, v154, v2
    v_exp_f32 v154, v154
    v_smfmac_f32_32x32x32_bf16 v[168:183], v[76:79], v[144:151], v7
    v_sub_f32 v155, v155, v2
    v_exp_f32 v155, v155
    v_sub_f32 v156, v156, v2
    v_exp_f32 v156, v156
    v_sub_f32 v157, v157, v2
    v_exp_f32 v157, v157
    v_mfma_f32_32x32x16_bf16 v[136:151], v[48:51], v[28:31], 0
    v_sub_f32 v158, v158, v2
    v_exp_f32 v158, v158
    v_sub_f32 v159, v159, v2
    v_exp_f32 v159, v159
    v_sub_f32 v160, v160, v2
    v_exp_f32 v160, v160
    v_sub_f32 v161, v161, v2
    v_exp_f32 v161, v161
    v_sub_f32 v162, v162, v2
    v_exp_f32 v162, v162
    v_smfmac_f32_32x32x32_bf16 v[168:183], v[80:83], v[152:159], v7
    v_sub_f32 v163, v163, v2
    v_exp_f32 v163, v163
    v_sub_f32 v164, v164, v2
    v_exp_f32 v164, v164
    v_sub_f32 v165, v165, v2
    v_exp_f32 v165, v165
    v_sub_f32 v166, v166, v2
    v_exp_f32 v166, v166
    v_sub_f32 v167, v167, v2
    v_exp_f32 v167, v167
    s_setprio 1
    v_sub_f32 v136, v136, v2
    v_exp_f32 v136, v136
    v_sub_f32 v137, v137, v2
    v_exp_f32 v137, v137
    v_sub_f32 v138, v138, v2
    v_exp_f32 v138, v138
    v_smfmac_f32_32x32x32_bf16 v[168:183], v[84:87], v[160:167], v7
    v_sub_f32 v139, v139, v2
    v_exp_f32 v139, v139
    v_sub_f32 v140, v140, v2
    v_exp_f32 v140, v140
    v_sub_f32 v141, v141, v2
    v_exp_f32 v141, v141
    v_mfma_f32_32x32x16_bf16 v[152:167], v[52:55], v[28:31], 0
    v_sub_f32 v142, v142, v2
    v_exp_f32 v142, v142
    v_sub_f32 v143, v143, v2
    v_exp_f32 v143, v143
    v_sub_f32 v144, v144, v2
    v_exp_f32 v144, v144
    v_sub_f32 v145, v145, v2
    v_exp_f32 v145, v145
    v_sub_f32 v146, v146, v2
    v_exp_f32 v146, v146
    v_smfmac_f32_32x32x32_bf16 v[168:183], v[88:91], v[136:143], v7
    v_sub_f32 v147, v147, v2
    v_exp_f32 v147, v147
    v_sub_f32 v148, v148, v2
    v_exp_f32 v148, v148
    v_sub_f32 v149, v149, v2
    v_exp_f32 v149, v149
    v_sub_f32 v150, v150, v2
    v_exp_f32 v150, v150
    v_sub_f32 v151, v151, v2
    v_exp_f32 v151, v151
    s_setprio 0
    v_sub_f32 v152, v152, v2
    v_exp_f32 v152, v152
    v_sub_f32 v153, v153, v2
    v_exp_f32 v153, v153
    v_sub_f32 v154, v154, v2
    v_exp_f32 v154, v154
    v_smfmac_f32_32x32x32_bf16 v[168:183], v[92:95], v[144:151], v7
    v_sub_f32 v155, v155, v2
    v_exp_f32 v155, v155
    v_sub_f32 v156, v156, v2
    v_exp_f32 v156, v156
    v_sub_f32 v157, v157, v2
    v_exp_f32 v157, v157
    v_mfma_f32_32x32x16_bf16 v[136:151], v[56:59], v[28:31], 0
    v_sub_f32 v158, v158, v2
    v_exp_f32 v158, v158
    v_sub_f32 v159, v159, v2
    v_exp_f32 v159, v159
    v_sub_f32 v160, v160, v2
    v_exp_f32 v160, v160
    v_sub_f32 v161, v161, v2
    v_exp_f32 v161, v161
    v_sub_f32 v162, v162, v2
    v_exp_f32 v162, v162
    v_smfmac_f32_32x32x32_bf16 v[168:183], v[96:99], v[152:159], v7
    v_sub_f32 v163, v163, v2
    v_exp_f32 v163, v163
    v_sub_f32 v164, v164, v2
    v_exp_f32 v164, v164
    v_sub_f32 v165, v165, v2
    v_exp_f32 v165, v165
    v_sub_f32 v166, v166, v2
    v_exp_f32 v166, v166
    v_sub_f32 v167, v167, v2
    v_exp_f32 v167, v167
    s_setprio 3
    v_sub_f32 v136, v136, v2
    v_exp_f32 v136, v136
    v_sub_f32 v137, v137, v2
    v_exp_f32 v137, v137
    v_sub_f32 v138, v138, v2
    v_exp_f32 v138, v138
    v_smfmac_f32_32x32x32_bf16 v[168:183], v[100:103], v[160:167], v7
    v_sub_f32 v139, v139, v2
    v_exp_f32 v139, v139
    v_sub_f32 v140, v140, v2
    v_exp_f32 v140, v140
    v_sub_f32 v141, v141, v2
    v_exp_f32 v141, v141
    v_mfma_f32_32x32x16_bf16 v[152:167], v[60:63], v[28:31], 0
    v_sub_f32 v142, v142, v2
    v_exp_f32 v142, v142
    v_sub_f32 v143, v143, v2
    v_exp_f32 v143, v143
    v_sub_f32 v144, v144, v2
    v_exp_f32 v144, v144
    v_sub_f32 v145, v145, v2
    v_exp_f32 v145, v145
    v_sub_f32 v146, v146, v2
    v_exp_f32 v146, v146
    v_smfmac_f32_32x32x32_bf16 v[168:183], v[104:107], v[136:143], v7
    v_sub_f32 v147, v147, v2
    v_exp_f32 v147, v147
    v_sub_f32 v148, v148, v2
    v_exp_f32 v148, v148
    v_sub_f32 v149, v149, v2
    v_exp_f32 v149, v149
    v_sub_f32 v150, v150, v2
    v_exp_f32 v150, v150
    v_sub_f32 v151, v151, v2
    v_exp_f32 v151, v151
    s_setprio 2
    v_sub_f32 v152, v152, v2
    v_exp_f32 v152, v152
    v_sub_f32 v153, v153, v2
    v_exp_f32 v153, v153
    v_sub_f32 v154, v154, v2
    v_exp_f32 v154, v154
    v_smfmac_f32_32x32x32_bf16 v[168:183], v[108:111], v[144:151], v7
    v_sub_f32 v155, v155, v2
    v_exp_f32 v155, v155
    v_sub_f32 v156, v156, v2
    v_exp_f32 v156, v156
    v_sub_f32 v157, v157, v2
    v_exp_f32 v157, v157
    v_mfma_f32_32x32x16_bf16 v[136:151], v[64:67], v[28:31], 0
    v_sub_f32 v158, v158, v2
    v_exp_f32 v158, v158
    v_sub_f32 v159, v159, v2
    v_exp_f32 v159, v159
    v_sub_f32 v160, v160, v2
    v_exp_f32 v160, v160
    v_sub_f32 v161, v161, v2
    v_exp_f32 v161, v161
    v_sub_f32 v162, v162, v2
    v_exp_f32 v162, v162
    v_smfmac_f32_32x32x32_bf16 v[168:183], v[112:115], v[152:159], v7
    v_sub_f32 v163, v163, v2
    v_exp_f32 v163, v163
    v_sub_f32 v164, v164, v2
    v_exp_f32 v164, v164
    v_sub_f32 v165, v165, v2
    v_exp_f32 v165, v165
    v_sub_f32 v166, v166, v2
    v_exp_f32 v166, v166
    v_sub_f32 v167, v167, v2
    v_exp_f32 v167, v167
    s_setprio 1
    v_sub_f32 v136, v136, v2
    v_exp_f32 v136, v136
    v_sub_f32 v137, v137, v2
    v_exp_f32 v137, v137
    v_sub_f32 v138, v138, v2
    v_exp_f32 v138, v138
    v_smfmac_f32_32x32x32_bf16 v[168:183], v[116:119], v[160:167], v7
    v_sub_f32 v139, v139, v2
    v_exp_f32 v139, v139
    v_sub_f32 v140, v140, v2
    v_exp_f32 v140, v140
    v_sub_f32 v141, v141, v2
    v_exp_f32 v141, v141
    v_mfma_f32_32x32x16_bf16 v[152:167], v[68:71], v[28:31], 0
    v_sub_f32 v142, v142, v2
    v_exp_f32 v142, v142
    v_sub_f32 v143, v143, v2
    v_exp_f32 v143, v143
    v_sub_f32 v144, v144, v2
    v_exp_f32 v144, v144
    v_sub_f32 v145, v145, v2
    v_exp_f32 v145, v145
    ds_read_b128 v[28:31], v17 offset:1024
    ds_read_b32 v3, v1 offset:128
    v_sub_f32 v146, v146, v2
    v_exp_f32 v146, v146
    v_smfmac_f32_32x32x32_bf16 v[168:183], v[120:123], v[136:143], v7
    v_sub_f32 v147, v147, v2
    v_exp_f32 v147, v147
    v_sub_f32 v148, v148, v2
    v_exp_f32 v148, v148
    v_sub_f32 v149, v149, v2
    v_exp_f32 v149, v149
    v_sub_f32 v150, v150, v2
    v_exp_f32 v150, v150
    v_sub_f32 v151, v151, v2
    v_exp_f32 v151, v151
    s_setprio 0
    v_sub_f32 v152, v152, v2
    v_exp_f32 v152, v152
    v_sub_f32 v153, v153, v2
    v_exp_f32 v153, v153
    v_sub_f32 v154, v154, v2
    v_exp_f32 v154, v154
    v_smfmac_f32_32x32x32_bf16 v[168:183], v[124:127], v[144:151], v7
    v_sub_f32 v155, v155, v2
    v_exp_f32 v155, v155
    v_sub_f32 v156, v156, v2
    v_exp_f32 v156, v156
    v_sub_f32 v157, v157, v2
    v_exp_f32 v157, v157
    s_waitcnt lgkmcnt(0)
    v_mfma_f32_32x32x16_bf16 v[136:151], v[40:43], v[28:31], 0
    v_sub_f32 v158, v158, v2
    v_exp_f32 v158, v158
    v_sub_f32 v159, v159, v2
    v_exp_f32 v159, v159
    v_sub_f32 v160, v160, v2
    v_exp_f32 v160, v160
    v_sub_f32 v161, v161, v2
    v_exp_f32 v161, v161
    v_sub_f32 v162, v162, v2
    v_exp_f32 v162, v162
    v_smfmac_f32_32x32x32_bf16 v[168:183], v[128:131], v[152:159], v7
    v_sub_f32 v163, v163, v2
    v_exp_f32 v163, v163
    v_sub_f32 v164, v164, v2
    v_exp_f32 v164, v164
    v_sub_f32 v165, v165, v2
    v_exp_f32 v165, v165
    v_sub_f32 v166, v166, v2
    v_exp_f32 v166, v166
    v_sub_f32 v167, v167, v2
    v_exp_f32 v167, v167
    s_setprio 3
    v_sub_f32 v136, v136, v3
    v_exp_f32 v136, v136
    v_sub_f32 v137, v137, v3
    v_exp_f32 v137, v137
    v_sub_f32 v138, v138, v3
    v_exp_f32 v138, v138
    v_smfmac_f32_32x32x32_bf16 v[168:183], v[132:135], v[160:167], v7
    v_sub_f32 v139, v139, v3
    v_exp_f32 v139, v139
    v_sub_f32 v140, v140, v3
    v_exp_f32 v140, v140
    v_sub_f32 v141, v141, v3
    v_exp_f32 v141, v141
    v_mfma_f32_32x32x16_bf16 v[152:167], v[44:47], v[28:31], 0
    v_sub_f32 v142, v142, v3
    v_exp_f32 v142, v142
    v_sub_f32 v143, v143, v3
    v_exp_f32 v143, v143
    v_sub_f32 v144, v144, v3
    v_exp_f32 v144, v144
    v_sub_f32 v145, v145, v3
    v_exp_f32 v145, v145
    v_sub_f32 v146, v146, v3
    v_exp_f32 v146, v146
    v_smfmac_f32_32x32x32_bf16 v[184:199], v[72:75], v[136:143], v7
    v_sub_f32 v147, v147, v3
    v_exp_f32 v147, v147
    v_sub_f32 v148, v148, v3
    v_exp_f32 v148, v148
    v_sub_f32 v149, v149, v3
    v_exp_f32 v149, v149
    v_sub_f32 v150, v150, v3
    v_exp_f32 v150, v150
    v_sub_f32 v151, v151, v3
    v_exp_f32 v151, v151
    s_setprio 2
    v_mov_b32 v23, 1
    v_sub_f32 v152, v152, v3
    v_exp_f32 v152, v152
    ds_write_b128 v9, v[168:171]
    v_sub_f32 v153, v153, v3
    v_exp_f32 v153, v153
    v_sub_f32 v154, v154, v3
    v_exp_f32 v154, v154
    v_smfmac_f32_32x32x32_bf16 v[184:199], v[76:79], v[144:151], v7
    ds_write_b128 v9, v[172:175] offset:1024
    v_sub_f32 v155, v155, v3
    v_exp_f32 v155, v155
    s_lshl_b32 s22, s21, 13
    s_lshl_b32 s23, s20, 10
    s_add_u32 s22, s22, s23
    s_mul_i32 s23, s20, 1040
    s_add_u32 m0, s23, 126976
    s_nop 0
    buffer_load_dwordx4 v8, s[36:39], s22 offen lds
    v_sub_f32 v156, v156, v3
    v_exp_f32 v156, v156
    ds_write_b32 v10, v176
    v_sub_f32 v157, v157, v3
    v_exp_f32 v157, v157
    v_mfma_f32_32x32x16_bf16 v[136:151], v[48:51], v[28:31], 0
    v_sub_f32 v158, v158, v3
    v_exp_f32 v158, v158
    ds_write_b32 v21, v23
    v_sub_f32 v159, v159, v3
    v_exp_f32 v159, v159
    v_sub_f32 v160, v160, v3
    v_exp_f32 v160, v160
    v_sub_f32 v161, v161, v3
    v_exp_f32 v161, v161
    v_sub_f32 v162, v162, v3
    v_exp_f32 v162, v162
    v_smfmac_f32_32x32x32_bf16 v[184:199], v[80:83], v[152:159], v7
    v_sub_f32 v163, v163, v3
    v_exp_f32 v163, v163
    v_sub_f32 v164, v164, v3
    v_exp_f32 v164, v164
    s_mov_b32 s46, 0
    buffer_load_dwordx4 v[200:203], v15, s[32:35], s46 offen offset:0
    v_sub_f32 v165, v165, v3
    v_exp_f32 v165, v165
    v_sub_f32 v166, v166, v3
    v_exp_f32 v166, v166
    v_sub_f32 v167, v167, v3
    v_exp_f32 v167, v167
    s_setprio 1
    v_sub_f32 v136, v136, v3
    v_exp_f32 v136, v136
    v_sub_f32 v137, v137, v3
    v_exp_f32 v137, v137
    v_sub_f32 v138, v138, v3
    v_exp_f32 v138, v138
    v_smfmac_f32_32x32x32_bf16 v[184:199], v[84:87], v[160:167], v7
    v_sub_f32 v139, v139, v3
    v_exp_f32 v139, v139
    v_sub_f32 v140, v140, v3
    v_exp_f32 v140, v140
    v_sub_f32 v141, v141, v3
    v_exp_f32 v141, v141
    v_mfma_f32_32x32x16_bf16 v[152:167], v[52:55], v[28:31], 0
    v_sub_f32 v142, v142, v3
    v_exp_f32 v142, v142
    v_sub_f32 v143, v143, v3
    v_exp_f32 v143, v143
    v_sub_f32 v144, v144, v3
    v_exp_f32 v144, v144
    v_sub_f32 v145, v145, v3
    v_exp_f32 v145, v145
    v_sub_f32 v146, v146, v3
    v_exp_f32 v146, v146
    v_smfmac_f32_32x32x32_bf16 v[184:199], v[88:91], v[136:143], v7
    v_sub_f32 v147, v147, v3
    v_exp_f32 v147, v147
    v_sub_f32 v148, v148, v3
    v_exp_f32 v148, v148
    s_cmp_lg_u32 s20, 0
    s_cbranch_scc1 K2_PAS10
    buffer_load_dword v4, v6, s[56:59], s49 offen
K2_PAS10:
    s_waitcnt lgkmcnt(0)
    s_mov_b32 s46, 0
    buffer_load_dwordx4 v[204:207], v15, s[32:35], s46 offen offset:1024
    v_sub_f32 v149, v149, v3
    v_exp_f32 v149, v149
    v_sub_f32 v150, v150, v3
    v_exp_f32 v150, v150
    v_sub_f32 v151, v151, v3
    v_exp_f32 v151, v151
    s_setprio 0
    ds_read_b32 v22, v19
    v_sub_f32 v152, v152, v3
    v_exp_f32 v152, v152
    v_sub_f32 v153, v153, v3
    v_exp_f32 v153, v153
    v_sub_f32 v154, v154, v3
    v_exp_f32 v154, v154
    v_smfmac_f32_32x32x32_bf16 v[184:199], v[92:95], v[144:151], v7
    v_sub_f32 v155, v155, v3
    v_exp_f32 v155, v155
    s_cmp_lg_u32 s20, 7
    s_cbranch_scc1 K2_B1S
    s_add_u32 s24, s14, 0
    s_addc_u32 s25, s15, 0
    s_movk_i32 s26, 2752
    s_lshl_b32 s22, s6, 6
    v_lshlrev_b32 v4, 2, v0
    s_mov_b32 m0, 147456
    s_nop 0
    buffer_load_dword v4, s[24:27], s22 offen lds
K2_B1S:
    v_sub_f32 v156, v156, v3
    v_exp_f32 v156, v156
    v_sub_f32 v157, v157, v3
    v_exp_f32 v157, v157
    v_mfma_f32_32x32x16_bf16 v[136:151], v[56:59], v[28:31], 0
    v_sub_f32 v158, v158, v3
    v_exp_f32 v158, v158
    s_cmp_lg_u32 s47, 0
    s_cbranch_scc1 K2_NAS1
    s_waitcnt lgkmcnt(0)
    v_cmp_gt_u32 vcc, 1, v22
    s_cbranch_vccnz K2_RAS1
K2_CAS1:
    ds_read_b128 v[32:35], v12
    ds_read_b128 v[36:39], v12 offset:16
    ds_read_b64 v[216:217], v11 offset:0
    ds_read_b64 v[218:219], v11 offset:2048
    ds_read_b64 v[220:221], v11 offset:4096
    ds_read_b64 v[222:223], v11 offset:6144
    ds_read_b64 v[224:225], v11 offset:8192
    ds_read_b64 v[226:227], v11 offset:10240
    ds_read_b64 v[228:229], v11 offset:12288
    ds_read_b64 v[230:231], v11 offset:14336
K2_NAS1:
    v_sub_f32 v159, v159, v3
    v_exp_f32 v159, v159
    v_sub_f32 v160, v160, v3
    v_exp_f32 v160, v160
    v_mfma_f32_32x32x16_bf16 v[168:183], v[24:27], v[24:27], 0
    v_sub_f32 v161, v161, v3
    v_exp_f32 v161, v161
    v_sub_f32 v162, v162, v3
    v_exp_f32 v162, v162
    v_sub_f32 v163, v163, v3
    v_exp_f32 v163, v163
    v_smfmac_f32_32x32x32_bf16 v[184:199], v[96:99], v[152:159], v7
    v_sub_f32 v164, v164, v3
    v_exp_f32 v164, v164
    s_mov_b32 s46, 0
    buffer_load_dwordx4 v[208:211], v15, s[32:35], s46 offen offset:2048
    v_sub_f32 v165, v165, v3
    v_exp_f32 v165, v165
    v_sub_f32 v166, v166, v3
    v_exp_f32 v166, v166
    v_sub_f32 v167, v167, v3
    v_exp_f32 v167, v167
    s_setprio 3
    v_sub_f32 v136, v136, v3
    v_exp_f32 v136, v136
    v_sub_f32 v137, v137, v3
    v_exp_f32 v137, v137
    v_sub_f32 v138, v138, v3
    v_exp_f32 v138, v138
    v_smfmac_f32_32x32x32_bf16 v[184:199], v[100:103], v[160:167], v7
    s_cmp_lg_u32 s47, 0
    s_cbranch_scc1 K2_NBS1
    s_waitcnt lgkmcnt(0)
    v_pk_add_f32 v[32:33], v[32:33], v[34:35]
    v_pk_add_f32 v[36:37], v[36:37], v[38:39]
    v_pk_add_f32 v[216:217], v[216:217], v[218:219]
    v_pk_add_f32 v[220:221], v[220:221], v[222:223]
    v_pk_add_f32 v[224:225], v[224:225], v[226:227]
    v_pk_add_f32 v[228:229], v[228:229], v[230:231]
    v_pk_add_f32 v[32:33], v[32:33], v[36:37]
    v_pk_add_f32 v[216:217], v[216:217], v[220:221]
    v_add_f32 v32, v32, v33
    v_pk_add_f32 v[224:225], v[224:225], v[228:229]
    v_rcp_f32 v32, v32
    v_pk_add_f32 v[216:217], v[216:217], v[224:225]
    v_pk_mul_f32 v[216:217], v[216:217], v[32:33] op_sel_hi:[1,0]
    v_cvt_pk_bf16_f32 v216, v216, v217
    ds_write_b32 v13, v216
    ds_write_b32 v21, v23 offset:32
K2_NBS1:
    v_sub_f32 v139, v139, v3
    v_exp_f32 v139, v139
    v_sub_f32 v140, v140, v3
    v_exp_f32 v140, v140
    v_sub_f32 v141, v141, v3
    v_exp_f32 v141, v141
    v_mfma_f32_32x32x16_bf16 v[152:167], v[60:63], v[28:31], 0
    v_sub_f32 v142, v142, v3
    v_exp_f32 v142, v142
    v_sub_f32 v143, v143, v3
    v_exp_f32 v143, v143
    s_mov_b32 s46, 4096
    buffer_load_dwordx4 v[216:219], v15, s[32:35], s46 offen offset:0
    v_sub_f32 v144, v144, v3
    v_exp_f32 v144, v144
    v_sub_f32 v145, v145, v3
    v_exp_f32 v145, v145
    v_sub_f32 v146, v146, v3
    v_exp_f32 v146, v146
    v_smfmac_f32_32x32x32_bf16 v[184:199], v[104:107], v[136:143], v7
    v_sub_f32 v147, v147, v3
    v_exp_f32 v147, v147
    v_sub_f32 v148, v148, v3
    v_exp_f32 v148, v148
    s_cmp_lg_u32 s20, 1
    s_cbranch_scc1 K2_PAS12
    buffer_load_dword v4, v6, s[56:59], s49 offen
K2_PAS12:
    s_mov_b32 s46, 0
    buffer_load_dwordx4 v[212:215], v15, s[32:35], s46 offen offset:3072
    v_sub_f32 v149, v149, v3
    v_exp_f32 v149, v149
    v_sub_f32 v150, v150, v3
    v_exp_f32 v150, v150
    v_sub_f32 v151, v151, v3
    v_exp_f32 v151, v151
    s_setprio 2
    v_sub_f32 v152, v152, v3
    v_exp_f32 v152, v152
    v_sub_f32 v153, v153, v3
    v_exp_f32 v153, v153
    v_sub_f32 v154, v154, v3
    v_exp_f32 v154, v154
    v_smfmac_f32_32x32x32_bf16 v[184:199], v[108:111], v[144:151], v7
    v_sub_f32 v155, v155, v3
    v_exp_f32 v155, v155
    v_sub_f32 v156, v156, v3
    v_exp_f32 v156, v156
    v_sub_f32 v157, v157, v3
    v_exp_f32 v157, v157
    v_mfma_f32_32x32x16_bf16 v[136:151], v[64:67], v[28:31], 0
    v_sub_f32 v158, v158, v3
    v_exp_f32 v158, v158
    v_sub_f32 v159, v159, v3
    v_exp_f32 v159, v159
    s_mov_b32 s46, 4096
    buffer_load_dwordx4 v[220:223], v15, s[32:35], s46 offen offset:1024
    v_sub_f32 v160, v160, v3
    v_exp_f32 v160, v160
    v_sub_f32 v161, v161, v3
    v_exp_f32 v161, v161
    v_sub_f32 v162, v162, v3
    v_exp_f32 v162, v162
    v_smfmac_f32_32x32x32_bf16 v[184:199], v[112:115], v[152:159], v7
    v_sub_f32 v163, v163, v3
    v_exp_f32 v163, v163
    v_sub_f32 v164, v164, v3
    v_exp_f32 v164, v164
    v_sub_f32 v165, v165, v3
    v_exp_f32 v165, v165
    v_sub_f32 v166, v166, v3
    v_exp_f32 v166, v166
    v_sub_f32 v167, v167, v3
    v_exp_f32 v167, v167
    s_setprio 1
    v_sub_f32 v136, v136, v3
    v_exp_f32 v136, v136
    s_mov_b32 s46, 4096
    buffer_load_dwordx4 v[224:227], v15, s[32:35], s46 offen offset:2048
    ds_read_b32 v22, v20 offset:0
    v_sub_f32 v137, v137, v3
    v_exp_f32 v137, v137
    v_sub_f32 v138, v138, v3
    v_exp_f32 v138, v138
    v_smfmac_f32_32x32x32_bf16 v[184:199], v[116:119], v[160:167], v7
    v_sub_f32 v139, v139, v3
    v_exp_f32 v139, v139
    v_sub_f32 v140, v140, v3
    v_exp_f32 v140, v140
    v_sub_f32 v141, v141, v3
    v_exp_f32 v141, v141
    v_mfma_f32_32x32x16_bf16 v[152:167], v[68:71], v[28:31], 0
    v_sub_f32 v142, v142, v3
    v_exp_f32 v142, v142
    v_sub_f32 v143, v143, v3
    v_exp_f32 v143, v143
    s_waitcnt lgkmcnt(0)
    v_cmp_gt_u32 vcc, 1, v22
    s_cbranch_vccnz K2_RDS1
K2_CDS1:
    ds_read_b128 v[232:235], v14 offset:0
    ds_read_b128 v[236:239], v14 offset:512
    v_sub_f32 v144, v144, v3
    v_exp_f32 v144, v144
    v_sub_f32 v145, v145, v3
    v_exp_f32 v145, v145
    ds_read_b128 v[28:31], v17 offset:2048
    ds_read_b32 v2, v1 offset:256
    v_sub_f32 v146, v146, v3
    v_exp_f32 v146, v146
    v_smfmac_f32_32x32x32_bf16 v[184:199], v[120:123], v[136:143], v7
    v_sub_f32 v147, v147, v3
    v_exp_f32 v147, v147
    v_sub_f32 v148, v148, v3
    v_exp_f32 v148, v148
    s_cmp_lg_u32 s20, 2
    s_cbranch_scc1 K2_PAS14
    buffer_load_dword v4, v6, s[56:59], s49 offen
K2_PAS14:
    v_sub_f32 v149, v149, v3
    v_exp_f32 v149, v149
    v_sub_f32 v150, v150, v3
    v_exp_f32 v150, v150
    s_waitcnt lgkmcnt(0)
    s_waitcnt vmcnt(5)
    v_mfma_f32_16x16x32_bf16 v[240:243], v[200:203], v[232:235], 0
    v_sub_f32 v151, v151, v3
    v_exp_f32 v151, v151
    s_setprio 0
    v_sub_f32 v152, v152, v3
    v_exp_f32 v152, v152
    v_sub_f32 v153, v153, v3
    v_exp_f32 v153, v153
    v_sub_f32 v154, v154, v3
    v_exp_f32 v154, v154
    v_smfmac_f32_32x32x32_bf16 v[184:199], v[124:127], v[144:151], v7
    v_sub_f32 v155, v155, v3
    v_exp_f32 v155, v155
    v_sub_f32 v156, v156, v3
    v_exp_f32 v156, v156
    v_sub_f32 v157, v157, v3
    v_exp_f32 v157, v157
    s_waitcnt lgkmcnt(0)
    v_mfma_f32_32x32x16_bf16 v[136:151], v[40:43], v[28:31], 0
    v_sub_f32 v158, v158, v3
    v_exp_f32 v158, v158
    v_sub_f32 v159, v159, v3
    v_exp_f32 v159, v159
    s_mov_b32 s46, 4096
    buffer_load_dwordx4 v[228:231], v15, s[32:35], s46 offen offset:3072
    v_sub_f32 v160, v160, v3
    v_exp_f32 v160, v160
    v_mfma_f32_16x16x32_bf16 v[244:247], v[204:207], v[232:235], 0
    v_sub_f32 v161, v161, v3
    v_exp_f32 v161, v161
    v_sub_f32 v162, v162, v3
    v_exp_f32 v162, v162
    v_smfmac_f32_32x32x32_bf16 v[184:199], v[128:131], v[152:159], v7
    v_sub_f32 v163, v163, v3
    v_exp_f32 v163, v163
    v_sub_f32 v164, v164, v3
    v_exp_f32 v164, v164
    v_sub_f32 v165, v165, v3
    v_exp_f32 v165, v165
    v_sub_f32 v166, v166, v3
    v_exp_f32 v166, v166
    s_waitcnt vmcnt(3)
    v_mfma_f32_16x16x32_bf16 v[248:251], v[208:211], v[232:235], 0
    v_sub_f32 v167, v167, v3
    v_exp_f32 v167, v167
    s_setprio 3
    v_sub_f32 v136, v136, v2
    v_exp_f32 v136, v136
    v_sub_f32 v137, v137, v2
    v_exp_f32 v137, v137
    v_sub_f32 v138, v138, v2
    v_exp_f32 v138, v138
    v_smfmac_f32_32x32x32_bf16 v[184:199], v[132:135], v[160:167], v7
    v_sub_f32 v139, v139, v2
    v_exp_f32 v139, v139
    v_sub_f32 v140, v140, v2
    v_exp_f32 v140, v140
    v_sub_f32 v141, v141, v2
    v_exp_f32 v141, v141
    v_mfma_f32_32x32x16_bf16 v[152:167], v[44:47], v[28:31], 0
    v_sub_f32 v142, v142, v2
    v_exp_f32 v142, v142
    v_sub_f32 v143, v143, v2
    v_exp_f32 v143, v143
    v_sub_f32 v144, v144, v2
    v_exp_f32 v144, v144
    v_mfma_f32_16x16x32_bf16 v[252:255], v[212:215], v[232:235], 0
    v_sub_f32 v145, v145, v2
    v_exp_f32 v145, v145
    v_sub_f32 v146, v146, v2
    v_exp_f32 v146, v146
    v_smfmac_f32_32x32x32_bf16 v[168:183], v[72:75], v[136:143], v7
    v_sub_f32 v147, v147, v2
    v_exp_f32 v147, v147
    v_sub_f32 v148, v148, v2
    v_exp_f32 v148, v148
    s_cmp_lg_u32 s20, 3
    s_cbranch_scc1 K2_PAS16
    buffer_load_dword v4, v6, s[56:59], s49 offen
K2_PAS16:
    v_sub_f32 v149, v149, v2
    v_exp_f32 v149, v149
    v_sub_f32 v150, v150, v2
    v_exp_f32 v150, v150
    s_waitcnt vmcnt(2)
    v_mfma_f32_16x16x32_bf16 v[240:243], v[216:219], v[236:239], v[240:243]
    v_sub_f32 v151, v151, v2
    v_exp_f32 v151, v151
    s_setprio 2
    v_mov_b32 v23, 2
    v_sub_f32 v152, v152, v2
    v_exp_f32 v152, v152
    ds_write_b128 v9, v[184:187]
    v_sub_f32 v153, v153, v2
    v_exp_f32 v153, v153
    v_sub_f32 v154, v154, v2
    v_exp_f32 v154, v154
    v_smfmac_f32_32x32x32_bf16 v[168:183], v[76:79], v[144:151], v7
    ds_write_b128 v9, v[188:191] offset:1024
    v_sub_f32 v155, v155, v2
    v_exp_f32 v155, v155
    v_sub_f32 v156, v156, v2
    v_exp_f32 v156, v156
    ds_write_b32 v10, v192
    v_sub_f32 v157, v157, v2
    v_exp_f32 v157, v157
    v_mfma_f32_32x32x16_bf16 v[136:151], v[48:51], v[28:31], 0
    v_sub_f32 v158, v158, v2
    v_exp_f32 v158, v158
    ds_write_b32 v21, v23
    v_sub_f32 v159, v159, v2
    v_exp_f32 v159, v159
    v_sub_f32 v160, v160, v2
    v_exp_f32 v160, v160
    v_mfma_f32_16x16x32_bf16 v[244:247], v[220:223], v[236:239], v[244:247]
    v_sub_f32 v161, v161, v2
    v_exp_f32 v161, v161
    v_sub_f32 v162, v162, v2
    v_exp_f32 v162, v162
    v_smfmac_f32_32x32x32_bf16 v[168:183], v[80:83], v[152:159], v7
    v_sub_f32 v163, v163, v2
    v_exp_f32 v163, v163
    v_sub_f32 v164, v164, v2
    v_exp_f32 v164, v164
    s_mov_b32 s46, 65536
    buffer_load_dwordx4 v[200:203], v15, s[32:35], s46 offen offset:0
    v_sub_f32 v165, v165, v2
    v_exp_f32 v165, v165
    v_sub_f32 v166, v166, v2
    v_exp_f32 v166, v166
    s_waitcnt vmcnt(2)
    v_mfma_f32_16x16x32_bf16 v[248:251], v[224:227], v[236:239], v[248:251]
    v_sub_f32 v167, v167, v2
    v_exp_f32 v167, v167
    s_setprio 1
    v_sub_f32 v136, v136, v2
    v_exp_f32 v136, v136
    v_sub_f32 v137, v137, v2
    v_exp_f32 v137, v137
    v_sub_f32 v138, v138, v2
    v_exp_f32 v138, v138
    v_smfmac_f32_32x32x32_bf16 v[168:183], v[84:87], v[160:167], v7
    v_sub_f32 v139, v139, v2
    v_exp_f32 v139, v139
    v_sub_f32 v140, v140, v2
    v_exp_f32 v140, v140
    v_sub_f32 v141, v141, v2
    v_exp_f32 v141, v141
    v_mfma_f32_32x32x16_bf16 v[152:167], v[52:55], v[28:31], 0
    v_sub_f32 v142, v142, v2
    v_exp_f32 v142, v142
    v_sub_f32 v143, v143, v2
    v_exp_f32 v143, v143
    v_sub_f32 v144, v144, v2
    v_exp_f32 v144, v144
    s_waitcnt vmcnt(1)
    v_mfma_f32_16x16x32_bf16 v[252:255], v[228:231], v[236:239], v[252:255]
    v_sub_f32 v145, v145, v2
    v_exp_f32 v145, v145
    v_sub_f32 v146, v146, v2
    v_exp_f32 v146, v146
    v_smfmac_f32_32x32x32_bf16 v[168:183], v[88:91], v[136:143], v7
    v_sub_f32 v147, v147, v2
    v_exp_f32 v147, v147
    v_sub_f32 v148, v148, v2
    v_exp_f32 v148, v148
    s_cmp_lg_u32 s20, 4
    s_cbranch_scc1 K2_PAS18
    buffer_load_dword v4, v6, s[56:59], s49 offen
K2_PAS18:
    s_waitcnt lgkmcnt(0)
    s_mov_b32 s46, 65536
    buffer_load_dwordx4 v[204:207], v15, s[32:35], s46 offen offset:1024
    v_sub_f32 v149, v149, v2
    v_exp_f32 v149, v149
    v_sub_f32 v150, v150, v2
    v_exp_f32 v150, v150
    v_sub_f32 v151, v151, v2
    v_exp_f32 v151, v151
    s_setprio 0
    ds_read_b32 v22, v19
    v_sub_f32 v152, v152, v2
    v_exp_f32 v152, v152
    v_sub_f32 v153, v153, v2
    v_exp_f32 v153, v153
    v_sub_f32 v154, v154, v2
    v_exp_f32 v154, v154
    v_smfmac_f32_32x32x32_bf16 v[168:183], v[92:95], v[144:151], v7
    v_sub_f32 v155, v155, v2
    v_exp_f32 v155, v155
    v_sub_f32 v156, v156, v2
    v_exp_f32 v156, v156
    v_sub_f32 v157, v157, v2
    v_exp_f32 v157, v157
    v_mfma_f32_32x32x16_bf16 v[136:151], v[56:59], v[28:31], 0
    v_sub_f32 v158, v158, v2
    v_exp_f32 v158, v158
    s_cmp_lg_u32 s47, 1
    s_cbranch_scc1 K2_NAS2
    s_waitcnt lgkmcnt(0)
    v_cmp_gt_u32 vcc, 2, v22
    s_cbranch_vccnz K2_RAS2
K2_CAS2:
    ds_read_b128 v[32:35], v12
    ds_read_b128 v[36:39], v12 offset:16
    ds_read_b64 v[216:217], v11 offset:0
    ds_read_b64 v[218:219], v11 offset:2048
    ds_read_b64 v[220:221], v11 offset:4096
    ds_read_b64 v[222:223], v11 offset:6144
    ds_read_b64 v[224:225], v11 offset:8192
    ds_read_b64 v[226:227], v11 offset:10240
    ds_read_b64 v[228:229], v11 offset:12288
    ds_read_b64 v[230:231], v11 offset:14336
K2_NAS2:
    v_sub_f32 v159, v159, v2
    v_exp_f32 v159, v159
    v_sub_f32 v160, v160, v2
    v_exp_f32 v160, v160
    v_mfma_f32_32x32x16_bf16 v[184:199], v[24:27], v[24:27], 0
    v_sub_f32 v161, v161, v2
    v_exp_f32 v161, v161
    v_sub_f32 v162, v162, v2
    v_exp_f32 v162, v162
    v_sub_f32 v163, v163, v2
    v_exp_f32 v163, v163
    v_smfmac_f32_32x32x32_bf16 v[168:183], v[96:99], v[152:159], v7
    v_sub_f32 v164, v164, v2
    v_exp_f32 v164, v164
    s_mov_b32 s46, 65536
    buffer_load_dwordx4 v[208:211], v15, s[32:35], s46 offen offset:2048
    v_sub_f32 v165, v165, v2
    v_exp_f32 v165, v165
    v_sub_f32 v166, v166, v2
    v_exp_f32 v166, v166
    v_sub_f32 v167, v167, v2
    v_exp_f32 v167, v167
    s_setprio 3
    v_sub_f32 v136, v136, v2
    v_exp_f32 v136, v136
    v_sub_f32 v137, v137, v2
    v_exp_f32 v137, v137
    v_sub_f32 v138, v138, v2
    v_exp_f32 v138, v138
    v_smfmac_f32_32x32x32_bf16 v[168:183], v[100:103], v[160:167], v7
    s_cmp_lg_u32 s47, 1
    s_cbranch_scc1 K2_NBS2
    s_waitcnt lgkmcnt(0)
    v_pk_add_f32 v[32:33], v[32:33], v[34:35]
    v_pk_add_f32 v[36:37], v[36:37], v[38:39]
    v_pk_add_f32 v[216:217], v[216:217], v[218:219]
    v_pk_add_f32 v[220:221], v[220:221], v[222:223]
    v_pk_add_f32 v[224:225], v[224:225], v[226:227]
    v_pk_add_f32 v[228:229], v[228:229], v[230:231]
    v_pk_add_f32 v[32:33], v[32:33], v[36:37]
    v_pk_add_f32 v[216:217], v[216:217], v[220:221]
    v_add_f32 v32, v32, v33
    v_pk_add_f32 v[224:225], v[224:225], v[228:229]
    v_rcp_f32 v32, v32
    v_pk_add_f32 v[216:217], v[216:217], v[224:225]
    v_pk_mul_f32 v[216:217], v[216:217], v[32:33] op_sel_hi:[1,0]
    v_cvt_pk_bf16_f32 v216, v216, v217
    ds_write_b32 v13, v216
    ds_write_b32 v21, v23 offset:32
K2_NBS2:
    v_sub_f32 v139, v139, v2
    v_exp_f32 v139, v139
    v_sub_f32 v140, v140, v2
    v_exp_f32 v140, v140
    v_sub_f32 v141, v141, v2
    v_exp_f32 v141, v141
    v_mfma_f32_32x32x16_bf16 v[152:167], v[60:63], v[28:31], 0
    v_sub_f32 v142, v142, v2
    v_exp_f32 v142, v142
    v_sub_f32 v143, v143, v2
    v_exp_f32 v143, v143
    s_mov_b32 s46, 69632
    buffer_load_dwordx4 v[216:219], v15, s[32:35], s46 offen offset:0
    v_sub_f32 v144, v144, v2
    v_exp_f32 v144, v144
    v_sub_f32 v145, v145, v2
    v_exp_f32 v145, v145
    v_sub_f32 v146, v146, v2
    v_exp_f32 v146, v146
    v_smfmac_f32_32x32x32_bf16 v[168:183], v[104:107], v[136:143], v7
    v_sub_f32 v147, v147, v2
    v_exp_f32 v147, v147
    v_sub_f32 v148, v148, v2
    v_exp_f32 v148, v148
    s_cmp_lg_u32 s20, 5
    s_cbranch_scc1 K2_PAS20
    buffer_load_dword v4, v6, s[56:59], s49 offen
K2_PAS20:
    s_mov_b32 s46, 65536
    buffer_load_dwordx4 v[212:215], v15, s[32:35], s46 offen offset:3072
    v_sub_f32 v149, v149, v2
    v_exp_f32 v149, v149
    v_sub_f32 v150, v150, v2
    v_exp_f32 v150, v150
    v_sub_f32 v151, v151, v2
    v_exp_f32 v151, v151
    s_setprio 2
    v_sub_f32 v152, v152, v2
    v_exp_f32 v152, v152
    v_sub_f32 v153, v153, v2
    v_exp_f32 v153, v153
    v_sub_f32 v154, v154, v2
    v_exp_f32 v154, v154
    v_smfmac_f32_32x32x32_bf16 v[168:183], v[108:111], v[144:151], v7
    v_sub_f32 v155, v155, v2
    v_exp_f32 v155, v155
    v_sub_f32 v156, v156, v2
    v_exp_f32 v156, v156
    v_sub_f32 v157, v157, v2
    v_exp_f32 v157, v157
    v_mfma_f32_32x32x16_bf16 v[136:151], v[64:67], v[28:31], 0
    v_sub_f32 v158, v158, v2
    v_exp_f32 v158, v158
    v_sub_f32 v159, v159, v2
    v_exp_f32 v159, v159
    s_mov_b32 s46, 69632
    buffer_load_dwordx4 v[220:223], v15, s[32:35], s46 offen offset:1024
    v_sub_f32 v160, v160, v2
    v_exp_f32 v160, v160
    v_sub_f32 v161, v161, v2
    v_exp_f32 v161, v161
    v_sub_f32 v162, v162, v2
    v_exp_f32 v162, v162
    v_smfmac_f32_32x32x32_bf16 v[168:183], v[112:115], v[152:159], v7
    v_sub_f32 v163, v163, v2
    v_exp_f32 v163, v163
    v_sub_f32 v164, v164, v2
    v_exp_f32 v164, v164
    v_sub_f32 v165, v165, v2
    v_exp_f32 v165, v165
    v_sub_f32 v166, v166, v2
    v_exp_f32 v166, v166
    v_sub_f32 v167, v167, v2
    v_exp_f32 v167, v167
    s_setprio 1
    v_sub_f32 v136, v136, v2
    v_exp_f32 v136, v136
    s_mov_b32 s46, 69632
    buffer_load_dwordx4 v[224:227], v15, s[32:35], s46 offen offset:2048
    ds_read_b32 v22, v20 offset:16
    v_sub_f32 v137, v137, v2
    v_exp_f32 v137, v137
    v_sub_f32 v138, v138, v2
    v_exp_f32 v138, v138
    v_smfmac_f32_32x32x32_bf16 v[168:183], v[116:119], v[160:167], v7
    v_sub_f32 v139, v139, v2
    v_exp_f32 v139, v139
    v_sub_f32 v140, v140, v2
    v_exp_f32 v140, v140
    v_sub_f32 v141, v141, v2
    v_exp_f32 v141, v141
    v_mfma_f32_32x32x16_bf16 v[152:167], v[68:71], v[28:31], 0
    v_sub_f32 v142, v142, v2
    v_exp_f32 v142, v142
    v_sub_f32 v143, v143, v2
    v_exp_f32 v143, v143
    s_waitcnt lgkmcnt(0)
    v_cmp_gt_u32 vcc, 2, v22
    s_cbranch_vccnz K2_RDS2
K2_CDS2:
    ds_read_b128 v[232:235], v14 offset:0
    ds_read_b128 v[236:239], v14 offset:512
    v_sub_f32 v144, v144, v2
    v_exp_f32 v144, v144
    v_sub_f32 v145, v145, v2
    v_exp_f32 v145, v145
    ds_read_b128 v[28:31], v17 offset:3072
    ds_read_b32 v3, v1 offset:384
    v_sub_f32 v146, v146, v2
    v_exp_f32 v146, v146
    v_smfmac_f32_32x32x32_bf16 v[168:183], v[120:123], v[136:143], v7
    v_sub_f32 v147, v147, v2
    v_exp_f32 v147, v147
    v_sub_f32 v148, v148, v2
    v_exp_f32 v148, v148
    s_cmp_lg_u32 s20, 0
    s_cbranch_scc1 K2_PBS22
    buffer_load_dword v5, v6, s[40:43], s60 offen
K2_PBS22:
    v_sub_f32 v149, v149, v2
    v_exp_f32 v149, v149
    v_sub_f32 v150, v150, v2
    v_exp_f32 v150, v150
    s_waitcnt lgkmcnt(0)
    s_waitcnt vmcnt(5)
    v_mfma_f32_16x16x32_bf16 v[240:243], v[200:203], v[232:235], v[240:243]
    v_sub_f32 v151, v151, v2
    v_exp_f32 v151, v151
    s_setprio 0
    v_sub_f32 v152, v152, v2
    v_exp_f32 v152, v152
    v_sub_f32 v153, v153, v2
    v_exp_f32 v153, v153
    v_sub_f32 v154, v154, v2
    v_exp_f32 v154, v154
    v_smfmac_f32_32x32x32_bf16 v[168:183], v[124:127], v[144:151], v7
    v_sub_f32 v155, v155, v2
    v_exp_f32 v155, v155
    v_sub_f32 v156, v156, v2
    v_exp_f32 v156, v156
    v_sub_f32 v157, v157, v2
    v_exp_f32 v157, v157
    s_waitcnt lgkmcnt(0)
    v_mfma_f32_32x32x16_bf16 v[136:151], v[40:43], v[28:31], 0
    v_sub_f32 v158, v158, v2
    v_exp_f32 v158, v158
    v_sub_f32 v159, v159, v2
    v_exp_f32 v159, v159
    s_mov_b32 s46, 69632
    buffer_load_dwordx4 v[228:231], v15, s[32:35], s46 offen offset:3072
    v_sub_f32 v160, v160, v2
    v_exp_f32 v160, v160
    v_mfma_f32_16x16x32_bf16 v[244:247], v[204:207], v[232:235], v[244:247]
    v_sub_f32 v161, v161, v2
    v_exp_f32 v161, v161
    v_sub_f32 v162, v162, v2
    v_exp_f32 v162, v162
    v_smfmac_f32_32x32x32_bf16 v[168:183], v[128:131], v[152:159], v7
    v_sub_f32 v163, v163, v2
    v_exp_f32 v163, v163
    v_sub_f32 v164, v164, v2
    v_exp_f32 v164, v164
    v_sub_f32 v165, v165, v2
    v_exp_f32 v165, v165
    v_sub_f32 v166, v166, v2
    v_exp_f32 v166, v166
    s_waitcnt vmcnt(3)
    v_mfma_f32_16x16x32_bf16 v[248:251], v[208:211], v[232:235], v[248:251]
    v_sub_f32 v167, v167, v2
    v_exp_f32 v167, v167
    s_setprio 3
    v_sub_f32 v136, v136, v3
    v_exp_f32 v136, v136
    v_sub_f32 v137, v137, v3
    v_exp_f32 v137, v137
    v_sub_f32 v138, v138, v3
    v_exp_f32 v138, v138
    v_smfmac_f32_32x32x32_bf16 v[168:183], v[132:135], v[160:167], v7
    v_sub_f32 v139, v139, v3
    v_exp_f32 v139, v139
    v_sub_f32 v140, v140, v3
    v_exp_f32 v140, v140
    v_sub_f32 v141, v141, v3
    v_exp_f32 v141, v141
    v_mfma_f32_32x32x16_bf16 v[152:167], v[44:47], v[28:31], 0
    v_sub_f32 v142, v142, v3
    v_exp_f32 v142, v142
    v_sub_f32 v143, v143, v3
    v_exp_f32 v143, v143
    v_sub_f32 v144, v144, v3
    v_exp_f32 v144, v144
    v_mfma_f32_16x16x32_bf16 v[252:255], v[212:215], v[232:235], v[252:255]
    v_sub_f32 v145, v145, v3
    v_exp_f32 v145, v145
    v_sub_f32 v146, v146, v3
    v_exp_f32 v146, v146
    v_smfmac_f32_32x32x32_bf16 v[184:199], v[72:75], v[136:143], v7
    v_sub_f32 v147, v147, v3
    v_exp_f32 v147, v147
    v_sub_f32 v148, v148, v3
    v_exp_f32 v148, v148
    s_cmp_lg_u32 s20, 1
    s_cbranch_scc1 K2_PBS24
    buffer_load_dword v5, v6, s[40:43], s60 offen
K2_PBS24:
    v_sub_f32 v149, v149, v3
    v_exp_f32 v149, v149
    v_sub_f32 v150, v150, v3
    v_exp_f32 v150, v150
    s_waitcnt vmcnt(2)
    v_mfma_f32_16x16x32_bf16 v[240:243], v[216:219], v[236:239], v[240:243]
    v_sub_f32 v151, v151, v3
    v_exp_f32 v151, v151
    s_setprio 2
    v_mov_b32 v23, 3
    v_sub_f32 v152, v152, v3
    v_exp_f32 v152, v152
    ds_write_b128 v9, v[168:171]
    v_sub_f32 v153, v153, v3
    v_exp_f32 v153, v153
    v_sub_f32 v154, v154, v3
    v_exp_f32 v154, v154
    v_smfmac_f32_32x32x32_bf16 v[184:199], v[76:79], v[144:151], v7
    ds_write_b128 v9, v[172:175] offset:1024
    v_sub_f32 v155, v155, v3
    v_exp_f32 v155, v155
    v_sub_f32 v156, v156, v3
    v_exp_f32 v156, v156
    ds_write_b32 v10, v176
    v_sub_f32 v157, v157, v3
    v_exp_f32 v157, v157
    v_mfma_f32_32x32x16_bf16 v[136:151], v[48:51], v[28:31], 0
    v_sub_f32 v158, v158, v3
    v_exp_f32 v158, v158
    ds_write_b32 v21, v23
    v_sub_f32 v159, v159, v3
    v_exp_f32 v159, v159
    v_sub_f32 v160, v160, v3
    v_exp_f32 v160, v160
    v_mfma_f32_16x16x32_bf16 v[244:247], v[220:223], v[236:239], v[244:247]
    v_sub_f32 v161, v161, v3
    v_exp_f32 v161, v161
    v_sub_f32 v162, v162, v3
    v_exp_f32 v162, v162
    v_smfmac_f32_32x32x32_bf16 v[184:199], v[80:83], v[152:159], v7
    v_sub_f32 v163, v163, v3
    v_exp_f32 v163, v163
    v_sub_f32 v164, v164, v3
    v_exp_f32 v164, v164
    s_mov_b32 s46, 131072
    buffer_load_dwordx4 v[200:203], v15, s[32:35], s46 offen offset:0
    v_sub_f32 v165, v165, v3
    v_exp_f32 v165, v165
    v_sub_f32 v166, v166, v3
    v_exp_f32 v166, v166
    s_waitcnt vmcnt(2)
    v_mfma_f32_16x16x32_bf16 v[248:251], v[224:227], v[236:239], v[248:251]
    v_sub_f32 v167, v167, v3
    v_exp_f32 v167, v167
    s_setprio 1
    v_sub_f32 v136, v136, v3
    v_exp_f32 v136, v136
    v_sub_f32 v137, v137, v3
    v_exp_f32 v137, v137
    v_sub_f32 v138, v138, v3
    v_exp_f32 v138, v138
    v_smfmac_f32_32x32x32_bf16 v[184:199], v[84:87], v[160:167], v7
    v_sub_f32 v139, v139, v3
    v_exp_f32 v139, v139
    v_sub_f32 v140, v140, v3
    v_exp_f32 v140, v140
    v_sub_f32 v141, v141, v3
    v_exp_f32 v141, v141
    v_mfma_f32_32x32x16_bf16 v[152:167], v[52:55], v[28:31], 0
    v_sub_f32 v142, v142, v3
    v_exp_f32 v142, v142
    v_sub_f32 v143, v143, v3
    v_exp_f32 v143, v143
    v_sub_f32 v144, v144, v3
    v_exp_f32 v144, v144
    s_waitcnt vmcnt(1)
    v_mfma_f32_16x16x32_bf16 v[252:255], v[228:231], v[236:239], v[252:255]
    v_sub_f32 v145, v145, v3
    v_exp_f32 v145, v145
    v_sub_f32 v146, v146, v3
    v_exp_f32 v146, v146
    v_smfmac_f32_32x32x32_bf16 v[184:199], v[88:91], v[136:143], v7
    v_sub_f32 v147, v147, v3
    v_exp_f32 v147, v147
    v_sub_f32 v148, v148, v3
    v_exp_f32 v148, v148
    s_cmp_lg_u32 s20, 2
    s_cbranch_scc1 K2_PBS26
    buffer_load_dword v5, v6, s[40:43], s60 offen
K2_PBS26:
    s_waitcnt lgkmcnt(0)
    s_mov_b32 s46, 131072
    buffer_load_dwordx4 v[204:207], v15, s[32:35], s46 offen offset:1024
    v_sub_f32 v149, v149, v3
    v_exp_f32 v149, v149
    v_sub_f32 v150, v150, v3
    v_exp_f32 v150, v150
    v_sub_f32 v151, v151, v3
    v_exp_f32 v151, v151
    s_setprio 0
    ds_read_b32 v22, v19
    v_sub_f32 v152, v152, v3
    v_exp_f32 v152, v152
    v_sub_f32 v153, v153, v3
    v_exp_f32 v153, v153
    v_sub_f32 v154, v154, v3
    v_exp_f32 v154, v154
    v_smfmac_f32_32x32x32_bf16 v[184:199], v[92:95], v[144:151], v7
    v_sub_f32 v155, v155, v3
    v_exp_f32 v155, v155
    v_sub_f32 v156, v156, v3
    v_exp_f32 v156, v156
    v_sub_f32 v157, v157, v3
    v_exp_f32 v157, v157
    v_mfma_f32_32x32x16_bf16 v[136:151], v[56:59], v[28:31], 0
    v_sub_f32 v158, v158, v3
    v_exp_f32 v158, v158
    s_cmp_lg_u32 s47, 0
    s_cbranch_scc1 K2_NAS3
    s_waitcnt lgkmcnt(0)
    v_cmp_gt_u32 vcc, 3, v22
    s_cbranch_vccnz K2_RAS3
K2_CAS3:
    ds_read_b128 v[32:35], v12
    ds_read_b128 v[36:39], v12 offset:16
    ds_read_b64 v[216:217], v11 offset:0
    ds_read_b64 v[218:219], v11 offset:2048
    ds_read_b64 v[220:221], v11 offset:4096
    ds_read_b64 v[222:223], v11 offset:6144
    ds_read_b64 v[224:225], v11 offset:8192
    ds_read_b64 v[226:227], v11 offset:10240
    ds_read_b64 v[228:229], v11 offset:12288
    ds_read_b64 v[230:231], v11 offset:14336
K2_NAS3:
    v_sub_f32 v159, v159, v3
    v_exp_f32 v159, v159
    v_sub_f32 v160, v160, v3
    v_exp_f32 v160, v160
    v_mfma_f32_32x32x16_bf16 v[168:183], v[24:27], v[24:27], 0
    v_sub_f32 v161, v161, v3
    v_exp_f32 v161, v161
    v_sub_f32 v162, v162, v3
    v_exp_f32 v162, v162
    v_sub_f32 v163, v163, v3
    v_exp_f32 v163, v163
    v_smfmac_f32_32x32x32_bf16 v[184:199], v[96:99], v[152:159], v7
    v_sub_f32 v164, v164, v3
    v_exp_f32 v164, v164
    s_mov_b32 s46, 131072
    buffer_load_dwordx4 v[208:211], v15, s[32:35], s46 offen offset:2048
    v_sub_f32 v165, v165, v3
    v_exp_f32 v165, v165
    v_sub_f32 v166, v166, v3
    v_exp_f32 v166, v166
    v_sub_f32 v167, v167, v3
    v_exp_f32 v167, v167
    s_setprio 3
    v_sub_f32 v136, v136, v3
    v_exp_f32 v136, v136
    v_sub_f32 v137, v137, v3
    v_exp_f32 v137, v137
    v_sub_f32 v138, v138, v3
    v_exp_f32 v138, v138
    v_smfmac_f32_32x32x32_bf16 v[184:199], v[100:103], v[160:167], v7
    s_cmp_lg_u32 s47, 0
    s_cbranch_scc1 K2_NBS3
    s_waitcnt lgkmcnt(0)
    v_pk_add_f32 v[32:33], v[32:33], v[34:35]
    v_pk_add_f32 v[36:37], v[36:37], v[38:39]
    v_pk_add_f32 v[216:217], v[216:217], v[218:219]
    v_pk_add_f32 v[220:221], v[220:221], v[222:223]
    v_pk_add_f32 v[224:225], v[224:225], v[226:227]
    v_pk_add_f32 v[228:229], v[228:229], v[230:231]
    v_pk_add_f32 v[32:33], v[32:33], v[36:37]
    v_pk_add_f32 v[216:217], v[216:217], v[220:221]
    v_add_f32 v32, v32, v33
    v_pk_add_f32 v[224:225], v[224:225], v[228:229]
    v_rcp_f32 v32, v32
    v_pk_add_f32 v[216:217], v[216:217], v[224:225]
    v_pk_mul_f32 v[216:217], v[216:217], v[32:33] op_sel_hi:[1,0]
    v_cvt_pk_bf16_f32 v216, v216, v217
    ds_write_b32 v13, v216
    ds_write_b32 v21, v23 offset:32
K2_NBS3:
    v_sub_f32 v139, v139, v3
    v_exp_f32 v139, v139
    v_sub_f32 v140, v140, v3
    v_exp_f32 v140, v140
    v_sub_f32 v141, v141, v3
    v_exp_f32 v141, v141
    v_mfma_f32_32x32x16_bf16 v[152:167], v[60:63], v[28:31], 0
    v_sub_f32 v142, v142, v3
    v_exp_f32 v142, v142
    v_sub_f32 v143, v143, v3
    v_exp_f32 v143, v143
    s_mov_b32 s46, 135168
    buffer_load_dwordx4 v[216:219], v15, s[32:35], s46 offen offset:0
    v_sub_f32 v144, v144, v3
    v_exp_f32 v144, v144
    v_sub_f32 v145, v145, v3
    v_exp_f32 v145, v145
    v_sub_f32 v146, v146, v3
    v_exp_f32 v146, v146
    v_smfmac_f32_32x32x32_bf16 v[184:199], v[104:107], v[136:143], v7
    v_sub_f32 v147, v147, v3
    v_exp_f32 v147, v147
    v_sub_f32 v148, v148, v3
    v_exp_f32 v148, v148
    s_cmp_lg_u32 s20, 3
    s_cbranch_scc1 K2_PBS28
    buffer_load_dword v5, v6, s[40:43], s60 offen
K2_PBS28:
    s_mov_b32 s46, 131072
    buffer_load_dwordx4 v[212:215], v15, s[32:35], s46 offen offset:3072
    v_sub_f32 v149, v149, v3
    v_exp_f32 v149, v149
    v_sub_f32 v150, v150, v3
    v_exp_f32 v150, v150
    v_sub_f32 v151, v151, v3
    v_exp_f32 v151, v151
    s_setprio 2
    v_sub_f32 v152, v152, v3
    v_exp_f32 v152, v152
    v_sub_f32 v153, v153, v3
    v_exp_f32 v153, v153
    v_sub_f32 v154, v154, v3
    v_exp_f32 v154, v154
    v_smfmac_f32_32x32x32_bf16 v[184:199], v[108:111], v[144:151], v7
    v_sub_f32 v155, v155, v3
    v_exp_f32 v155, v155
    v_sub_f32 v156, v156, v3
    v_exp_f32 v156, v156
    v_sub_f32 v157, v157, v3
    v_exp_f32 v157, v157
    v_mfma_f32_32x32x16_bf16 v[136:151], v[64:67], v[28:31], 0
    v_sub_f32 v158, v158, v3
    v_exp_f32 v158, v158
    v_sub_f32 v159, v159, v3
    v_exp_f32 v159, v159
    s_mov_b32 s46, 135168
    buffer_load_dwordx4 v[220:223], v15, s[32:35], s46 offen offset:1024
    v_sub_f32 v160, v160, v3
    v_exp_f32 v160, v160
    v_sub_f32 v161, v161, v3
    v_exp_f32 v161, v161
    v_sub_f32 v162, v162, v3
    v_exp_f32 v162, v162
    v_smfmac_f32_32x32x32_bf16 v[184:199], v[112:115], v[152:159], v7
    v_sub_f32 v163, v163, v3
    v_exp_f32 v163, v163
    v_sub_f32 v164, v164, v3
    v_exp_f32 v164, v164
    v_sub_f32 v165, v165, v3
    v_exp_f32 v165, v165
    v_sub_f32 v166, v166, v3
    v_exp_f32 v166, v166
    v_sub_f32 v167, v167, v3
    v_exp_f32 v167, v167
    s_setprio 1
    v_sub_f32 v136, v136, v3
    v_exp_f32 v136, v136
    s_mov_b32 s46, 135168
    buffer_load_dwordx4 v[224:227], v15, s[32:35], s46 offen offset:2048
    ds_read_b32 v22, v20 offset:0
    v_sub_f32 v137, v137, v3
    v_exp_f32 v137, v137
    v_sub_f32 v138, v138, v3
    v_exp_f32 v138, v138
    v_smfmac_f32_32x32x32_bf16 v[184:199], v[116:119], v[160:167], v7
    v_sub_f32 v139, v139, v3
    v_exp_f32 v139, v139
    v_sub_f32 v140, v140, v3
    v_exp_f32 v140, v140
    v_sub_f32 v141, v141, v3
    v_exp_f32 v141, v141
    v_mfma_f32_32x32x16_bf16 v[152:167], v[68:71], v[28:31], 0
    v_sub_f32 v142, v142, v3
    v_exp_f32 v142, v142
    v_sub_f32 v143, v143, v3
    v_exp_f32 v143, v143
    s_waitcnt lgkmcnt(0)
    v_cmp_gt_u32 vcc, 3, v22
    s_cbranch_vccnz K2_RDS3
K2_CDS3:
    ds_read_b128 v[232:235], v14 offset:0
    ds_read_b128 v[236:239], v14 offset:512
    v_sub_f32 v144, v144, v3
    v_exp_f32 v144, v144
    v_sub_f32 v145, v145, v3
    v_exp_f32 v145, v145
    ds_read_b128 v[28:31], v17 offset:4096
    ds_read_b32 v2, v1 offset:512
    v_sub_f32 v146, v146, v3
    v_exp_f32 v146, v146
    v_smfmac_f32_32x32x32_bf16 v[184:199], v[120:123], v[136:143], v7
    v_sub_f32 v147, v147, v3
    v_exp_f32 v147, v147
    v_sub_f32 v148, v148, v3
    v_exp_f32 v148, v148
    s_cmp_lg_u32 s20, 4
    s_cbranch_scc1 K2_PBS30
    buffer_load_dword v5, v6, s[40:43], s60 offen
K2_PBS30:
    v_sub_f32 v149, v149, v3
    v_exp_f32 v149, v149
    v_sub_f32 v150, v150, v3
    v_exp_f32 v150, v150
    s_waitcnt lgkmcnt(0)
    s_waitcnt vmcnt(5)
    v_mfma_f32_16x16x32_bf16 v[240:243], v[200:203], v[232:235], v[240:243]
    v_sub_f32 v151, v151, v3
    v_exp_f32 v151, v151
    s_setprio 0
    v_sub_f32 v152, v152, v3
    v_exp_f32 v152, v152
    v_sub_f32 v153, v153, v3
    v_exp_f32 v153, v153
    v_sub_f32 v154, v154, v3
    v_exp_f32 v154, v154
    v_smfmac_f32_32x32x32_bf16 v[184:199], v[124:127], v[144:151], v7
    v_sub_f32 v155, v155, v3
    v_exp_f32 v155, v155
    v_sub_f32 v156, v156, v3
    v_exp_f32 v156, v156
    v_sub_f32 v157, v157, v3
    v_exp_f32 v157, v157
    s_waitcnt lgkmcnt(0)
    v_mfma_f32_32x32x16_bf16 v[136:151], v[40:43], v[28:31], 0
    v_sub_f32 v158, v158, v3
    v_exp_f32 v158, v158
    v_sub_f32 v159, v159, v3
    v_exp_f32 v159, v159
    s_mov_b32 s46, 135168
    buffer_load_dwordx4 v[228:231], v15, s[32:35], s46 offen offset:3072
    v_sub_f32 v160, v160, v3
    v_exp_f32 v160, v160
    v_mfma_f32_16x16x32_bf16 v[244:247], v[204:207], v[232:235], v[244:247]
    v_sub_f32 v161, v161, v3
    v_exp_f32 v161, v161
    v_sub_f32 v162, v162, v3
    v_exp_f32 v162, v162
    v_smfmac_f32_32x32x32_bf16 v[184:199], v[128:131], v[152:159], v7
    v_sub_f32 v163, v163, v3
    v_exp_f32 v163, v163
    v_sub_f32 v164, v164, v3
    v_exp_f32 v164, v164
    v_sub_f32 v165, v165, v3
    v_exp_f32 v165, v165
    v_sub_f32 v166, v166, v3
    v_exp_f32 v166, v166
    s_waitcnt vmcnt(3)
    v_mfma_f32_16x16x32_bf16 v[248:251], v[208:211], v[232:235], v[248:251]
    v_sub_f32 v167, v167, v3
    v_exp_f32 v167, v167
    s_setprio 3
    v_sub_f32 v136, v136, v2
    v_exp_f32 v136, v136
    v_sub_f32 v137, v137, v2
    v_exp_f32 v137, v137
    v_sub_f32 v138, v138, v2
    v_exp_f32 v138, v138
    v_smfmac_f32_32x32x32_bf16 v[184:199], v[132:135], v[160:167], v7
    v_sub_f32 v139, v139, v2
    v_exp_f32 v139, v139
    v_sub_f32 v140, v140, v2
    v_exp_f32 v140, v140
    v_sub_f32 v141, v141, v2
    v_exp_f32 v141, v141
    v_mfma_f32_32x32x16_bf16 v[152:167], v[44:47], v[28:31], 0
    v_sub_f32 v142, v142, v2
    v_exp_f32 v142, v142
    v_sub_f32 v143, v143, v2
    v_exp_f32 v143, v143
    v_sub_f32 v144, v144, v2
    v_exp_f32 v144, v144
    v_mfma_f32_16x16x32_bf16 v[252:255], v[212:215], v[232:235], v[252:255]
    v_sub_f32 v145, v145, v2
    v_exp_f32 v145, v145
    v_sub_f32 v146, v146, v2
    v_exp_f32 v146, v146
    v_smfmac_f32_32x32x32_bf16 v[168:183], v[72:75], v[136:143], v7
    v_sub_f32 v147, v147, v2
    v_exp_f32 v147, v147
    v_sub_f32 v148, v148, v2
    v_exp_f32 v148, v148
    s_cmp_lg_u32 s20, 5
    s_cbranch_scc1 K2_PBS32
    buffer_load_dword v5, v6, s[40:43], s60 offen
K2_PBS32:
    v_sub_f32 v149, v149, v2
    v_exp_f32 v149, v149
    v_sub_f32 v150, v150, v2
    v_exp_f32 v150, v150
    s_waitcnt vmcnt(2)
    v_mfma_f32_16x16x32_bf16 v[240:243], v[216:219], v[236:239], v[240:243]
    v_sub_f32 v151, v151, v2
    v_exp_f32 v151, v151
    s_setprio 2
    v_mov_b32 v23, 4
    v_sub_f32 v152, v152, v2
    v_exp_f32 v152, v152
    ds_write_b128 v9, v[184:187]
    v_sub_f32 v153, v153, v2
    v_exp_f32 v153, v153
    v_sub_f32 v154, v154, v2
    v_exp_f32 v154, v154
    v_smfmac_f32_32x32x32_bf16 v[168:183], v[76:79], v[144:151], v7
    ds_write_b128 v9, v[188:191] offset:1024
    v_sub_f32 v155, v155, v2
    v_exp_f32 v155, v155
    v_sub_f32 v156, v156, v2
    v_exp_f32 v156, v156
    ds_write_b32 v10, v192
    v_sub_f32 v157, v157, v2
    v_exp_f32 v157, v157
    v_mfma_f32_32x32x16_bf16 v[136:151], v[48:51], v[28:31], 0
    v_sub_f32 v158, v158, v2
    v_exp_f32 v158, v158
    ds_write_b32 v21, v23
    v_sub_f32 v159, v159, v2
    v_exp_f32 v159, v159
    v_sub_f32 v160, v160, v2
    v_exp_f32 v160, v160
    v_mfma_f32_16x16x32_bf16 v[244:247], v[220:223], v[236:239], v[244:247]
    v_sub_f32 v161, v161, v2
    v_exp_f32 v161, v161
    v_sub_f32 v162, v162, v2
    v_exp_f32 v162, v162
    v_smfmac_f32_32x32x32_bf16 v[168:183], v[80:83], v[152:159], v7
    v_sub_f32 v163, v163, v2
    v_exp_f32 v163, v163
    v_sub_f32 v164, v164, v2
    v_exp_f32 v164, v164
    s_mov_b32 s46, 196608
    buffer_load_dwordx4 v[200:203], v15, s[32:35], s46 offen offset:0
    v_sub_f32 v165, v165, v2
    v_exp_f32 v165, v165
    v_sub_f32 v166, v166, v2
    v_exp_f32 v166, v166
    s_waitcnt vmcnt(2)
    v_mfma_f32_16x16x32_bf16 v[248:251], v[224:227], v[236:239], v[248:251]
    v_sub_f32 v167, v167, v2
    v_exp_f32 v167, v167
    s_setprio 1
    v_sub_f32 v136, v136, v2
    v_exp_f32 v136, v136
    v_sub_f32 v137, v137, v2
    v_exp_f32 v137, v137
    v_sub_f32 v138, v138, v2
    v_exp_f32 v138, v138
    v_smfmac_f32_32x32x32_bf16 v[168:183], v[84:87], v[160:167], v7
    v_sub_f32 v139, v139, v2
    v_exp_f32 v139, v139
    v_sub_f32 v140, v140, v2
    v_exp_f32 v140, v140
    v_sub_f32 v141, v141, v2
    v_exp_f32 v141, v141
    v_mfma_f32_32x32x16_bf16 v[152:167], v[52:55], v[28:31], 0
    v_sub_f32 v142, v142, v2
    v_exp_f32 v142, v142
    v_sub_f32 v143, v143, v2
    v_exp_f32 v143, v143
    v_sub_f32 v144, v144, v2
    v_exp_f32 v144, v144
    s_waitcnt vmcnt(1)
    v_mfma_f32_16x16x32_bf16 v[252:255], v[228:231], v[236:239], v[252:255]
    v_sub_f32 v145, v145, v2
    v_exp_f32 v145, v145
    v_sub_f32 v146, v146, v2
    v_exp_f32 v146, v146
    v_smfmac_f32_32x32x32_bf16 v[168:183], v[88:91], v[136:143], v7
    v_sub_f32 v147, v147, v2
    v_exp_f32 v147, v147
    v_sub_f32 v148, v148, v2
    v_exp_f32 v148, v148
    s_waitcnt lgkmcnt(0)
    s_mov_b32 s46, 196608
    buffer_load_dwordx4 v[204:207], v15, s[32:35], s46 offen offset:1024
    v_sub_f32 v149, v149, v2
    v_exp_f32 v149, v149
    v_sub_f32 v150, v150, v2
    v_exp_f32 v150, v150
    v_sub_f32 v151, v151, v2
    v_exp_f32 v151, v151
    s_setprio 0
    ds_read_b32 v22, v19
    v_sub_f32 v152, v152, v2
    v_exp_f32 v152, v152
    v_sub_f32 v153, v153, v2
    v_exp_f32 v153, v153
    v_sub_f32 v154, v154, v2
    v_exp_f32 v154, v154
    v_smfmac_f32_32x32x32_bf16 v[168:183], v[92:95], v[144:151], v7
    v_sub_f32 v155, v155, v2
    v_exp_f32 v155, v155
    v_sub_f32 v156, v156, v2
    v_exp_f32 v156, v156
    v_sub_f32 v157, v157, v2
    v_exp_f32 v157, v157
    v_mfma_f32_32x32x16_bf16 v[136:151], v[56:59], v[28:31], 0
    v_sub_f32 v158, v158, v2
    v_exp_f32 v158, v158
    s_cmp_lg_u32 s47, 1
    s_cbranch_scc1 K2_NAS4
    s_waitcnt lgkmcnt(0)
    v_cmp_gt_u32 vcc, 4, v22
    s_cbranch_vccnz K2_RAS4
K2_CAS4:
    ds_read_b128 v[32:35], v12
    ds_read_b128 v[36:39], v12 offset:16
    ds_read_b64 v[216:217], v11 offset:0
    ds_read_b64 v[218:219], v11 offset:2048
    ds_read_b64 v[220:221], v11 offset:4096
    ds_read_b64 v[222:223], v11 offset:6144
    ds_read_b64 v[224:225], v11 offset:8192
    ds_read_b64 v[226:227], v11 offset:10240
    ds_read_b64 v[228:229], v11 offset:12288
    ds_read_b64 v[230:231], v11 offset:14336
K2_NAS4:
    v_sub_f32 v159, v159, v2
    v_exp_f32 v159, v159
    v_sub_f32 v160, v160, v2
    v_exp_f32 v160, v160
    v_mfma_f32_32x32x16_bf16 v[184:199], v[24:27], v[24:27], 0
    v_sub_f32 v161, v161, v2
    v_exp_f32 v161, v161
    v_sub_f32 v162, v162, v2
    v_exp_f32 v162, v162
    v_sub_f32 v163, v163, v2
    v_exp_f32 v163, v163
    v_smfmac_f32_32x32x32_bf16 v[168:183], v[96:99], v[152:159], v7
    v_sub_f32 v164, v164, v2
    v_exp_f32 v164, v164
    s_mov_b32 s46, 196608
    buffer_load_dwordx4 v[208:211], v15, s[32:35], s46 offen offset:2048
    v_sub_f32 v165, v165, v2
    v_exp_f32 v165, v165
    v_sub_f32 v166, v166, v2
    v_exp_f32 v166, v166
    v_sub_f32 v167, v167, v2
    v_exp_f32 v167, v167
    s_setprio 3
    v_sub_f32 v136, v136, v2
    v_exp_f32 v136, v136
    v_sub_f32 v137, v137, v2
    v_exp_f32 v137, v137
    v_sub_f32 v138, v138, v2
    v_exp_f32 v138, v138
    v_smfmac_f32_32x32x32_bf16 v[168:183], v[100:103], v[160:167], v7
    s_cmp_lg_u32 s47, 1
    s_cbranch_scc1 K2_NBS4
    s_waitcnt lgkmcnt(0)
    v_pk_add_f32 v[32:33], v[32:33], v[34:35]
    v_pk_add_f32 v[36:37], v[36:37], v[38:39]
    v_pk_add_f32 v[216:217], v[216:217], v[218:219]
    v_pk_add_f32 v[220:221], v[220:221], v[222:223]
    v_pk_add_f32 v[224:225], v[224:225], v[226:227]
    v_pk_add_f32 v[228:229], v[228:229], v[230:231]
    v_pk_add_f32 v[32:33], v[32:33], v[36:37]
    v_pk_add_f32 v[216:217], v[216:217], v[220:221]
    v_add_f32 v32, v32, v33
    v_pk_add_f32 v[224:225], v[224:225], v[228:229]
    v_rcp_f32 v32, v32
    v_pk_add_f32 v[216:217], v[216:217], v[224:225]
    v_pk_mul_f32 v[216:217], v[216:217], v[32:33] op_sel_hi:[1,0]
    v_cvt_pk_bf16_f32 v216, v216, v217
    ds_write_b32 v13, v216
    ds_write_b32 v21, v23 offset:32
K2_NBS4:
    v_sub_f32 v139, v139, v2
    v_exp_f32 v139, v139
    s_add_u32 s22, s61, 0
    s_and_b32 s22, s22, 15
    s_mul_i32 s22, s22, 44032
    s_add_u32 m0, s7, 0
    s_nop 0
    buffer_load_dwordx4 v18, s[56:59], s22 offen offset:0 lds
    v_sub_f32 v140, v140, v2
    v_exp_f32 v140, v140
    v_sub_f32 v141, v141, v2
    v_exp_f32 v141, v141
    v_mfma_f32_32x32x16_bf16 v[152:167], v[60:63], v[28:31], 0
    v_sub_f32 v142, v142, v2
    v_exp_f32 v142, v142
    v_sub_f32 v143, v143, v2
    v_exp_f32 v143, v143
    s_mov_b32 s46, 200704
    buffer_load_dwordx4 v[216:219], v15, s[32:35], s46 offen offset:0
    v_sub_f32 v144, v144, v2
    v_exp_f32 v144, v144
    v_sub_f32 v145, v145, v2
    v_exp_f32 v145, v145
    v_sub_f32 v146, v146, v2
    v_exp_f32 v146, v146
    v_smfmac_f32_32x32x32_bf16 v[168:183], v[104:107], v[136:143], v7
    v_sub_f32 v147, v147, v2
    v_exp_f32 v147, v147
    v_sub_f32 v148, v148, v2
    v_exp_f32 v148, v148
    s_mov_b32 s46, 196608
    buffer_load_dwordx4 v[212:215], v15, s[32:35], s46 offen offset:3072
    v_sub_f32 v149, v149, v2
    v_exp_f32 v149, v149
    v_sub_f32 v150, v150, v2
    v_exp_f32 v150, v150
    v_sub_f32 v151, v151, v2
    v_exp_f32 v151, v151
    s_setprio 2
    v_sub_f32 v152, v152, v2
    v_exp_f32 v152, v152
    v_sub_f32 v153, v153, v2
    v_exp_f32 v153, v153
    v_sub_f32 v154, v154, v2
    v_exp_f32 v154, v154
    v_smfmac_f32_32x32x32_bf16 v[168:183], v[108:111], v[144:151], v7
    v_sub_f32 v155, v155, v2
    v_exp_f32 v155, v155
    v_sub_f32 v156, v156, v2
    v_exp_f32 v156, v156
    v_sub_f32 v157, v157, v2
    v_exp_f32 v157, v157
    v_mfma_f32_32x32x16_bf16 v[136:151], v[64:67], v[28:31], 0
    v_sub_f32 v158, v158, v2
    v_exp_f32 v158, v158
    v_sub_f32 v159, v159, v2
    v_exp_f32 v159, v159
    s_mov_b32 s46, 200704
    buffer_load_dwordx4 v[220:223], v15, s[32:35], s46 offen offset:1024
    v_sub_f32 v160, v160, v2
    v_exp_f32 v160, v160
    v_sub_f32 v161, v161, v2
    v_exp_f32 v161, v161
    v_sub_f32 v162, v162, v2
    v_exp_f32 v162, v162
    v_smfmac_f32_32x32x32_bf16 v[168:183], v[112:115], v[152:159], v7
    v_sub_f32 v163, v163, v2
    v_exp_f32 v163, v163
    v_sub_f32 v164, v164, v2
    v_exp_f32 v164, v164
    v_sub_f32 v165, v165, v2
    v_exp_f32 v165, v165
    v_sub_f32 v166, v166, v2
    v_exp_f32 v166, v166
    v_sub_f32 v167, v167, v2
    v_exp_f32 v167, v167
    s_setprio 1
    v_sub_f32 v136, v136, v2
    v_exp_f32 v136, v136
    s_mov_b32 s46, 200704
    buffer_load_dwordx4 v[224:227], v15, s[32:35], s46 offen offset:2048
    ds_read_b32 v22, v20 offset:16
    v_sub_f32 v137, v137, v2
    v_exp_f32 v137, v137
    v_sub_f32 v138, v138, v2
    v_exp_f32 v138, v138
    v_smfmac_f32_32x32x32_bf16 v[168:183], v[116:119], v[160:167], v7
    v_sub_f32 v139, v139, v2
    v_exp_f32 v139, v139
    s_add_u32 s22, s61, 0
    s_and_b32 s22, s22, 15
    s_mul_i32 s22, s22, 44032
    s_add_u32 m0, s7, 960
    s_nop 0
    buffer_load_dwordx4 v18, s[56:59], s22 offen offset:64 lds
    v_sub_f32 v140, v140, v2
    v_exp_f32 v140, v140
    v_sub_f32 v141, v141, v2
    v_exp_f32 v141, v141
    v_mfma_f32_32x32x16_bf16 v[152:167], v[68:71], v[28:31], 0
    v_sub_f32 v142, v142, v2
    v_exp_f32 v142, v142
    v_sub_f32 v143, v143, v2
    v_exp_f32 v143, v143
    s_waitcnt lgkmcnt(0)
    v_cmp_gt_u32 vcc, 4, v22
    s_cbranch_vccnz K2_RDS4
K2_CDS4:
    ds_read_b128 v[232:235], v14 offset:0
    ds_read_b128 v[236:239], v14 offset:512
    v_sub_f32 v144, v144, v2
    v_exp_f32 v144, v144
    v_sub_f32 v145, v145, v2
    v_exp_f32 v145, v145
    ds_read_b128 v[28:31], v17 offset:5120
    ds_read_b32 v3, v1 offset:640
    v_sub_f32 v146, v146, v2
    v_exp_f32 v146, v146
    v_smfmac_f32_32x32x32_bf16 v[168:183], v[120:123], v[136:143], v7
    v_sub_f32 v147, v147, v2
    v_exp_f32 v147, v147
    v_sub_f32 v148, v148, v2
    v_exp_f32 v148, v148
    v_sub_f32 v149, v149, v2
    v_exp_f32 v149, v149
    v_sub_f32 v150, v150, v2
    v_exp_f32 v150, v150
    s_waitcnt lgkmcnt(0)
    s_waitcnt vmcnt(7)
    v_mfma_f32_16x16x32_bf16 v[240:243], v[200:203], v[232:235], v[240:243]
    v_sub_f32 v151, v151, v2
    v_exp_f32 v151, v151
    s_setprio 0
    v_sub_f32 v152, v152, v2
    v_exp_f32 v152, v152
    v_sub_f32 v153, v153, v2
    v_exp_f32 v153, v153
    v_sub_f32 v154, v154, v2
    v_exp_f32 v154, v154
    v_smfmac_f32_32x32x32_bf16 v[168:183], v[124:127], v[144:151], v7
    v_sub_f32 v155, v155, v2
    v_exp_f32 v155, v155
    v_sub_f32 v156, v156, v2
    v_exp_f32 v156, v156
    v_sub_f32 v157, v157, v2
    v_exp_f32 v157, v157
    s_waitcnt lgkmcnt(0)
    v_mfma_f32_32x32x16_bf16 v[136:151], v[40:43], v[28:31], 0
    v_sub_f32 v158, v158, v2
    v_exp_f32 v158, v158
    v_sub_f32 v159, v159, v2
    v_exp_f32 v159, v159
    s_mov_b32 s46, 200704
    buffer_load_dwordx4 v[228:231], v15, s[32:35], s46 offen offset:3072
    v_sub_f32 v160, v160, v2
    v_exp_f32 v160, v160
    v_mfma_f32_16x16x32_bf16 v[244:247], v[204:207], v[232:235], v[244:247]
    v_sub_f32 v161, v161, v2
    v_exp_f32 v161, v161
    v_sub_f32 v162, v162, v2
    v_exp_f32 v162, v162
    v_smfmac_f32_32x32x32_bf16 v[168:183], v[128:131], v[152:159], v7
    v_sub_f32 v163, v163, v2
    v_exp_f32 v163, v163
    v_sub_f32 v164, v164, v2
    v_exp_f32 v164, v164
    v_sub_f32 v165, v165, v2
    v_exp_f32 v165, v165
    v_sub_f32 v166, v166, v2
    v_exp_f32 v166, v166
    s_waitcnt vmcnt(4)
    v_mfma_f32_16x16x32_bf16 v[248:251], v[208:211], v[232:235], v[248:251]
    v_sub_f32 v167, v167, v2
    v_exp_f32 v167, v167
    s_setprio 3
    v_sub_f32 v136, v136, v3
    v_exp_f32 v136, v136
    v_sub_f32 v137, v137, v3
    v_exp_f32 v137, v137
    v_sub_f32 v138, v138, v3
    v_exp_f32 v138, v138
    v_smfmac_f32_32x32x32_bf16 v[168:183], v[132:135], v[160:167], v7
    v_sub_f32 v139, v139, v3
    v_exp_f32 v139, v139
    s_add_u32 s22, s61, 0
    s_and_b32 s22, s22, 15
    s_mul_i32 s22, s22, 44032
    s_add_u32 m0, s7, 1920
    s_nop 0
    buffer_load_dwordx4 v18, s[56:59], s22 offen offset:128 lds
    v_sub_f32 v140, v140, v3
    v_exp_f32 v140, v140
    v_sub_f32 v141, v141, v3
    v_exp_f32 v141, v141
    v_mfma_f32_32x32x16_bf16 v[152:167], v[44:47], v[28:31], 0
    v_sub_f32 v142, v142, v3
    v_exp_f32 v142, v142
    v_sub_f32 v143, v143, v3
    v_exp_f32 v143, v143
    v_sub_f32 v144, v144, v3
    v_exp_f32 v144, v144
    v_mfma_f32_16x16x32_bf16 v[252:255], v[212:215], v[232:235], v[252:255]
    v_sub_f32 v145, v145, v3
    v_exp_f32 v145, v145
    v_sub_f32 v146, v146, v3
    v_exp_f32 v146, v146
    v_smfmac_f32_32x32x32_bf16 v[184:199], v[72:75], v[136:143], v7
    v_sub_f32 v147, v147, v3
    v_exp_f32 v147, v147
    v_sub_f32 v148, v148, v3
    v_exp_f32 v148, v148
    v_sub_f32 v149, v149, v3
    v_exp_f32 v149, v149
    v_sub_f32 v150, v150, v3
    v_exp_f32 v150, v150
    s_waitcnt vmcnt(4)
    v_mfma_f32_16x16x32_bf16 v[240:243], v[216:219], v[236:239], v[240:243]
    v_sub_f32 v151, v151, v3
    v_exp_f32 v151, v151
    s_setprio 2
    v_mov_b32 v23, 5
    v_sub_f32 v152, v152, v3
    v_exp_f32 v152, v152
    ds_write_b128 v9, v[168:171]
    v_sub_f32 v153, v153, v3
    v_exp_f32 v153, v153
    v_sub_f32 v154, v154, v3
    v_exp_f32 v154, v154
    v_smfmac_f32_32x32x32_bf16 v[184:199], v[76:79], v[144:151], v7
    ds_write_b128 v9, v[172:175] offset:1024
    v_sub_f32 v155, v155, v3
    v_exp_f32 v155, v155
    v_sub_f32 v156, v156, v3
    v_exp_f32 v156, v156
    ds_write_b32 v10, v176
    v_sub_f32 v157, v157, v3
    v_exp_f32 v157, v157
    v_mfma_f32_32x32x16_bf16 v[136:151], v[48:51], v[28:31], 0
    v_sub_f32 v158, v158, v3
    v_exp_f32 v158, v158
    ds_write_b32 v21, v23
    v_sub_f32 v159, v159, v3
    v_exp_f32 v159, v159
    v_sub_f32 v160, v160, v3
    v_exp_f32 v160, v160
    v_mfma_f32_16x16x32_bf16 v[244:247], v[220:223], v[236:239], v[244:247]
    v_sub_f32 v161, v161, v3
    v_exp_f32 v161, v161
    v_sub_f32 v162, v162, v3
    v_exp_f32 v162, v162
    v_smfmac_f32_32x32x32_bf16 v[184:199], v[80:83], v[152:159], v7
    v_sub_f32 v163, v163, v3
    v_exp_f32 v163, v163
    v_sub_f32 v164, v164, v3
    v_exp_f32 v164, v164
    s_mov_b32 s46, 262144
    buffer_load_dwordx4 v[200:203], v15, s[32:35], s46 offen offset:0
    v_sub_f32 v165, v165, v3
    v_exp_f32 v165, v165
    v_sub_f32 v166, v166, v3
    v_exp_f32 v166, v166
    s_waitcnt vmcnt(4)
    v_mfma_f32_16x16x32_bf16 v[248:251], v[224:227], v[236:239], v[248:251]
    v_sub_f32 v167, v167, v3
    v_exp_f32 v167, v167
    s_setprio 1
    v_sub_f32 v136, v136, v3
    v_exp_f32 v136, v136
    v_sub_f32 v137, v137, v3
    v_exp_f32 v137, v137
    v_sub_f32 v138, v138, v3
    v_exp_f32 v138, v138
    v_smfmac_f32_32x32x32_bf16 v[184:199], v[84:87], v[160:167], v7
    v_sub_f32 v139, v139, v3
    v_exp_f32 v139, v139
    s_add_u32 s22, s61, 1
    s_and_b32 s22, s22, 15
    s_mul_i32 s22, s22, 44032
    s_add_u32 m0, s7, 3072
    s_nop 0
    buffer_load_dwordx4 v18, s[56:59], s22 offen offset:0 lds
    v_sub_f32 v140, v140, v3
    v_exp_f32 v140, v140
    v_sub_f32 v141, v141, v3
    v_exp_f32 v141, v141
    v_mfma_f32_32x32x16_bf16 v[152:167], v[52:55], v[28:31], 0
    v_sub_f32 v142, v142, v3
    v_exp_f32 v142, v142
    v_sub_f32 v143, v143, v3
    v_exp_f32 v143, v143
    v_sub_f32 v144, v144, v3
    v_exp_f32 v144, v144
    s_waitcnt vmcnt(3)
    v_mfma_f32_16x16x32_bf16 v[252:255], v[228:231], v[236:239], v[252:255]
    v_sub_f32 v145, v145, v3
    v_exp_f32 v145, v145
    v_sub_f32 v146, v146, v3
    v_exp_f32 v146, v146
    v_smfmac_f32_32x32x32_bf16 v[184:199], v[88:91], v[136:143], v7
    v_sub_f32 v147, v147, v3
    v_exp_f32 v147, v147
    v_sub_f32 v148, v148, v3
    v_exp_f32 v148, v148
    s_waitcnt lgkmcnt(0)
    s_mov_b32 s46, 262144
    buffer_load_dwordx4 v[204:207], v15, s[32:35], s46 offen offset:1024
    v_sub_f32 v149, v149, v3
    v_exp_f32 v149, v149
    v_sub_f32 v150, v150, v3
    v_exp_f32 v150, v150
    v_sub_f32 v151, v151, v3
    v_exp_f32 v151, v151
    s_setprio 0
    ds_read_b32 v22, v19
    v_sub_f32 v152, v152, v3
    v_exp_f32 v152, v152
    v_sub_f32 v153, v153, v3
    v_exp_f32 v153, v153
    v_sub_f32 v154, v154, v3
    v_exp_f32 v154, v154
    v_smfmac_f32_32x32x32_bf16 v[184:199], v[92:95], v[144:151], v7
    v_sub_f32 v155, v155, v3
    v_exp_f32 v155, v155
    v_sub_f32 v156, v156, v3
    v_exp_f32 v156, v156
    v_sub_f32 v157, v157, v3
    v_exp_f32 v157, v157
    v_mfma_f32_32x32x16_bf16 v[136:151], v[56:59], v[28:31], 0
    v_sub_f32 v158, v158, v3
    v_exp_f32 v158, v158
    s_cmp_lg_u32 s47, 0
    s_cbranch_scc1 K2_NAS5
    s_waitcnt lgkmcnt(0)
    v_cmp_gt_u32 vcc, 5, v22
    s_cbranch_vccnz K2_RAS5
K2_CAS5:
    ds_read_b128 v[32:35], v12
    ds_read_b128 v[36:39], v12 offset:16
    ds_read_b64 v[216:217], v11 offset:0
    ds_read_b64 v[218:219], v11 offset:2048
    ds_read_b64 v[220:221], v11 offset:4096
    ds_read_b64 v[222:223], v11 offset:6144
    ds_read_b64 v[224:225], v11 offset:8192
    ds_read_b64 v[226:227], v11 offset:10240
    ds_read_b64 v[228:229], v11 offset:12288
    ds_read_b64 v[230:231], v11 offset:14336
K2_NAS5:
    v_sub_f32 v159, v159, v3
    v_exp_f32 v159, v159
    v_sub_f32 v160, v160, v3
    v_exp_f32 v160, v160
    v_mfma_f32_32x32x16_bf16 v[168:183], v[24:27], v[24:27], 0
    v_sub_f32 v161, v161, v3
    v_exp_f32 v161, v161
    v_sub_f32 v162, v162, v3
    v_exp_f32 v162, v162
    v_sub_f32 v163, v163, v3
    v_exp_f32 v163, v163
    v_smfmac_f32_32x32x32_bf16 v[184:199], v[96:99], v[152:159], v7
    v_sub_f32 v164, v164, v3
    v_exp_f32 v164, v164
    s_mov_b32 s46, 262144
    buffer_load_dwordx4 v[208:211], v15, s[32:35], s46 offen offset:2048
    v_sub_f32 v165, v165, v3
    v_exp_f32 v165, v165
    v_sub_f32 v166, v166, v3
    v_exp_f32 v166, v166
    v_sub_f32 v167, v167, v3
    v_exp_f32 v167, v167
    s_setprio 3
    v_sub_f32 v136, v136, v3
    v_exp_f32 v136, v136
    v_sub_f32 v137, v137, v3
    v_exp_f32 v137, v137
    v_sub_f32 v138, v138, v3
    v_exp_f32 v138, v138
    v_smfmac_f32_32x32x32_bf16 v[184:199], v[100:103], v[160:167], v7
    s_cmp_lg_u32 s47, 0
    s_cbranch_scc1 K2_NBS5
    s_waitcnt lgkmcnt(0)
    v_pk_add_f32 v[32:33], v[32:33], v[34:35]
    v_pk_add_f32 v[36:37], v[36:37], v[38:39]
    v_pk_add_f32 v[216:217], v[216:217], v[218:219]
    v_pk_add_f32 v[220:221], v[220:221], v[222:223]
    v_pk_add_f32 v[224:225], v[224:225], v[226:227]
    v_pk_add_f32 v[228:229], v[228:229], v[230:231]
    v_pk_add_f32 v[32:33], v[32:33], v[36:37]
    v_pk_add_f32 v[216:217], v[216:217], v[220:221]
    v_add_f32 v32, v32, v33
    v_pk_add_f32 v[224:225], v[224:225], v[228:229]
    v_rcp_f32 v32, v32
    v_pk_add_f32 v[216:217], v[216:217], v[224:225]
    v_pk_mul_f32 v[216:217], v[216:217], v[32:33] op_sel_hi:[1,0]
    v_cvt_pk_bf16_f32 v216, v216, v217
    ds_write_b32 v13, v216
    ds_write_b32 v21, v23 offset:32
K2_NBS5:
    v_sub_f32 v139, v139, v3
    v_exp_f32 v139, v139
    s_add_u32 s22, s61, 1
    s_and_b32 s22, s22, 15
    s_mul_i32 s22, s22, 44032
    s_add_u32 m0, s7, 4032
    s_nop 0
    buffer_load_dwordx4 v18, s[56:59], s22 offen offset:64 lds
    v_sub_f32 v140, v140, v3
    v_exp_f32 v140, v140
    v_sub_f32 v141, v141, v3
    v_exp_f32 v141, v141
    v_mfma_f32_32x32x16_bf16 v[152:167], v[60:63], v[28:31], 0
    v_sub_f32 v142, v142, v3
    v_exp_f32 v142, v142
    v_sub_f32 v143, v143, v3
    v_exp_f32 v143, v143
    s_mov_b32 s46, 266240
    buffer_load_dwordx4 v[216:219], v15, s[32:35], s46 offen offset:0
    v_sub_f32 v144, v144, v3
    v_exp_f32 v144, v144
    v_sub_f32 v145, v145, v3
    v_exp_f32 v145, v145
    v_sub_f32 v146, v146, v3
    v_exp_f32 v146, v146
    v_smfmac_f32_32x32x32_bf16 v[184:199], v[104:107], v[136:143], v7
    v_sub_f32 v147, v147, v3
    v_exp_f32 v147, v147
    v_sub_f32 v148, v148, v3
    v_exp_f32 v148, v148
    s_mov_b32 s46, 262144
    buffer_load_dwordx4 v[212:215], v15, s[32:35], s46 offen offset:3072
    v_sub_f32 v149, v149, v3
    v_exp_f32 v149, v149
    v_sub_f32 v150, v150, v3
    v_exp_f32 v150, v150
    v_sub_f32 v151, v151, v3
    v_exp_f32 v151, v151
    s_setprio 2
    v_sub_f32 v152, v152, v3
    v_exp_f32 v152, v152
    v_sub_f32 v153, v153, v3
    v_exp_f32 v153, v153
    v_sub_f32 v154, v154, v3
    v_exp_f32 v154, v154
    v_smfmac_f32_32x32x32_bf16 v[184:199], v[108:111], v[144:151], v7
    v_sub_f32 v155, v155, v3
    v_exp_f32 v155, v155
    v_sub_f32 v156, v156, v3
    v_exp_f32 v156, v156
    v_sub_f32 v157, v157, v3
    v_exp_f32 v157, v157
    v_mfma_f32_32x32x16_bf16 v[136:151], v[64:67], v[28:31], 0
    v_sub_f32 v158, v158, v3
    v_exp_f32 v158, v158
    v_sub_f32 v159, v159, v3
    v_exp_f32 v159, v159
    s_mov_b32 s46, 266240
    buffer_load_dwordx4 v[220:223], v15, s[32:35], s46 offen offset:1024
    v_sub_f32 v160, v160, v3
    v_exp_f32 v160, v160
    v_sub_f32 v161, v161, v3
    v_exp_f32 v161, v161
    v_sub_f32 v162, v162, v3
    v_exp_f32 v162, v162
    v_smfmac_f32_32x32x32_bf16 v[184:199], v[112:115], v[152:159], v7
    v_sub_f32 v163, v163, v3
    v_exp_f32 v163, v163
    v_sub_f32 v164, v164, v3
    v_exp_f32 v164, v164
    v_sub_f32 v165, v165, v3
    v_exp_f32 v165, v165
    v_sub_f32 v166, v166, v3
    v_exp_f32 v166, v166
    v_sub_f32 v167, v167, v3
    v_exp_f32 v167, v167
    s_setprio 1
    v_sub_f32 v136, v136, v3
    v_exp_f32 v136, v136
    s_mov_b32 s46, 266240
    buffer_load_dwordx4 v[224:227], v15, s[32:35], s46 offen offset:2048
    ds_read_b32 v22, v20 offset:0
    v_sub_f32 v137, v137, v3
    v_exp_f32 v137, v137
    v_sub_f32 v138, v138, v3
    v_exp_f32 v138, v138
    v_smfmac_f32_32x32x32_bf16 v[184:199], v[116:119], v[160:167], v7
    v_sub_f32 v139, v139, v3
    v_exp_f32 v139, v139
    s_add_u32 s22, s61, 1
    s_and_b32 s22, s22, 15
    s_mul_i32 s22, s22, 44032
    s_add_u32 m0, s7, 4992
    s_nop 0
    buffer_load_dwordx4 v18, s[56:59], s22 offen offset:128 lds
    v_sub_f32 v140, v140, v3
    v_exp_f32 v140, v140
    v_sub_f32 v141, v141, v3
    v_exp_f32 v141, v141
    v_mfma_f32_32x32x16_bf16 v[152:167], v[68:71], v[28:31], 0
    v_sub_f32 v142, v142, v3
    v_exp_f32 v142, v142
    v_sub_f32 v143, v143, v3
    v_exp_f32 v143, v143
    s_waitcnt lgkmcnt(0)
    v_cmp_gt_u32 vcc, 5, v22
    s_cbranch_vccnz K2_RDS5
K2_CDS5:
    ds_read_b128 v[232:235], v14 offset:0
    ds_read_b128 v[236:239], v14 offset:512
    v_sub_f32 v144, v144, v3
    v_exp_f32 v144, v144
    v_sub_f32 v145, v145, v3
    v_exp_f32 v145, v145
    ds_read_b128 v[28:31], v17 offset:6144
    ds_read_b32 v2, v1 offset:768
    v_sub_f32 v146, v146, v3
    v_exp_f32 v146, v146
    v_smfmac_f32_32x32x32_bf16 v[184:199], v[120:123], v[136:143], v7
    v_sub_f32 v147, v147, v3
    v_exp_f32 v147, v147
    v_sub_f32 v148, v148, v3
    v_exp_f32 v148, v148
    v_sub_f32 v149, v149, v3
    v_exp_f32 v149, v149
    v_sub_f32 v150, v150, v3
    v_exp_f32 v150, v150
    s_waitcnt lgkmcnt(0)
    s_waitcnt vmcnt(7)
    v_mfma_f32_16x16x32_bf16 v[240:243], v[200:203], v[232:235], v[240:243]
    v_sub_f32 v151, v151, v3
    v_exp_f32 v151, v151
    s_setprio 0
    v_sub_f32 v152, v152, v3
    v_exp_f32 v152, v152
    v_sub_f32 v153, v153, v3
    v_exp_f32 v153, v153
    v_sub_f32 v154, v154, v3
    v_exp_f32 v154, v154
    v_smfmac_f32_32x32x32_bf16 v[184:199], v[124:127], v[144:151], v7
    v_sub_f32 v155, v155, v3
    v_exp_f32 v155, v155
    v_sub_f32 v156, v156, v3
    v_exp_f32 v156, v156
    v_sub_f32 v157, v157, v3
    v_exp_f32 v157, v157
    s_waitcnt lgkmcnt(0)
    v_mfma_f32_32x32x16_bf16 v[136:151], v[40:43], v[28:31], 0
    v_sub_f32 v158, v158, v3
    v_exp_f32 v158, v158
    v_sub_f32 v159, v159, v3
    v_exp_f32 v159, v159
    s_mov_b32 s46, 266240
    buffer_load_dwordx4 v[228:231], v15, s[32:35], s46 offen offset:3072
    v_sub_f32 v160, v160, v3
    v_exp_f32 v160, v160
    v_mfma_f32_16x16x32_bf16 v[244:247], v[204:207], v[232:235], v[244:247]
    v_sub_f32 v161, v161, v3
    v_exp_f32 v161, v161
    v_sub_f32 v162, v162, v3
    v_exp_f32 v162, v162
    v_smfmac_f32_32x32x32_bf16 v[184:199], v[128:131], v[152:159], v7
    v_sub_f32 v163, v163, v3
    v_exp_f32 v163, v163
    v_sub_f32 v164, v164, v3
    v_exp_f32 v164, v164
    v_sub_f32 v165, v165, v3
    v_exp_f32 v165, v165
    v_sub_f32 v166, v166, v3
    v_exp_f32 v166, v166
    s_waitcnt vmcnt(4)
    v_mfma_f32_16x16x32_bf16 v[248:251], v[208:211], v[232:235], v[248:251]
    v_sub_f32 v167, v167, v3
    v_exp_f32 v167, v167
    s_setprio 3
    v_sub_f32 v136, v136, v2
    v_exp_f32 v136, v136
    v_sub_f32 v137, v137, v2
    v_exp_f32 v137, v137
    v_sub_f32 v138, v138, v2
    v_exp_f32 v138, v138
    v_smfmac_f32_32x32x32_bf16 v[184:199], v[132:135], v[160:167], v7
    v_sub_f32 v139, v139, v2
    v_exp_f32 v139, v139
    s_add_u32 s22, s61, 2
    s_and_b32 s22, s22, 15
    s_mul_i32 s22, s22, 44032
    s_add_u32 m0, s7, 6144
    s_nop 0
    buffer_load_dwordx4 v18, s[56:59], s22 offen offset:0 lds
    v_sub_f32 v140, v140, v2
    v_exp_f32 v140, v140
    v_sub_f32 v141, v141, v2
    v_exp_f32 v141, v141
    v_mfma_f32_32x32x16_bf16 v[152:167], v[44:47], v[28:31], 0
    v_sub_f32 v142, v142, v2
    v_exp_f32 v142, v142
    v_sub_f32 v143, v143, v2
    v_exp_f32 v143, v143
    v_sub_f32 v144, v144, v2
    v_exp_f32 v144, v144
    v_mfma_f32_16x16x32_bf16 v[252:255], v[212:215], v[232:235], v[252:255]
    v_sub_f32 v145, v145, v2
    v_exp_f32 v145, v145
    v_sub_f32 v146, v146, v2
    v_exp_f32 v146, v146
    v_smfmac_f32_32x32x32_bf16 v[168:183], v[72:75], v[136:143], v7
    v_sub_f32 v147, v147, v2
    v_exp_f32 v147, v147
    v_sub_f32 v148, v148, v2
    v_exp_f32 v148, v148
    v_sub_f32 v149, v149, v2
    v_exp_f32 v149, v149
    v_sub_f32 v150, v150, v2
    v_exp_f32 v150, v150
    s_waitcnt vmcnt(4)
    v_mfma_f32_16x16x32_bf16 v[240:243], v[216:219], v[236:239], v[240:243]
    v_sub_f32 v151, v151, v2
    v_exp_f32 v151, v151
    s_setprio 2
    v_mov_b32 v23, 6
    v_sub_f32 v152, v152, v2
    v_exp_f32 v152, v152
    ds_write_b128 v9, v[184:187]
    v_sub_f32 v153, v153, v2
    v_exp_f32 v153, v153
    v_sub_f32 v154, v154, v2
    v_exp_f32 v154, v154
    v_smfmac_f32_32x32x32_bf16 v[168:183], v[76:79], v[144:151], v7
    ds_write_b128 v9, v[188:191] offset:1024
    v_sub_f32 v155, v155, v2
    v_exp_f32 v155, v155
    v_sub_f32 v156, v156, v2
    v_exp_f32 v156, v156
    ds_write_b32 v10, v192
    v_sub_f32 v157, v157, v2
    v_exp_f32 v157, v157
    v_mfma_f32_32x32x16_bf16 v[136:151], v[48:51], v[28:31], 0
    v_sub_f32 v158, v158, v2
    v_exp_f32 v158, v158
    ds_write_b32 v21, v23
    v_sub_f32 v159, v159, v2
    v_exp_f32 v159, v159
    v_sub_f32 v160, v160, v2
    v_exp_f32 v160, v160
    v_mfma_f32_16x16x32_bf16 v[244:247], v[220:223], v[236:239], v[244:247]
    v_sub_f32 v161, v161, v2
    v_exp_f32 v161, v161
    v_sub_f32 v162, v162, v2
    v_exp_f32 v162, v162
    v_smfmac_f32_32x32x32_bf16 v[168:183], v[80:83], v[152:159], v7
    v_sub_f32 v163, v163, v2
    v_exp_f32 v163, v163
    v_sub_f32 v164, v164, v2
    v_exp_f32 v164, v164
    s_mov_b32 s46, 327680
    buffer_load_dwordx4 v[200:203], v15, s[32:35], s46 offen offset:0
    v_sub_f32 v165, v165, v2
    v_exp_f32 v165, v165
    v_sub_f32 v166, v166, v2
    v_exp_f32 v166, v166
    s_waitcnt vmcnt(4)
    v_mfma_f32_16x16x32_bf16 v[248:251], v[224:227], v[236:239], v[248:251]
    v_sub_f32 v167, v167, v2
    v_exp_f32 v167, v167
    s_setprio 1
    v_sub_f32 v136, v136, v2
    v_exp_f32 v136, v136
    v_sub_f32 v137, v137, v2
    v_exp_f32 v137, v137
    v_sub_f32 v138, v138, v2
    v_exp_f32 v138, v138
    v_smfmac_f32_32x32x32_bf16 v[168:183], v[84:87], v[160:167], v7
    v_sub_f32 v139, v139, v2
    v_exp_f32 v139, v139
    s_add_u32 s22, s61, 2
    s_and_b32 s22, s22, 15
    s_mul_i32 s22, s22, 44032
    s_add_u32 m0, s7, 7104
    s_nop 0
    buffer_load_dwordx4 v18, s[56:59], s22 offen offset:64 lds
    v_sub_f32 v140, v140, v2
    v_exp_f32 v140, v140
    v_sub_f32 v141, v141, v2
    v_exp_f32 v141, v141
    v_mfma_f32_32x32x16_bf16 v[152:167], v[52:55], v[28:31], 0
    v_sub_f32 v142, v142, v2
    v_exp_f32 v142, v142
    v_sub_f32 v143, v143, v2
    v_exp_f32 v143, v143
    v_sub_f32 v144, v144, v2
    v_exp_f32 v144, v144
    s_waitcnt vmcnt(3)
    v_mfma_f32_16x16x32_bf16 v[252:255], v[228:231], v[236:239], v[252:255]
    v_sub_f32 v145, v145, v2
    v_exp_f32 v145, v145
    v_sub_f32 v146, v146, v2
    v_exp_f32 v146, v146
    v_smfmac_f32_32x32x32_bf16 v[168:183], v[88:91], v[136:143], v7
    v_sub_f32 v147, v147, v2
    v_exp_f32 v147, v147
    v_sub_f32 v148, v148, v2
    v_exp_f32 v148, v148
    s_waitcnt lgkmcnt(0)
    s_mov_b32 s46, 327680
    buffer_load_dwordx4 v[204:207], v15, s[32:35], s46 offen offset:1024
    v_sub_f32 v149, v149, v2
    v_exp_f32 v149, v149
    v_sub_f32 v150, v150, v2
    v_exp_f32 v150, v150
    v_sub_f32 v151, v151, v2
    v_exp_f32 v151, v151
    s_setprio 0
    ds_read_b32 v22, v19
    v_sub_f32 v152, v152, v2
    v_exp_f32 v152, v152
    v_sub_f32 v153, v153, v2
    v_exp_f32 v153, v153
    v_sub_f32 v154, v154, v2
    v_exp_f32 v154, v154
    v_smfmac_f32_32x32x32_bf16 v[168:183], v[92:95], v[144:151], v7
    v_sub_f32 v155, v155, v2
    v_exp_f32 v155, v155
    v_sub_f32 v156, v156, v2
    v_exp_f32 v156, v156
    v_sub_f32 v157, v157, v2
    v_exp_f32 v157, v157
    v_mfma_f32_32x32x16_bf16 v[136:151], v[56:59], v[28:31], 0
    v_sub_f32 v158, v158, v2
    v_exp_f32 v158, v158
    s_cmp_lg_u32 s47, 1
    s_cbranch_scc1 K2_NAS6
    s_waitcnt lgkmcnt(0)
    v_cmp_gt_u32 vcc, 6, v22
    s_cbranch_vccnz K2_RAS6
K2_CAS6:
    ds_read_b128 v[32:35], v12
    ds_read_b128 v[36:39], v12 offset:16
    ds_read_b64 v[216:217], v11 offset:0
    ds_read_b64 v[218:219], v11 offset:2048
    ds_read_b64 v[220:221], v11 offset:4096
    ds_read_b64 v[222:223], v11 offset:6144
    ds_read_b64 v[224:225], v11 offset:8192
    ds_read_b64 v[226:227], v11 offset:10240
    ds_read_b64 v[228:229], v11 offset:12288
    ds_read_b64 v[230:231], v11 offset:14336
K2_NAS6:
    v_sub_f32 v159, v159, v2
    v_exp_f32 v159, v159
    v_sub_f32 v160, v160, v2
    v_exp_f32 v160, v160
    v_mfma_f32_32x32x16_bf16 v[184:199], v[24:27], v[24:27], 0
    v_sub_f32 v161, v161, v2
    v_exp_f32 v161, v161
    v_sub_f32 v162, v162, v2
    v_exp_f32 v162, v162
    v_sub_f32 v163, v163, v2
    v_exp_f32 v163, v163
    v_smfmac_f32_32x32x32_bf16 v[168:183], v[96:99], v[152:159], v7
    v_sub_f32 v164, v164, v2
    v_exp_f32 v164, v164
    s_mov_b32 s46, 327680
    buffer_load_dwordx4 v[208:211], v15, s[32:35], s46 offen offset:2048
    v_sub_f32 v165, v165, v2
    v_exp_f32 v165, v165
    v_sub_f32 v166, v166, v2
    v_exp_f32 v166, v166
    v_sub_f32 v167, v167, v2
    v_exp_f32 v167, v167
    s_setprio 3
    v_sub_f32 v136, v136, v2
    v_exp_f32 v136, v136
    v_sub_f32 v137, v137, v2
    v_exp_f32 v137, v137
    v_sub_f32 v138, v138, v2
    v_exp_f32 v138, v138
    v_smfmac_f32_32x32x32_bf16 v[168:183], v[100:103], v[160:167], v7
    s_cmp_lg_u32 s47, 1
    s_cbranch_scc1 K2_NBS6
    s_waitcnt lgkmcnt(0)
    v_pk_add_f32 v[32:33], v[32:33], v[34:35]
    v_pk_add_f32 v[36:37], v[36:37], v[38:39]
    v_pk_add_f32 v[216:217], v[216:217], v[218:219]
    v_pk_add_f32 v[220:221], v[220:221], v[222:223]
    v_pk_add_f32 v[224:225], v[224:225], v[226:227]
    v_pk_add_f32 v[228:229], v[228:229], v[230:231]
    v_pk_add_f32 v[32:33], v[32:33], v[36:37]
    v_pk_add_f32 v[216:217], v[216:217], v[220:221]
    v_add_f32 v32, v32, v33
    v_pk_add_f32 v[224:225], v[224:225], v[228:229]
    v_rcp_f32 v32, v32
    v_pk_add_f32 v[216:217], v[216:217], v[224:225]
    v_pk_mul_f32 v[216:217], v[216:217], v[32:33] op_sel_hi:[1,0]
    v_cvt_pk_bf16_f32 v216, v216, v217
    ds_write_b32 v13, v216
    ds_write_b32 v21, v23 offset:32
K2_NBS6:
    v_sub_f32 v139, v139, v2
    v_exp_f32 v139, v139
    s_add_u32 s22, s61, 2
    s_and_b32 s22, s22, 15
    s_mul_i32 s22, s22, 44032
    s_add_u32 m0, s7, 8064
    s_nop 0
    buffer_load_dwordx4 v18, s[56:59], s22 offen offset:128 lds
    v_sub_f32 v140, v140, v2
    v_exp_f32 v140, v140
    v_sub_f32 v141, v141, v2
    v_exp_f32 v141, v141
    v_mfma_f32_32x32x16_bf16 v[152:167], v[60:63], v[28:31], 0
    v_sub_f32 v142, v142, v2
    v_exp_f32 v142, v142
    v_sub_f32 v143, v143, v2
    v_exp_f32 v143, v143
    s_mov_b32 s46, 331776
    buffer_load_dwordx4 v[216:219], v15, s[32:35], s46 offen offset:0
    v_sub_f32 v144, v144, v2
    v_exp_f32 v144, v144
    v_sub_f32 v145, v145, v2
    v_exp_f32 v145, v145
    v_sub_f32 v146, v146, v2
    v_exp_f32 v146, v146
    v_smfmac_f32_32x32x32_bf16 v[168:183], v[104:107], v[136:143], v7
    v_sub_f32 v147, v147, v2
    v_exp_f32 v147, v147
    v_sub_f32 v148, v148, v2
    v_exp_f32 v148, v148
    s_mov_b32 s46, 327680
    buffer_load_dwordx4 v[212:215], v15, s[32:35], s46 offen offset:3072
    v_sub_f32 v149, v149, v2
    v_exp_f32 v149, v149
    v_sub_f32 v150, v150, v2
    v_exp_f32 v150, v150
    v_sub_f32 v151, v151, v2
    v_exp_f32 v151, v151
    s_setprio 2
    v_sub_f32 v152, v152, v2
    v_exp_f32 v152, v152
    v_sub_f32 v153, v153, v2
    v_exp_f32 v153, v153
    v_sub_f32 v154, v154, v2
    v_exp_f32 v154, v154
    v_smfmac_f32_32x32x32_bf16 v[168:183], v[108:111], v[144:151], v7
    v_sub_f32 v155, v155, v2
    v_exp_f32 v155, v155
    v_sub_f32 v156, v156, v2
    v_exp_f32 v156, v156
    v_sub_f32 v157, v157, v2
    v_exp_f32 v157, v157
    v_mfma_f32_32x32x16_bf16 v[136:151], v[64:67], v[28:31], 0
    v_sub_f32 v158, v158, v2
    v_exp_f32 v158, v158
    v_sub_f32 v159, v159, v2
    v_exp_f32 v159, v159
    s_mov_b32 s46, 331776
    buffer_load_dwordx4 v[220:223], v15, s[32:35], s46 offen offset:1024
    v_sub_f32 v160, v160, v2
    v_exp_f32 v160, v160
    v_sub_f32 v161, v161, v2
    v_exp_f32 v161, v161
    v_sub_f32 v162, v162, v2
    v_exp_f32 v162, v162
    v_smfmac_f32_32x32x32_bf16 v[168:183], v[112:115], v[152:159], v7
    v_sub_f32 v163, v163, v2
    v_exp_f32 v163, v163
    v_sub_f32 v164, v164, v2
    v_exp_f32 v164, v164
    v_sub_f32 v165, v165, v2
    v_exp_f32 v165, v165
    v_sub_f32 v166, v166, v2
    v_exp_f32 v166, v166
    v_sub_f32 v167, v167, v2
    v_exp_f32 v167, v167
    s_setprio 1
    v_sub_f32 v136, v136, v2
    v_exp_f32 v136, v136
    s_mov_b32 s46, 331776
    buffer_load_dwordx4 v[224:227], v15, s[32:35], s46 offen offset:2048
    ds_read_b32 v22, v20 offset:16
    v_sub_f32 v137, v137, v2
    v_exp_f32 v137, v137
    v_sub_f32 v138, v138, v2
    v_exp_f32 v138, v138
    v_smfmac_f32_32x32x32_bf16 v[168:183], v[116:119], v[160:167], v7
    v_sub_f32 v139, v139, v2
    v_exp_f32 v139, v139
    s_add_u32 s22, s61, 3
    s_and_b32 s22, s22, 15
    s_mul_i32 s22, s22, 44032
    s_add_u32 m0, s7, 9216
    s_nop 0
    buffer_load_dwordx4 v18, s[56:59], s22 offen offset:0 lds
    v_sub_f32 v140, v140, v2
    v_exp_f32 v140, v140
    v_sub_f32 v141, v141, v2
    v_exp_f32 v141, v141
    v_mfma_f32_32x32x16_bf16 v[152:167], v[68:71], v[28:31], 0
    v_sub_f32 v142, v142, v2
    v_exp_f32 v142, v142
    v_sub_f32 v143, v143, v2
    v_exp_f32 v143, v143
    s_waitcnt lgkmcnt(0)
    v_cmp_gt_u32 vcc, 6, v22
    s_cbranch_vccnz K2_RDS6
K2_CDS6:
    ds_read_b128 v[232:235], v14 offset:0
    ds_read_b128 v[236:239], v14 offset:512
    v_sub_f32 v144, v144, v2
    v_exp_f32 v144, v144
    v_sub_f32 v145, v145, v2
    v_exp_f32 v145, v145
    ds_read_b128 v[28:31], v17 offset:7168
    ds_read_b32 v3, v1 offset:896
    v_sub_f32 v146, v146, v2
    v_exp_f32 v146, v146
    v_smfmac_f32_32x32x32_bf16 v[168:183], v[120:123], v[136:143], v7
    v_sub_f32 v147, v147, v2
    v_exp_f32 v147, v147
    v_sub_f32 v148, v148, v2
    v_exp_f32 v148, v148
    v_sub_f32 v149, v149, v2
    v_exp_f32 v149, v149
    v_sub_f32 v150, v150, v2
    v_exp_f32 v150, v150
    s_waitcnt lgkmcnt(0)
    s_waitcnt vmcnt(7)
    v_mfma_f32_16x16x32_bf16 v[240:243], v[200:203], v[232:235], v[240:243]
    v_sub_f32 v151, v151, v2
    v_exp_f32 v151, v151
    s_setprio 0
    v_sub_f32 v152, v152, v2
    v_exp_f32 v152, v152
    v_sub_f32 v153, v153, v2
    v_exp_f32 v153, v153
    v_sub_f32 v154, v154, v2
    v_exp_f32 v154, v154
    v_smfmac_f32_32x32x32_bf16 v[168:183], v[124:127], v[144:151], v7
    v_sub_f32 v155, v155, v2
    v_exp_f32 v155, v155
    v_sub_f32 v156, v156, v2
    v_exp_f32 v156, v156
    v_sub_f32 v157, v157, v2
    v_exp_f32 v157, v157
    s_waitcnt lgkmcnt(0)
    v_mfma_f32_32x32x16_bf16 v[136:151], v[40:43], v[28:31], 0
    v_sub_f32 v158, v158, v2
    v_exp_f32 v158, v158
    v_sub_f32 v159, v159, v2
    v_exp_f32 v159, v159
    s_mov_b32 s46, 331776
    buffer_load_dwordx4 v[228:231], v15, s[32:35], s46 offen offset:3072
    v_sub_f32 v160, v160, v2
    v_exp_f32 v160, v160
    v_mfma_f32_16x16x32_bf16 v[244:247], v[204:207], v[232:235], v[244:247]
    v_sub_f32 v161, v161, v2
    v_exp_f32 v161, v161
    v_sub_f32 v162, v162, v2
    v_exp_f32 v162, v162
    v_smfmac_f32_32x32x32_bf16 v[168:183], v[128:131], v[152:159], v7
    v_sub_f32 v163, v163, v2
    v_exp_f32 v163, v163
    v_sub_f32 v164, v164, v2
    v_exp_f32 v164, v164
    v_sub_f32 v165, v165, v2
    v_exp_f32 v165, v165
    v_sub_f32 v166, v166, v2
    v_exp_f32 v166, v166
    s_waitcnt vmcnt(4)
    v_mfma_f32_16x16x32_bf16 v[248:251], v[208:211], v[232:235], v[248:251]
    v_sub_f32 v167, v167, v2
    v_exp_f32 v167, v167
    s_setprio 3
    v_sub_f32 v136, v136, v3
    v_exp_f32 v136, v136
    v_sub_f32 v137, v137, v3
    v_exp_f32 v137, v137
    v_sub_f32 v138, v138, v3
    v_exp_f32 v138, v138
    v_smfmac_f32_32x32x32_bf16 v[168:183], v[132:135], v[160:167], v7
    v_sub_f32 v139, v139, v3
    v_exp_f32 v139, v139
    s_add_u32 s22, s61, 3
    s_and_b32 s22, s22, 15
    s_mul_i32 s22, s22, 44032
    s_add_u32 m0, s7, 10176
    s_nop 0
    buffer_load_dwordx4 v18, s[56:59], s22 offen offset:64 lds
    v_sub_f32 v140, v140, v3
    v_exp_f32 v140, v140
    v_sub_f32 v141, v141, v3
    v_exp_f32 v141, v141
    v_mfma_f32_32x32x16_bf16 v[152:167], v[44:47], v[28:31], 0
    v_sub_f32 v142, v142, v3
    v_exp_f32 v142, v142
    v_sub_f32 v143, v143, v3
    v_exp_f32 v143, v143
    v_sub_f32 v144, v144, v3
    v_exp_f32 v144, v144
    v_mfma_f32_16x16x32_bf16 v[252:255], v[212:215], v[232:235], v[252:255]
    v_sub_f32 v145, v145, v3
    v_exp_f32 v145, v145
    v_sub_f32 v146, v146, v3
    v_exp_f32 v146, v146
    v_smfmac_f32_32x32x32_bf16 v[184:199], v[72:75], v[136:143], v7
    v_sub_f32 v147, v147, v3
    v_exp_f32 v147, v147
    v_sub_f32 v148, v148, v3
    v_exp_f32 v148, v148
    v_sub_f32 v149, v149, v3
    v_exp_f32 v149, v149
    v_sub_f32 v150, v150, v3
    v_exp_f32 v150, v150
    s_waitcnt vmcnt(4)
    v_mfma_f32_16x16x32_bf16 v[240:243], v[216:219], v[236:239], v[240:243]
    v_sub_f32 v151, v151, v3
    v_exp_f32 v151, v151
    s_setprio 2
    v_mov_b32 v23, 7
    v_sub_f32 v152, v152, v3
    v_exp_f32 v152, v152
    ds_write_b128 v9, v[168:171]
    v_sub_f32 v153, v153, v3
    v_exp_f32 v153, v153
    v_sub_f32 v154, v154, v3
    v_exp_f32 v154, v154
    v_smfmac_f32_32x32x32_bf16 v[184:199], v[76:79], v[144:151], v7
    ds_write_b128 v9, v[172:175] offset:1024
    v_sub_f32 v155, v155, v3
    v_exp_f32 v155, v155
    v_sub_f32 v156, v156, v3
    v_exp_f32 v156, v156
    ds_write_b32 v10, v176
    v_sub_f32 v157, v157, v3
    v_exp_f32 v157, v157
    v_mfma_f32_32x32x16_bf16 v[136:151], v[48:51], v[28:31], 0
    v_sub_f32 v158, v158, v3
    v_exp_f32 v158, v158
    ds_write_b32 v21, v23
    v_sub_f32 v159, v159, v3
    v_exp_f32 v159, v159
    v_sub_f32 v160, v160, v3
    v_exp_f32 v160, v160
    v_mfma_f32_16x16x32_bf16 v[244:247], v[220:223], v[236:239], v[244:247]
    v_sub_f32 v161, v161, v3
    v_exp_f32 v161, v161
    v_sub_f32 v162, v162, v3
    v_exp_f32 v162, v162
    v_smfmac_f32_32x32x32_bf16 v[184:199], v[80:83], v[152:159], v7
    v_sub_f32 v163, v163, v3
    v_exp_f32 v163, v163
    v_sub_f32 v164, v164, v3
    v_exp_f32 v164, v164
    s_mov_b32 s46, 393216
    buffer_load_dwordx4 v[200:203], v15, s[32:35], s46 offen offset:0
    v_sub_f32 v165, v165, v3
    v_exp_f32 v165, v165
    v_sub_f32 v166, v166, v3
    v_exp_f32 v166, v166
    s_waitcnt vmcnt(4)
    v_mfma_f32_16x16x32_bf16 v[248:251], v[224:227], v[236:239], v[248:251]
    v_sub_f32 v167, v167, v3
    v_exp_f32 v167, v167
    s_setprio 1
    v_sub_f32 v136, v136, v3
    v_exp_f32 v136, v136
    s_and_b32 s51, s5, 7
    s_lshl_b32 s60, s51, 3
    s_add_u32 s60, s60, s20
    s_mul_i32 s60, s60, 22528
    v_sub_f32 v137, v137, v3
    v_exp_f32 v137, v137
    v_sub_f32 v138, v138, v3
    v_exp_f32 v138, v138
    v_smfmac_f32_32x32x32_bf16 v[184:199], v[84:87], v[160:167], v7
    v_sub_f32 v139, v139, v3
    v_exp_f32 v139, v139
    s_add_u32 s22, s61, 3
    s_and_b32 s22, s22, 15
    s_mul_i32 s22, s22, 44032
    s_add_u32 m0, s7, 11136
    s_nop 0
    buffer_load_dwordx4 v18, s[56:59], s22 offen offset:128 lds
    v_sub_f32 v140, v140, v3
    v_exp_f32 v140, v140
    v_sub_f32 v141, v141, v3
    v_exp_f32 v141, v141
    v_mfma_f32_32x32x16_bf16 v[152:167], v[52:55], v[28:31], 0
    v_sub_f32 v142, v142, v3
    v_exp_f32 v142, v142
    v_sub_f32 v143, v143, v3
    v_exp_f32 v143, v143
    v_sub_f32 v144, v144, v3
    v_exp_f32 v144, v144
    s_waitcnt vmcnt(3)
    v_mfma_f32_16x16x32_bf16 v[252:255], v[228:231], v[236:239], v[252:255]
    v_sub_f32 v145, v145, v3
    v_exp_f32 v145, v145
    v_sub_f32 v146, v146, v3
    v_exp_f32 v146, v146
    v_smfmac_f32_32x32x32_bf16 v[184:199], v[88:91], v[136:143], v7
    v_sub_f32 v147, v147, v3
    v_exp_f32 v147, v147
    v_sub_f32 v148, v148, v3
    v_exp_f32 v148, v148
    s_waitcnt lgkmcnt(0)
    s_mov_b32 s46, 393216
    buffer_load_dwordx4 v[204:207], v15, s[32:35], s46 offen offset:1024
    v_sub_f32 v149, v149, v3
    v_exp_f32 v149, v149
    v_sub_f32 v150, v150, v3
    v_exp_f32 v150, v150
    v_sub_f32 v151, v151, v3
    v_exp_f32 v151, v151
    s_setprio 0
    ds_read_b32 v22, v19
    v_sub_f32 v152, v152, v3
    v_exp_f32 v152, v152
    v_sub_f32 v153, v153, v3
    v_exp_f32 v153, v153
    v_sub_f32 v154, v154, v3
    v_exp_f32 v154, v154
    v_smfmac_f32_32x32x32_bf16 v[184:199], v[92:95], v[144:151], v7
    v_sub_f32 v155, v155, v3
    v_exp_f32 v155, v155
    s_mov_b32 s46, 458752
    buffer_load_dwordx4 v[40:43], v15, s[32:35], s46 offen offset:0
    v_sub_f32 v156, v156, v3
    v_exp_f32 v156, v156
    v_sub_f32 v157, v157, v3
    v_exp_f32 v157, v157
    v_mfma_f32_32x32x16_bf16 v[136:151], v[56:59], v[28:31], 0
    v_sub_f32 v158, v158, v3
    v_exp_f32 v158, v158
    s_cmp_lg_u32 s47, 0
    s_cbranch_scc1 K2_NAS7
    s_waitcnt lgkmcnt(0)
    v_cmp_gt_u32 vcc, 7, v22
    s_cbranch_vccnz K2_RAS7
K2_CAS7:
    ds_read_b128 v[32:35], v12
    ds_read_b128 v[36:39], v12 offset:16
    ds_read_b64 v[216:217], v11 offset:0
    ds_read_b64 v[218:219], v11 offset:2048
    ds_read_b64 v[220:221], v11 offset:4096
    ds_read_b64 v[222:223], v11 offset:6144
    ds_read_b64 v[224:225], v11 offset:8192
    ds_read_b64 v[226:227], v11 offset:10240
    ds_read_b64 v[228:229], v11 offset:12288
    ds_read_b64 v[230:231], v11 offset:14336
K2_NAS7:
    v_sub_f32 v159, v159, v3
    v_exp_f32 v159, v159
    v_sub_f32 v160, v160, v3
    v_exp_f32 v160, v160
    v_mfma_f32_32x32x16_bf16 v[168:183], v[24:27], v[24:27], 0
    v_sub_f32 v161, v161, v3
    v_exp_f32 v161, v161
    v_sub_f32 v162, v162, v3
    v_exp_f32 v162, v162
    v_sub_f32 v163, v163, v3
    v_exp_f32 v163, v163
    v_smfmac_f32_32x32x32_bf16 v[184:199], v[96:99], v[152:159], v7
    v_sub_f32 v164, v164, v3
    v_exp_f32 v164, v164
    s_mov_b32 s46, 393216
    buffer_load_dwordx4 v[208:211], v15, s[32:35], s46 offen offset:2048
    v_sub_f32 v165, v165, v3
    v_exp_f32 v165, v165
    v_sub_f32 v166, v166, v3
    v_exp_f32 v166, v166
    v_sub_f32 v167, v167, v3
    v_exp_f32 v167, v167
    s_setprio 3
    v_sub_f32 v136, v136, v3
    v_exp_f32 v136, v136
    v_sub_f32 v137, v137, v3
    v_exp_f32 v137, v137
    v_sub_f32 v138, v138, v3
    v_exp_f32 v138, v138
    v_smfmac_f32_32x32x32_bf16 v[184:199], v[100:103], v[160:167], v7
    s_cmp_lg_u32 s47, 0
    s_cbranch_scc1 K2_NBS7
    s_waitcnt lgkmcnt(0)
    v_pk_add_f32 v[32:33], v[32:33], v[34:35]
    v_pk_add_f32 v[36:37], v[36:37], v[38:39]
    v_pk_add_f32 v[216:217], v[216:217], v[218:219]
    v_pk_add_f32 v[220:221], v[220:221], v[222:223]
    v_pk_add_f32 v[224:225], v[224:225], v[226:227]
    v_pk_add_f32 v[228:229], v[228:229], v[230:231]
    v_pk_add_f32 v[32:33], v[32:33], v[36:37]
    v_pk_add_f32 v[216:217], v[216:217], v[220:221]
    v_add_f32 v32, v32, v33
    v_pk_add_f32 v[224:225], v[224:225], v[228:229]
    v_rcp_f32 v32, v32
    v_pk_add_f32 v[216:217], v[216:217], v[224:225]
    v_pk_mul_f32 v[216:217], v[216:217], v[32:33] op_sel_hi:[1,0]
    v_cvt_pk_bf16_f32 v216, v216, v217
    ds_write_b32 v13, v216
    ds_write_b32 v21, v23 offset:32
K2_NBS7:
    v_sub_f32 v139, v139, v3
    v_exp_f32 v139, v139
    s_mov_b32 s46, 458752
    buffer_load_dwordx4 v[44:47], v15, s[32:35], s46 offen offset:1024
    v_sub_f32 v140, v140, v3
    v_exp_f32 v140, v140
    v_sub_f32 v141, v141, v3
    v_exp_f32 v141, v141
    v_mfma_f32_32x32x16_bf16 v[152:167], v[60:63], v[28:31], 0
    v_sub_f32 v142, v142, v3
    v_exp_f32 v142, v142
    v_sub_f32 v143, v143, v3
    v_exp_f32 v143, v143
    s_mov_b32 s46, 397312
    buffer_load_dwordx4 v[216:219], v15, s[32:35], s46 offen offset:0
    v_sub_f32 v144, v144, v3
    v_exp_f32 v144, v144
    v_sub_f32 v145, v145, v3
    v_exp_f32 v145, v145
    v_sub_f32 v146, v146, v3
    v_exp_f32 v146, v146
    v_smfmac_f32_32x32x32_bf16 v[184:199], v[104:107], v[136:143], v7
    v_sub_f32 v147, v147, v3
    v_exp_f32 v147, v147
    v_sub_f32 v148, v148, v3
    v_exp_f32 v148, v148
    s_mov_b32 s46, 393216
    buffer_load_dwordx4 v[212:215], v15, s[32:35], s46 offen offset:3072
    v_sub_f32 v149, v149, v3
    v_exp_f32 v149, v149
    v_sub_f32 v150, v150, v3
    v_exp_f32 v150, v150
    v_sub_f32 v151, v151, v3
    v_exp_f32 v151, v151
    s_mov_b32 s46, 462848
    buffer_load_dwordx4 v[56:59], v15, s[32:35], s46 offen offset:0
    s_setprio 2
    v_sub_f32 v152, v152, v3
    v_exp_f32 v152, v152
    v_sub_f32 v153, v153, v3
    v_exp_f32 v153, v153
    v_sub_f32 v154, v154, v3
    v_exp_f32 v154, v154
    v_smfmac_f32_32x32x32_bf16 v[184:199], v[108:111], v[144:151], v7
    v_sub_f32 v155, v155, v3
    v_exp_f32 v155, v155
    s_mov_b32 s46, 458752
    buffer_load_dwordx4 v[48:51], v15, s[32:35], s46 offen offset:2048
    v_sub_f32 v156, v156, v3
    v_exp_f32 v156, v156
    v_sub_f32 v157, v157, v3
    v_exp_f32 v157, v157
    v_mfma_f32_32x32x16_bf16 v[136:151], v[64:67], v[28:31], 0
    v_sub_f32 v158, v158, v3
    v_exp_f32 v158, v158
    v_sub_f32 v159, v159, v3
    v_exp_f32 v159, v159
    s_mov_b32 s46, 397312
    buffer_load_dwordx4 v[220:223], v15, s[32:35], s46 offen offset:1024
    v_sub_f32 v160, v160, v3
    v_exp_f32 v160, v160
    v_sub_f32 v161, v161, v3
    v_exp_f32 v161, v161
    v_sub_f32 v162, v162, v3
    v_exp_f32 v162, v162
    v_smfmac_f32_32x32x32_bf16 v[184:199], v[112:115], v[152:159], v7
    v_sub_f32 v163, v163, v3
    v_exp_f32 v163, v163
    v_sub_f32 v164, v164, v3
    v_exp_f32 v164, v164
    v_sub_f32 v165, v165, v3
    v_exp_f32 v165, v165
    v_sub_f32 v166, v166, v3
    v_exp_f32 v166, v166
    v_sub_f32 v167, v167, v3
    v_exp_f32 v167, v167
    s_mov_b32 s46, 462848
    buffer_load_dwordx4 v[60:63], v15, s[32:35], s46 offen offset:1024
    s_setprio 1
    v_sub_f32 v136, v136, v3
    v_exp_f32 v136, v136
    s_mov_b32 s46, 397312
    buffer_load_dwordx4 v[224:227], v15, s[32:35], s46 offen offset:2048
    ds_read_b32 v22, v20 offset:0
    v_sub_f32 v137, v137, v3
    v_exp_f32 v137, v137
    v_sub_f32 v138, v138, v3
    v_exp_f32 v138, v138
    v_smfmac_f32_32x32x32_bf16 v[184:199], v[116:119], v[160:167], v7
    v_sub_f32 v139, v139, v3
    v_exp_f32 v139, v139
    s_mov_b32 s46, 458752
    buffer_load_dwordx4 v[52:55], v15, s[32:35], s46 offen offset:3072
    v_sub_f32 v140, v140, v3
    v_exp_f32 v140, v140
    v_sub_f32 v141, v141, v3
    v_exp_f32 v141, v141
    v_mfma_f32_32x32x16_bf16 v[152:167], v[68:71], v[28:31], 0
    v_sub_f32 v142, v142, v3
    v_exp_f32 v142, v142
    v_sub_f32 v143, v143, v3
    v_exp_f32 v143, v143
    s_waitcnt lgkmcnt(0)
    v_cmp_gt_u32 vcc, 7, v22
    s_cbranch_vccnz K2_RDS7
K2_CDS7:
    ds_read_b128 v[232:235], v14 offset:0
    ds_read_b128 v[236:239], v14 offset:512
    v_sub_f32 v144, v144, v3
    v_exp_f32 v144, v144
    v_sub_f32 v145, v145, v3
    v_exp_f32 v145, v145
    v_sub_f32 v146, v146, v3
    v_exp_f32 v146, v146
    v_smfmac_f32_32x32x32_bf16 v[184:199], v[120:123], v[136:143], v7
    v_sub_f32 v147, v147, v3
    v_exp_f32 v147, v147
    v_sub_f32 v148, v148, v3
    v_exp_f32 v148, v148
    v_sub_f32 v149, v149, v3
    v_exp_f32 v149, v149
    v_sub_f32 v150, v150, v3
    v_exp_f32 v150, v150
    s_waitcnt lgkmcnt(0)
    s_waitcnt vmcnt(11)
    v_mfma_f32_16x16x32_bf16 v[240:243], v[200:203], v[232:235], v[240:243]
    v_sub_f32 v151, v151, v3
    v_exp_f32 v151, v151
    s_mov_b32 s46, 462848
    buffer_load_dwordx4 v[64:67], v15, s[32:35], s46 offen offset:2048
    s_setprio 0
    v_sub_f32 v152, v152, v3
    v_exp_f32 v152, v152
    v_sub_f32 v153, v153, v3
    v_exp_f32 v153, v153
    v_sub_f32 v154, v154, v3
    v_exp_f32 v154, v154
    v_smfmac_f32_32x32x32_bf16 v[184:199], v[124:127], v[144:151], v7
    v_sub_f32 v155, v155, v3
    v_exp_f32 v155, v155
    v_sub_f32 v156, v156, v3
    v_exp_f32 v156, v156
    v_sub_f32 v157, v157, v3
    v_exp_f32 v157, v157
    v_sub_f32 v158, v158, v3
    v_exp_f32 v158, v158
    v_sub_f32 v159, v159, v3
    v_exp_f32 v159, v159
    s_mov_b32 s46, 397312
    buffer_load_dwordx4 v[228:231], v15, s[32:35], s46 offen offset:3072
    v_sub_f32 v160, v160, v3
    v_exp_f32 v160, v160
    v_mfma_f32_16x16x32_bf16 v[244:247], v[204:207], v[232:235], v[244:247]
    v_sub_f32 v161, v161, v3
    v_exp_f32 v161, v161
    v_sub_f32 v162, v162, v3
    v_exp_f32 v162, v162
    v_smfmac_f32_32x32x32_bf16 v[184:199], v[128:131], v[152:159], v7
    v_sub_f32 v163, v163, v3
    v_exp_f32 v163, v163
    v_sub_f32 v164, v164, v3
    v_exp_f32 v164, v164
    v_sub_f32 v165, v165, v3
    v_exp_f32 v165, v165
    v_sub_f32 v166, v166, v3
    v_exp_f32 v166, v166
    s_waitcnt vmcnt(8)
    v_mfma_f32_16x16x32_bf16 v[248:251], v[208:211], v[232:235], v[248:251]
    v_sub_f32 v167, v167, v3
    v_exp_f32 v167, v167
    s_mov_b32 s46, 462848
    buffer_load_dwordx4 v[68:71], v15, s[32:35], s46 offen offset:3072
    s_nop 1
    v_smfmac_f32_32x32x32_bf16 v[184:199], v[132:135], v[160:167], v7
    s_branch K2_TAIL
K2_RAF1:
    ds_read_b32 v22, v19 offset:0
    s_waitcnt lgkmcnt(0)
    v_cmp_gt_u32 vcc, 1, v22
    s_cbranch_vccnz K2_RAF1
    s_branch K2_CAF1
K2_RDF1:
    ds_read_b32 v22, v20 offset:0
    s_waitcnt lgkmcnt(0)
    v_cmp_gt_u32 vcc, 1, v22
    s_cbranch_vccnz K2_RDF1
    s_branch K2_CDF1
K2_RAF2:
    ds_read_b32 v22, v19 offset:0
    s_waitcnt lgkmcnt(0)
    v_cmp_gt_u32 vcc, 2, v22
    s_cbranch_vccnz K2_RAF2
    s_branch K2_CAF2
K2_RDF2:
    ds_read_b32 v22, v20 offset:16
    s_waitcnt lgkmcnt(0)
    v_cmp_gt_u32 vcc, 2, v22
    s_cbranch_vccnz K2_RDF2
    s_branch K2_CDF2
K2_RAF3:
    ds_read_b32 v22, v19 offset:0
    s_waitcnt lgkmcnt(0)
    v_cmp_gt_u32 vcc, 3, v22
    s_cbranch_vccnz K2_RAF3
    s_branch K2_CAF3
K2_RDF3:
    ds_read_b32 v22, v20 offset:0
    s_waitcnt lgkmcnt(0)
    v_cmp_gt_u32 vcc, 3, v22
    s_cbranch_vccnz K2_RDF3
    s_branch K2_CDF3
K2_RAF4:
    ds_read_b32 v22, v19 offset:0
    s_waitcnt lgkmcnt(0)
    v_cmp_gt_u32 vcc, 4, v22
    s_cbranch_vccnz K2_RAF4
    s_branch K2_CAF4
K2_RDF4:
    ds_read_b32 v22, v20 offset:16
    s_waitcnt lgkmcnt(0)
    v_cmp_gt_u32 vcc, 4, v22
    s_cbranch_vccnz K2_RDF4
    s_branch K2_CDF4
K2_RAF5:
    ds_read_b32 v22, v19 offset:0
    s_waitcnt lgkmcnt(0)
    v_cmp_gt_u32 vcc, 5, v22
    s_cbranch_vccnz K2_RAF5
    s_branch K2_CAF5
K2_RDF5:
    ds_read_b32 v22, v20 offset:0
    s_waitcnt lgkmcnt(0)
    v_cmp_gt_u32 vcc, 5, v22
    s_cbranch_vccnz K2_RDF5
    s_branch K2_CDF5
K2_RAF6:
    ds_read_b32 v22, v19 offset:0
    s_waitcnt lgkmcnt(0)
    v_cmp_gt_u32 vcc, 6, v22
    s_cbranch_vccnz K2_RAF6
    s_branch K2_CAF6
K2_RDF6:
    ds_read_b32 v22, v20 offset:16
    s_waitcnt lgkmcnt(0)
    v_cmp_gt_u32 vcc, 6, v22
    s_cbranch_vccnz K2_RDF6
    s_branch K2_CDF6
K2_RAF7:
    ds_read_b32 v22, v19 offset:0
    s_waitcnt lgkmcnt(0)
    v_cmp_gt_u32 vcc, 7, v22
    s_cbranch_vccnz K2_RAF7
    s_branch K2_CAF7
K2_RDF7:
    ds_read_b32 v22, v20 offset:0
    s_waitcnt lgkmcnt(0)
    v_cmp_gt_u32 vcc, 7, v22
    s_cbranch_vccnz K2_RDF7
    s_branch K2_CDF7
K2_RAS1:
    ds_read_b32 v22, v19 offset:0
    s_waitcnt lgkmcnt(0)
    v_cmp_gt_u32 vcc, 1, v22
    s_cbranch_vccnz K2_RAS1
    s_branch K2_CAS1
K2_RDS1:
    ds_read_b32 v22, v20 offset:0
    s_waitcnt lgkmcnt(0)
    v_cmp_gt_u32 vcc, 1, v22
    s_cbranch_vccnz K2_RDS1
    s_branch K2_CDS1
K2_RAS2:
    ds_read_b32 v22, v19 offset:0
    s_waitcnt lgkmcnt(0)
    v_cmp_gt_u32 vcc, 2, v22
    s_cbranch_vccnz K2_RAS2
    s_branch K2_CAS2
K2_RDS2:
    ds_read_b32 v22, v20 offset:16
    s_waitcnt lgkmcnt(0)
    v_cmp_gt_u32 vcc, 2, v22
    s_cbranch_vccnz K2_RDS2
    s_branch K2_CDS2
K2_RAS3:
    ds_read_b32 v22, v19 offset:0
    s_waitcnt lgkmcnt(0)
    v_cmp_gt_u32 vcc, 3, v22
    s_cbranch_vccnz K2_RAS3
    s_branch K2_CAS3
K2_RDS3:
    ds_read_b32 v22, v20 offset:0
    s_waitcnt lgkmcnt(0)
    v_cmp_gt_u32 vcc, 3, v22
    s_cbranch_vccnz K2_RDS3
    s_branch K2_CDS3
K2_RAS4:
    ds_read_b32 v22, v19 offset:0
    s_waitcnt lgkmcnt(0)
    v_cmp_gt_u32 vcc, 4, v22
    s_cbranch_vccnz K2_RAS4
    s_branch K2_CAS4
K2_RDS4:
    ds_read_b32 v22, v20 offset:16
    s_waitcnt lgkmcnt(0)
    v_cmp_gt_u32 vcc, 4, v22
    s_cbranch_vccnz K2_RDS4
    s_branch K2_CDS4
K2_RAS5:
    ds_read_b32 v22, v19 offset:0
    s_waitcnt lgkmcnt(0)
    v_cmp_gt_u32 vcc, 5, v22
    s_cbranch_vccnz K2_RAS5
    s_branch K2_CAS5
K2_RDS5:
    ds_read_b32 v22, v20 offset:0
    s_waitcnt lgkmcnt(0)
    v_cmp_gt_u32 vcc, 5, v22
    s_cbranch_vccnz K2_RDS5
    s_branch K2_CDS5
K2_RAS6:
    ds_read_b32 v22, v19 offset:0
    s_waitcnt lgkmcnt(0)
    v_cmp_gt_u32 vcc, 6, v22
    s_cbranch_vccnz K2_RAS6
    s_branch K2_CAS6
K2_RDS6:
    ds_read_b32 v22, v20 offset:16
    s_waitcnt lgkmcnt(0)
    v_cmp_gt_u32 vcc, 6, v22
    s_cbranch_vccnz K2_RDS6
    s_branch K2_CDS6
K2_RAS7:
    ds_read_b32 v22, v19 offset:0
    s_waitcnt lgkmcnt(0)
    v_cmp_gt_u32 vcc, 7, v22
    s_cbranch_vccnz K2_RAS7
    s_branch K2_CAS7
K2_RDS7:
    ds_read_b32 v22, v20 offset:0
    s_waitcnt lgkmcnt(0)
    v_cmp_gt_u32 vcc, 7, v22
    s_cbranch_vccnz K2_RDS7
    s_branch K2_CDS7
.section .rodata,"a"
.p2align 6
.amdhsa_kernel qkv_kernel
  .amdhsa_next_free_vgpr 128
  .amdhsa_next_free_sgpr 102
  .amdhsa_accum_offset 128
  .amdhsa_group_segment_fixed_size 0
  .amdhsa_kernarg_size 104
  .amdhsa_user_sgpr_count 2
  .amdhsa_user_sgpr_kernarg_segment_ptr 1
  .amdhsa_system_sgpr_workgroup_id_x 1
.end_amdhsa_kernel
.p2align 6
.amdhsa_kernel attn_kernel
  .amdhsa_next_free_vgpr 256
  .amdhsa_next_free_sgpr 102
  .amdhsa_accum_offset 256
  .amdhsa_group_segment_fixed_size 0
  .amdhsa_kernarg_size 104
  .amdhsa_user_sgpr_count 2
  .amdhsa_user_sgpr_kernarg_segment_ptr 1
  .amdhsa_system_sgpr_workgroup_id_x 1
.end_amdhsa_kernel
```
